```python
import torch

def _softmax(x, axis=-1):
    return torch.softmax(x, dim=axis)

def _gelu(x):
    return torch.nn.functional.gelu(x, approximate='tanh')

def _silu(x):
    return torch.nn.functional.silu(x)

def _sigmoid(x):
    return torch.sigmoid(x)

def _layernorm(x, axis=-1, eps=1e-05):
    m = x.mean(dim=axis, keepdim=True)
    v = x.var(dim=axis, keepdim=True, unbiased=False)
    return (x - m) / torch.sqrt(v + eps)

def _scatter_add(tgt, idx, src, axis=0):
    return tgt.clone().index_add_(axis, idx, src)

def _segment_sum(src, seg, n):
    out = torch.zeros((n,) + src.shape[1:], dtype=src.dtype)
    return out.index_add_(0, seg, src)

def _pad(x, pw):
    flat = tuple((v for pair in reversed(pw) for v in pair))
    return torch.nn.functional.pad(x, flat)
kernel_name = 'adaLN_cond__mha_block__geglu_ffn__prompt'

def setup_inputs():

    _w = lambda a: (lambda t: t.to(torch.bfloat16) if t.is_floating_point() else t)(torch.as_tensor(a))

    def _A_setup():
        B, S, D, H = (1, 2048, 640, 32)
        return {'x': _w((lambda *s: torch.randn(*s, dtype=torch.bfloat16) * 0.05)(B, S, D)), 'wqkv': _w((lambda *s: torch.randn(*s, dtype=torch.bfloat16) * 0.05)(D, 3 * D)), 'wo': _w((lambda *s: torch.randn(*s, dtype=torch.bfloat16) * 0.05)(D, D))}
    _A_in = _A_setup()

    def _B_setup():
        B, S, D, F = (1, 2048, 640, 1728)
        return {'x': _w((lambda *s: torch.randn(*s, dtype=torch.bfloat16) * 0.05)(B, S, D)), 'w_gate': _w((lambda *s: torch.randn(*s, dtype=torch.bfloat16) * 0.05)(D, F)), 'w_up': _w((lambda *s: torch.randn(*s, dtype=torch.bfloat16) * 0.05)(D, F)), 'w_down': _w((lambda *s: torch.randn(*s, dtype=torch.bfloat16) * 0.05)(F, D))}
    _B_in = _B_setup()
    return {'A_x': _A_in['x'], 'A_wqkv': _A_in['wqkv'], 'A_wo': _A_in['wo'], 'B_x': _B_in['x'], 'B_w_gate': _B_in['w_gate'], 'B_w_up': _B_in['w_up'], 'B_w_down': _B_in['w_down'], 'c': _w((lambda *s: torch.randn(*s, dtype=torch.bfloat16) * 0.1)(1, 640) * 8.0), 'w_mod': _w((lambda *s: torch.randn(*s, dtype=torch.bfloat16) * 0.1)(640, 6 * 640) * 640 ** (-0.5) * 8.0)}

def reference(A_x, A_wqkv, A_wo, B_x, B_w_gate, B_w_up, B_w_down, c, w_mod):

    def _A_ref(x, wqkv, wo):
        B, S, D = x.shape
        H = 32
        Dh = D // H
        qkv = (lambda x, *d: x.permute(*d))((x @ wqkv).reshape(B, S, 3, H, Dh), 2, 0, 3, 1, 4)
        q, k, v = (qkv[0], qkv[1], qkv[2])
        scores = torch.einsum('bhqd,bhkd->bhqk', q, k) * Dh ** (-0.5)
        p = _softmax(scores, axis=-1)
        o = torch.einsum('bhqk,bhkd->bhqd', p, v)
        return (lambda x, *d: x.permute(*d))(o, 0, 2, 1, 3).reshape(B, S, D) @ wo

    def _B_ref(x, w_gate, w_up, w_down):
        return _gelu(x @ w_gate) * (x @ w_up) @ w_down
    x = A_x
    mod = (_silu(c) @ w_mod).reshape(c.shape[0], 6, 1, -1)
    sa, ca, ga, sb, cb, gb = (mod[:, 0].clone(), mod[:, 1].clone(), mod[:, 2].clone(), mod[:, 3].clone(), mod[:, 4].clone(), mod[:, 5].clone())
    h = _layernorm(x, axis=-1) * (1 + ca) + sa
    x = x + ga * _A_ref(h, A_wqkv, A_wo)
    h = _layernorm(x, axis=-1) * (1 + cb) + sb
    x = x + gb * _B_ref(h, B_w_gate, B_w_up, B_w_down)
    return x
```

```asm
; @launch grid=(256,1,1) block=(512,1,1) lds=163840
.amdgcn_target "amdgcn-amd-amdhsa--gfx950"
.text
.globl adaLN_cond__mha_block__geglu_ffn__prompt_kernel
.p2align 8
.type adaLN_cond__mha_block__geglu_ffn__prompt_kernel,@function
adaLN_cond__mha_block__geglu_ffn__prompt_kernel:
    s_cmp_ge_u32 s2, 256
    s_cbranch_scc1 Lend
    s_load_dwordx16 s[4:19], s[0:1], 0
    s_load_dwordx8 s[20:27], s[0:1], 64
    v_lshrrev_b32 v2, 6, v0
    v_and_b32 v1, 63, v0
    s_nop 0
    v_readfirstlane_b32 s32, v2
    v_mov_b32 v2, 0
    v_mov_b32 v3, 0
    v_lshlrev_b32 v4, 3, v1
    ds_write_b64 v4, v[2:3] offset:3520
    s_and_b32 s37, s2, 1
    s_lshl_b32 s37, s37, 3
    s_bfe_u32 s38, s2, 0x30003
    s_add_u32 s34, s37, s38
    s_bfe_u32 s37, s2, 0x20001
    s_lshl_b32 s37, s37, 2
    s_lshr_b32 s38, s2, 6
    s_add_u32 s33, s37, s38
    s_lshl_b32 s36, s33, 4
    s_add_u32 s36, s36, s34
    s_mov_b32 s47, s33
    s_mov_b32 s43, s34
    s_mul_i32 s60, s2, 3277
    s_lshr_b32 s60, s60, 16
    s_mul_i32 s37, s60, 20
    s_sub_u32 s61, s2, s37
    s_lshl_b32 s61, s61, 7
    s_waitcnt lgkmcnt(0)
    s_load_dword s35, s[26:27], 0
    s_mov_b32 s28, s26
    s_mov_b32 s29, s27
    s_mov_b32 s30, 0x10000000
    s_mov_b32 s31, 0x20000
    s_cmp_ge_u32 s32, 3
    s_cbranch_scc1 Lp0
    s_cmp_ge_u32 s32, 1
    s_cbranch_scc1 Lgv
    v_and_b32 v6, 7, v1
    v_mul_u32_u24 v10, 1280, v6
    v_lshrrev_b32 v2, 3, v1
    v_lshl_add_u32 v10, v2, 4, v10
    s_mul_i32 s37, s36, 10240
    v_add_u32 v10, s37, v10
    global_load_dwordx4 v[12:15], v10, s[4:5] offset:0
    global_load_dwordx4 v[16:19], v10, s[4:5] offset:128
    global_load_dwordx4 v[20:23], v10, s[4:5] offset:256
    global_load_dwordx4 v[24:27], v10, s[4:5] offset:384
    global_load_dwordx4 v[28:31], v10, s[4:5] offset:512
    global_load_dwordx4 v[32:35], v10, s[4:5] offset:640
    global_load_dwordx4 v[36:39], v10, s[4:5] offset:768
    global_load_dwordx4 v[40:43], v10, s[4:5] offset:896
    global_load_dwordx4 v[44:47], v10, s[4:5] offset:1024
    global_load_dwordx4 v[48:51], v10, s[4:5] offset:1152
    s_barrier
    v_mov_b32 v128, 0
    v_mov_b32 v129, 0
    v_mov_b32 v130, 0
    v_mov_b32 v131, 0
    s_mov_b32 s42, 0x3f803f80
    s_lshr_b32 s37, s36, 2
    s_mul_i32 s37, s37, 40960
    s_and_b32 s38, s34, 3
    s_lshl_b32 s38, s38, 7
    s_add_u32 s37, s37, s38
    s_add_u32 s64, s37, 0x2100000
    v_lshlrev_b32 v6, 4, v6
    v_lshrrev_b32 v2, 4, v1
    v_lshl_add_u32 v6, v2, 10, v6
    v_bfe_u32 v2, v1, 3, 1
    v_lshl_add_u32 v6, v2, 9, v6
    s_waitcnt lgkmcnt(0)
    s_mul_i32 s35, s35, 0x9E3779B1
    s_add_u32 s35, s35, 0x7F4A7C15
    s_waitcnt vmcnt(9)
    v_dot2_f32_bf16 v128, v12, s42, v128
    v_dot2_f32_bf16 v129, v12, v12, v129
    v_dot2_f32_bf16 v130, v13, s42, v130
    v_dot2_f32_bf16 v131, v13, v13, v131
    v_dot2_f32_bf16 v128, v14, s42, v128
    v_dot2_f32_bf16 v129, v14, v14, v129
    v_dot2_f32_bf16 v130, v15, s42, v130
    v_dot2_f32_bf16 v131, v15, v15, v131
    s_waitcnt vmcnt(8)
    v_dot2_f32_bf16 v128, v16, s42, v128
    v_dot2_f32_bf16 v129, v16, v16, v129
    v_dot2_f32_bf16 v130, v17, s42, v130
    v_dot2_f32_bf16 v131, v17, v17, v131
    v_dot2_f32_bf16 v128, v18, s42, v128
    v_dot2_f32_bf16 v129, v18, v18, v129
    v_dot2_f32_bf16 v130, v19, s42, v130
    v_dot2_f32_bf16 v131, v19, v19, v131
    s_waitcnt vmcnt(7)
    v_dot2_f32_bf16 v128, v20, s42, v128
    v_dot2_f32_bf16 v129, v20, v20, v129
    v_dot2_f32_bf16 v130, v21, s42, v130
    v_dot2_f32_bf16 v131, v21, v21, v131
    v_dot2_f32_bf16 v128, v22, s42, v128
    v_dot2_f32_bf16 v129, v22, v22, v129
    v_dot2_f32_bf16 v130, v23, s42, v130
    v_dot2_f32_bf16 v131, v23, v23, v131
    s_waitcnt vmcnt(6)
    v_dot2_f32_bf16 v128, v24, s42, v128
    v_dot2_f32_bf16 v129, v24, v24, v129
    v_dot2_f32_bf16 v130, v25, s42, v130
    v_dot2_f32_bf16 v131, v25, v25, v131
    v_dot2_f32_bf16 v128, v26, s42, v128
    v_dot2_f32_bf16 v129, v26, v26, v129
    v_dot2_f32_bf16 v130, v27, s42, v130
    v_dot2_f32_bf16 v131, v27, v27, v131
    s_waitcnt vmcnt(5)
    v_dot2_f32_bf16 v128, v28, s42, v128
    v_dot2_f32_bf16 v129, v28, v28, v129
    v_dot2_f32_bf16 v130, v29, s42, v130
    v_dot2_f32_bf16 v131, v29, v29, v131
    v_dot2_f32_bf16 v128, v30, s42, v128
    v_dot2_f32_bf16 v129, v30, v30, v129
    v_dot2_f32_bf16 v130, v31, s42, v130
    v_dot2_f32_bf16 v131, v31, v31, v131
    s_waitcnt vmcnt(4)
    v_dot2_f32_bf16 v128, v32, s42, v128
    v_dot2_f32_bf16 v129, v32, v32, v129
    v_dot2_f32_bf16 v130, v33, s42, v130
    v_dot2_f32_bf16 v131, v33, v33, v131
    v_dot2_f32_bf16 v128, v34, s42, v128
    v_dot2_f32_bf16 v129, v34, v34, v129
    v_dot2_f32_bf16 v130, v35, s42, v130
    v_dot2_f32_bf16 v131, v35, v35, v131
    s_waitcnt vmcnt(3)
    v_dot2_f32_bf16 v128, v36, s42, v128
    v_dot2_f32_bf16 v129, v36, v36, v129
    v_dot2_f32_bf16 v130, v37, s42, v130
    v_dot2_f32_bf16 v131, v37, v37, v131
    v_dot2_f32_bf16 v128, v38, s42, v128
    v_dot2_f32_bf16 v129, v38, v38, v129
    v_dot2_f32_bf16 v130, v39, s42, v130
    v_dot2_f32_bf16 v131, v39, v39, v131
    s_waitcnt vmcnt(2)
    v_dot2_f32_bf16 v128, v40, s42, v128
    v_dot2_f32_bf16 v129, v40, v40, v129
    v_dot2_f32_bf16 v130, v41, s42, v130
    v_dot2_f32_bf16 v131, v41, v41, v131
    v_dot2_f32_bf16 v128, v42, s42, v128
    v_dot2_f32_bf16 v129, v42, v42, v129
    v_dot2_f32_bf16 v130, v43, s42, v130
    v_dot2_f32_bf16 v131, v43, v43, v131
    s_waitcnt vmcnt(1)
    v_dot2_f32_bf16 v128, v44, s42, v128
    v_dot2_f32_bf16 v129, v44, v44, v129
    v_dot2_f32_bf16 v130, v45, s42, v130
    v_dot2_f32_bf16 v131, v45, v45, v131
    v_dot2_f32_bf16 v128, v46, s42, v128
    v_dot2_f32_bf16 v129, v46, v46, v129
    v_dot2_f32_bf16 v130, v47, s42, v130
    v_dot2_f32_bf16 v131, v47, v47, v131
    s_waitcnt vmcnt(0)
    v_dot2_f32_bf16 v128, v48, s42, v128
    v_dot2_f32_bf16 v129, v48, v48, v129
    v_dot2_f32_bf16 v130, v49, s42, v130
    v_dot2_f32_bf16 v131, v49, v49, v131
    v_dot2_f32_bf16 v128, v50, s42, v128
    v_dot2_f32_bf16 v129, v50, v50, v129
    v_dot2_f32_bf16 v130, v51, s42, v130
    v_dot2_f32_bf16 v131, v51, v51, v131
    s_nop 2
    v_add_f32 v128, v128, v130
    v_add_f32 v129, v129, v131
    v_mov_b32 v130, v128
    v_mov_b32 v131, v129
    s_nop 1
    v_permlane32_swap_b32 v128, v130
    v_permlane32_swap_b32 v129, v131
    v_add_f32 v128, v128, v130
    v_add_f32 v129, v129, v131
    v_mov_b32 v130, v128
    v_mov_b32 v131, v129
    s_nop 1
    v_permlane16_swap_b32 v128, v130
    v_permlane16_swap_b32 v129, v131
    v_add_f32 v128, v128, v130
    v_add_f32 v129, v129, v131
    s_nop 1
    v_add_f32_dpp v128, v128, v128 row_ror:8 row_mask:0xf bank_mask:0xf
    v_add_f32_dpp v129, v129, v129 row_ror:8 row_mask:0xf bank_mask:0xf
    v_mul_f32 v128, 0x3acccccd, v128
    v_mul_f32 v129, 0x3acccccd, v129
    v_fma_f32 v129, -v128, v128, v129
    v_max_f32 v129, 0, v129
    v_add_f32 v129, 0x3727c5ac, v129
    v_rsq_f32 v130, v129
    s_nop 0
    v_mov_b32 v131, v130
    v_mul_f32 v128, v128, v130
    v_sub_f32 v128, 0, v128
    v_mov_b32 v129, v128
    s_mov_b32 s37, s64
    v_lshlrev_b32 v2, 16, v12
    v_and_b32 v3, 0xffff0000, v12
    v_pk_fma_f32 v[2:3], v[2:3], v[130:131], v[128:129]
    v_cvt_pk_bf16_f32 v12, v2, v3
    v_lshlrev_b32 v4, 16, v13
    v_and_b32 v5, 0xffff0000, v13
    v_pk_fma_f32 v[4:5], v[4:5], v[130:131], v[128:129]
    v_cvt_pk_bf16_f32 v13, v4, v5
    v_lshlrev_b32 v2, 16, v14
    v_and_b32 v3, 0xffff0000, v14
    v_pk_fma_f32 v[2:3], v[2:3], v[130:131], v[128:129]
    v_cvt_pk_bf16_f32 v14, v2, v3
    v_lshlrev_b32 v4, 16, v15
    v_and_b32 v5, 0xffff0000, v15
    v_pk_fma_f32 v[4:5], v[4:5], v[130:131], v[128:129]
    v_cvt_pk_bf16_f32 v15, v4, v5
    buffer_store_dwordx4 v[12:15], v6, s[28:31], s37 offen sc1
    s_add_u32 s37, s37, 4096
    v_lshlrev_b32 v2, 16, v16
    v_and_b32 v3, 0xffff0000, v16
    v_pk_fma_f32 v[2:3], v[2:3], v[130:131], v[128:129]
    v_cvt_pk_bf16_f32 v16, v2, v3
    v_lshlrev_b32 v4, 16, v17
    v_and_b32 v5, 0xffff0000, v17
    v_pk_fma_f32 v[4:5], v[4:5], v[130:131], v[128:129]
    v_cvt_pk_bf16_f32 v17, v4, v5
    v_lshlrev_b32 v2, 16, v18
    v_and_b32 v3, 0xffff0000, v18
    v_pk_fma_f32 v[2:3], v[2:3], v[130:131], v[128:129]
    v_cvt_pk_bf16_f32 v18, v2, v3
    v_lshlrev_b32 v4, 16, v19
    v_and_b32 v5, 0xffff0000, v19
    v_pk_fma_f32 v[4:5], v[4:5], v[130:131], v[128:129]
    v_cvt_pk_bf16_f32 v19, v4, v5
    buffer_store_dwordx4 v[16:19], v6, s[28:31], s37 offen sc1
    s_add_u32 s37, s37, 4096
    v_lshlrev_b32 v2, 16, v20
    v_and_b32 v3, 0xffff0000, v20
    v_pk_fma_f32 v[2:3], v[2:3], v[130:131], v[128:129]
    v_cvt_pk_bf16_f32 v20, v2, v3
    v_lshlrev_b32 v4, 16, v21
    v_and_b32 v5, 0xffff0000, v21
    v_pk_fma_f32 v[4:5], v[4:5], v[130:131], v[128:129]
    v_cvt_pk_bf16_f32 v21, v4, v5
    v_lshlrev_b32 v2, 16, v22
    v_and_b32 v3, 0xffff0000, v22
    v_pk_fma_f32 v[2:3], v[2:3], v[130:131], v[128:129]
    v_cvt_pk_bf16_f32 v22, v2, v3
    v_lshlrev_b32 v4, 16, v23
    v_and_b32 v5, 0xffff0000, v23
    v_pk_fma_f32 v[4:5], v[4:5], v[130:131], v[128:129]
    v_cvt_pk_bf16_f32 v23, v4, v5
    buffer_store_dwordx4 v[20:23], v6, s[28:31], s37 offen sc1
    s_add_u32 s37, s37, 4096
    v_lshlrev_b32 v2, 16, v24
    v_and_b32 v3, 0xffff0000, v24
    v_pk_fma_f32 v[2:3], v[2:3], v[130:131], v[128:129]
    v_cvt_pk_bf16_f32 v24, v2, v3
    v_lshlrev_b32 v4, 16, v25
    v_and_b32 v5, 0xffff0000, v25
    v_pk_fma_f32 v[4:5], v[4:5], v[130:131], v[128:129]
    v_cvt_pk_bf16_f32 v25, v4, v5
    v_lshlrev_b32 v2, 16, v26
    v_and_b32 v3, 0xffff0000, v26
    v_pk_fma_f32 v[2:3], v[2:3], v[130:131], v[128:129]
    v_cvt_pk_bf16_f32 v26, v2, v3
    v_lshlrev_b32 v4, 16, v27
    v_and_b32 v5, 0xffff0000, v27
    v_pk_fma_f32 v[4:5], v[4:5], v[130:131], v[128:129]
    v_cvt_pk_bf16_f32 v27, v4, v5
    buffer_store_dwordx4 v[24:27], v6, s[28:31], s37 offen sc1
    s_add_u32 s37, s37, 4096
    v_lshlrev_b32 v2, 16, v28
    v_and_b32 v3, 0xffff0000, v28
    v_pk_fma_f32 v[2:3], v[2:3], v[130:131], v[128:129]
    v_cvt_pk_bf16_f32 v28, v2, v3
    v_lshlrev_b32 v4, 16, v29
    v_and_b32 v5, 0xffff0000, v29
    v_pk_fma_f32 v[4:5], v[4:5], v[130:131], v[128:129]
    v_cvt_pk_bf16_f32 v29, v4, v5
    v_lshlrev_b32 v2, 16, v30
    v_and_b32 v3, 0xffff0000, v30
    v_pk_fma_f32 v[2:3], v[2:3], v[130:131], v[128:129]
    v_cvt_pk_bf16_f32 v30, v2, v3
    v_lshlrev_b32 v4, 16, v31
    v_and_b32 v5, 0xffff0000, v31
    v_pk_fma_f32 v[4:5], v[4:5], v[130:131], v[128:129]
    v_cvt_pk_bf16_f32 v31, v4, v5
    buffer_store_dwordx4 v[28:31], v6, s[28:31], s37 offen sc1
    s_add_u32 s37, s37, 4096
    v_lshlrev_b32 v2, 16, v32
    v_and_b32 v3, 0xffff0000, v32
    v_pk_fma_f32 v[2:3], v[2:3], v[130:131], v[128:129]
    v_cvt_pk_bf16_f32 v32, v2, v3
    v_lshlrev_b32 v4, 16, v33
    v_and_b32 v5, 0xffff0000, v33
    v_pk_fma_f32 v[4:5], v[4:5], v[130:131], v[128:129]
    v_cvt_pk_bf16_f32 v33, v4, v5
    v_lshlrev_b32 v2, 16, v34
    v_and_b32 v3, 0xffff0000, v34
    v_pk_fma_f32 v[2:3], v[2:3], v[130:131], v[128:129]
    v_cvt_pk_bf16_f32 v34, v2, v3
    v_lshlrev_b32 v4, 16, v35
    v_and_b32 v5, 0xffff0000, v35
    v_pk_fma_f32 v[4:5], v[4:5], v[130:131], v[128:129]
    v_cvt_pk_bf16_f32 v35, v4, v5
    buffer_store_dwordx4 v[32:35], v6, s[28:31], s37 offen sc1
    s_add_u32 s37, s37, 4096
    v_lshlrev_b32 v2, 16, v36
    v_and_b32 v3, 0xffff0000, v36
    v_pk_fma_f32 v[2:3], v[2:3], v[130:131], v[128:129]
    v_cvt_pk_bf16_f32 v36, v2, v3
    v_lshlrev_b32 v4, 16, v37
    v_and_b32 v5, 0xffff0000, v37
    v_pk_fma_f32 v[4:5], v[4:5], v[130:131], v[128:129]
    v_cvt_pk_bf16_f32 v37, v4, v5
    v_lshlrev_b32 v2, 16, v38
    v_and_b32 v3, 0xffff0000, v38
    v_pk_fma_f32 v[2:3], v[2:3], v[130:131], v[128:129]
    v_cvt_pk_bf16_f32 v38, v2, v3
    v_lshlrev_b32 v4, 16, v39
    v_and_b32 v5, 0xffff0000, v39
    v_pk_fma_f32 v[4:5], v[4:5], v[130:131], v[128:129]
    v_cvt_pk_bf16_f32 v39, v4, v5
    buffer_store_dwordx4 v[36:39], v6, s[28:31], s37 offen sc1
    s_add_u32 s37, s37, 4096
    v_lshlrev_b32 v2, 16, v40
    v_and_b32 v3, 0xffff0000, v40
    v_pk_fma_f32 v[2:3], v[2:3], v[130:131], v[128:129]
    v_cvt_pk_bf16_f32 v40, v2, v3
    v_lshlrev_b32 v4, 16, v41
    v_and_b32 v5, 0xffff0000, v41
    v_pk_fma_f32 v[4:5], v[4:5], v[130:131], v[128:129]
    v_cvt_pk_bf16_f32 v41, v4, v5
    v_lshlrev_b32 v2, 16, v42
    v_and_b32 v3, 0xffff0000, v42
    v_pk_fma_f32 v[2:3], v[2:3], v[130:131], v[128:129]
    v_cvt_pk_bf16_f32 v42, v2, v3
    v_lshlrev_b32 v4, 16, v43
    v_and_b32 v5, 0xffff0000, v43
    v_pk_fma_f32 v[4:5], v[4:5], v[130:131], v[128:129]
    v_cvt_pk_bf16_f32 v43, v4, v5
    buffer_store_dwordx4 v[40:43], v6, s[28:31], s37 offen sc1
    s_add_u32 s37, s37, 4096
    v_lshlrev_b32 v2, 16, v44
    v_and_b32 v3, 0xffff0000, v44
    v_pk_fma_f32 v[2:3], v[2:3], v[130:131], v[128:129]
    v_cvt_pk_bf16_f32 v44, v2, v3
    v_lshlrev_b32 v4, 16, v45
    v_and_b32 v5, 0xffff0000, v45
    v_pk_fma_f32 v[4:5], v[4:5], v[130:131], v[128:129]
    v_cvt_pk_bf16_f32 v45, v4, v5
    v_lshlrev_b32 v2, 16, v46
    v_and_b32 v3, 0xffff0000, v46
    v_pk_fma_f32 v[2:3], v[2:3], v[130:131], v[128:129]
    v_cvt_pk_bf16_f32 v46, v2, v3
    v_lshlrev_b32 v4, 16, v47
    v_and_b32 v5, 0xffff0000, v47
    v_pk_fma_f32 v[4:5], v[4:5], v[130:131], v[128:129]
    v_cvt_pk_bf16_f32 v47, v4, v5
    buffer_store_dwordx4 v[44:47], v6, s[28:31], s37 offen sc1
    s_add_u32 s37, s37, 4096
    v_lshlrev_b32 v2, 16, v48
    v_and_b32 v3, 0xffff0000, v48
    v_pk_fma_f32 v[2:3], v[2:3], v[130:131], v[128:129]
    v_cvt_pk_bf16_f32 v48, v2, v3
    v_lshlrev_b32 v4, 16, v49
    v_and_b32 v5, 0xffff0000, v49
    v_pk_fma_f32 v[4:5], v[4:5], v[130:131], v[128:129]
    v_cvt_pk_bf16_f32 v49, v4, v5
    v_lshlrev_b32 v2, 16, v50
    v_and_b32 v3, 0xffff0000, v50
    v_pk_fma_f32 v[2:3], v[2:3], v[130:131], v[128:129]
    v_cvt_pk_bf16_f32 v50, v2, v3
    v_lshlrev_b32 v4, 16, v51
    v_and_b32 v5, 0xffff0000, v51
    v_pk_fma_f32 v[4:5], v[4:5], v[130:131], v[128:129]
    v_cvt_pk_bf16_f32 v51, v4, v5
    buffer_store_dwordx4 v[48:51], v6, s[28:31], s37 offen sc1
    s_add_u32 s37, s37, 4096
    v_lshlrev_b32 v7, 7, v1
    v_add_u32 v8, 8192, v7
    v_add_u32 v7, 0x10000, v7
    v_add_u32 v8, 0x10000, v8
    v_and_b32 v3, 15, v1
    s_lshl_b32 s37, s33, 11
    s_add_u32 s37, s37, 0x48000
    v_lshl_add_u32 v3, v3, 7, s37
    v_cmp_gt_u32 vcc, 36, v1
    s_nop 1
    v_cndmask_b32 v8, v3, v8, vcc
    v_and_b32 v9, 15, v1
    s_lshl_b32 s37, s34, 7
    s_add_u32 s37, s37, 0x70000
    v_lshl_add_u32 v9, v9, 11, s37
    s_waitcnt vmcnt(0)
    s_mul_i32 s37, s36, 128
    s_add_u32 s37, s37, 294912
    v_mov_b32 v2, s35
    v_mov_b32 v3, 0
    s_mov_b64 s[44:45], exec
    s_mov_b64 exec, 1
    buffer_store_dword v2, v3, s[28:31], s37 offen sc1
    s_mov_b64 exec, s[44:45]
    s_mov_b32 s46, 30000
Lp0_1:
    buffer_load_dword v2, v7, s[28:31], 0 offen sc1
    buffer_load_dword v3, v8, s[28:31], 0 offen sc1
    buffer_load_dword v4, v9, s[28:31], 0 offen sc1
    s_waitcnt vmcnt(0)
    v_xor_b32 v2, s35, v2
    v_xor_b32 v3, s35, v3
    v_xor_b32 v4, s35, v4
    v_or3_b32 v2, v2, v3, v4
    v_cmp_ne_u32 vcc, 0, v2
    s_cbranch_vccz Lpe0_2
    s_sub_u32 s46, s46, 1
    s_cmp_gt_i32 s46, 0
    s_cbranch_scc1 Lp0_1
Lpe0_2:
    s_branch Lp0b
Lgv:
    s_cmp_ge_u32 s2, 100
    s_cbranch_scc1 Lg1a
    s_sub_u32 s32, s32, 1
    s_lshl_b32 s37, s60, 7
    s_mul_i32 s38, s32, 64
    s_add_u32 s37, s37, s38
    v_lshrrev_b32 v2, 3, v1
    v_add_u32 v2, s37, v2
    v_lshlrev_b32 v3, 1, v2
    v_mul_u32_u24 v2, 7680, v2
    v_and_b32 v4, 7, v1
    v_lshlrev_b32 v4, 4, v4
    v_add3_u32 v2, v2, v4, s61
    global_load_dwordx4 v[12:15], v2, s[20:21]
    v_add_u32 v2, 61440, v2
    global_load_dwordx4 v[16:19], v2, s[20:21]
    v_add_u32 v2, 61440, v2
    global_load_dwordx4 v[20:23], v2, s[20:21]
    v_add_u32 v2, 61440, v2
    global_load_dwordx4 v[24:27], v2, s[20:21]
    v_add_u32 v2, 61440, v2
    global_load_dwordx4 v[28:31], v2, s[20:21]
    v_add_u32 v2, 61440, v2
    global_load_dwordx4 v[32:35], v2, s[20:21]
    v_add_u32 v2, 61440, v2
    global_load_dwordx4 v[36:39], v2, s[20:21]
    v_add_u32 v2, 61440, v2
    global_load_dwordx4 v[40:43], v2, s[20:21]
    global_load_ushort v44, v3, s[18:19] offset:0
    global_load_ushort v45, v3, s[18:19] offset:16
    global_load_ushort v46, v3, s[18:19] offset:32
    global_load_ushort v47, v3, s[18:19] offset:48
    global_load_ushort v48, v3, s[18:19] offset:64
    global_load_ushort v49, v3, s[18:19] offset:80
    global_load_ushort v50, v3, s[18:19] offset:96
    global_load_ushort v51, v3, s[18:19] offset:112
    s_barrier
    s_waitcnt lgkmcnt(0)
    s_mul_i32 s35, s35, 0x9E3779B1
    s_add_u32 s35, s35, 0x7F4A7C15
    s_waitcnt vmcnt(0)
    v_lshlrev_b32 v44, 16, v44
    v_mul_f32 v2, 0xbfb8aa3b, v44
    v_exp_f32 v2, v2
    s_nop 0
    v_add_f32 v2, 1.0, v2
    v_rcp_f32 v2, v2
    s_nop 0
    v_mul_f32 v44, v44, v2
    v_cvt_pk_bf16_f32 v44, v44, v44
    v_and_b32 v44, 0xffff0000, v44
    v_lshlrev_b32 v45, 16, v45
    v_mul_f32 v2, 0xbfb8aa3b, v45
    v_exp_f32 v2, v2
    s_nop 0
    v_add_f32 v2, 1.0, v2
    v_rcp_f32 v2, v2
    s_nop 0
    v_mul_f32 v45, v45, v2
    v_cvt_pk_bf16_f32 v45, v45, v45
    v_and_b32 v45, 0xffff0000, v45
    v_lshlrev_b32 v46, 16, v46
    v_mul_f32 v2, 0xbfb8aa3b, v46
    v_exp_f32 v2, v2
    s_nop 0
    v_add_f32 v2, 1.0, v2
    v_rcp_f32 v2, v2
    s_nop 0
    v_mul_f32 v46, v46, v2
    v_cvt_pk_bf16_f32 v46, v46, v46
    v_and_b32 v46, 0xffff0000, v46
    v_lshlrev_b32 v47, 16, v47
    v_mul_f32 v2, 0xbfb8aa3b, v47
    v_exp_f32 v2, v2
    s_nop 0
    v_add_f32 v2, 1.0, v2
    v_rcp_f32 v2, v2
    s_nop 0
    v_mul_f32 v47, v47, v2
    v_cvt_pk_bf16_f32 v47, v47, v47
    v_and_b32 v47, 0xffff0000, v47
    v_lshlrev_b32 v48, 16, v48
    v_mul_f32 v2, 0xbfb8aa3b, v48
    v_exp_f32 v2, v2
    s_nop 0
    v_add_f32 v2, 1.0, v2
    v_rcp_f32 v2, v2
    s_nop 0
    v_mul_f32 v48, v48, v2
    v_cvt_pk_bf16_f32 v48, v48, v48
    v_and_b32 v48, 0xffff0000, v48
    v_lshlrev_b32 v49, 16, v49
    v_mul_f32 v2, 0xbfb8aa3b, v49
    v_exp_f32 v2, v2
    s_nop 0
    v_add_f32 v2, 1.0, v2
    v_rcp_f32 v2, v2
    s_nop 0
    v_mul_f32 v49, v49, v2
    v_cvt_pk_bf16_f32 v49, v49, v49
    v_and_b32 v49, 0xffff0000, v49
    v_lshlrev_b32 v50, 16, v50
    v_mul_f32 v2, 0xbfb8aa3b, v50
    v_exp_f32 v2, v2
    s_nop 0
    v_add_f32 v2, 1.0, v2
    v_rcp_f32 v2, v2
    s_nop 0
    v_mul_f32 v50, v50, v2
    v_cvt_pk_bf16_f32 v50, v50, v50
    v_and_b32 v50, 0xffff0000, v50
    v_lshlrev_b32 v51, 16, v51
    v_mul_f32 v2, 0xbfb8aa3b, v51
    v_exp_f32 v2, v2
    s_nop 0
    v_add_f32 v2, 1.0, v2
    v_rcp_f32 v2, v2
    s_nop 0
    v_mul_f32 v51, v51, v2
    v_cvt_pk_bf16_f32 v51, v51, v51
    v_and_b32 v51, 0xffff0000, v51
    v_lshlrev_b32 v2, 16, v12
    v_and_b32 v3, 0xffff0000, v12
    v_mul_f32 v136, v2, v44
    v_mul_f32 v137, v3, v44
    v_lshlrev_b32 v2, 16, v13
    v_and_b32 v3, 0xffff0000, v13
    v_mul_f32 v138, v2, v44
    v_mul_f32 v139, v3, v44
    v_lshlrev_b32 v2, 16, v14
    v_and_b32 v3, 0xffff0000, v14
    v_mul_f32 v140, v2, v44
    v_mul_f32 v141, v3, v44
    v_lshlrev_b32 v2, 16, v15
    v_and_b32 v3, 0xffff0000, v15
    v_mul_f32 v142, v2, v44
    v_mul_f32 v143, v3, v44
    v_lshlrev_b32 v2, 16, v16
    v_and_b32 v3, 0xffff0000, v16
    v_fmac_f32 v136, v2, v45
    v_fmac_f32 v137, v3, v45
    v_lshlrev_b32 v2, 16, v17
    v_and_b32 v3, 0xffff0000, v17
    v_fmac_f32 v138, v2, v45
    v_fmac_f32 v139, v3, v45
    v_lshlrev_b32 v2, 16, v18
    v_and_b32 v3, 0xffff0000, v18
    v_fmac_f32 v140, v2, v45
    v_fmac_f32 v141, v3, v45
    v_lshlrev_b32 v2, 16, v19
    v_and_b32 v3, 0xffff0000, v19
    v_fmac_f32 v142, v2, v45
    v_fmac_f32 v143, v3, v45
    v_lshlrev_b32 v2, 16, v20
    v_and_b32 v3, 0xffff0000, v20
    v_fmac_f32 v136, v2, v46
    v_fmac_f32 v137, v3, v46
    v_lshlrev_b32 v2, 16, v21
    v_and_b32 v3, 0xffff0000, v21
    v_fmac_f32 v138, v2, v46
    v_fmac_f32 v139, v3, v46
    v_lshlrev_b32 v2, 16, v22
    v_and_b32 v3, 0xffff0000, v22
    v_fmac_f32 v140, v2, v46
    v_fmac_f32 v141, v3, v46
    v_lshlrev_b32 v2, 16, v23
    v_and_b32 v3, 0xffff0000, v23
    v_fmac_f32 v142, v2, v46
    v_fmac_f32 v143, v3, v46
    v_lshlrev_b32 v2, 16, v24
    v_and_b32 v3, 0xffff0000, v24
    v_fmac_f32 v136, v2, v47
    v_fmac_f32 v137, v3, v47
    v_lshlrev_b32 v2, 16, v25
    v_and_b32 v3, 0xffff0000, v25
    v_fmac_f32 v138, v2, v47
    v_fmac_f32 v139, v3, v47
    v_lshlrev_b32 v2, 16, v26
    v_and_b32 v3, 0xffff0000, v26
    v_fmac_f32 v140, v2, v47
    v_fmac_f32 v141, v3, v47
    v_lshlrev_b32 v2, 16, v27
    v_and_b32 v3, 0xffff0000, v27
    v_fmac_f32 v142, v2, v47
    v_fmac_f32 v143, v3, v47
    v_lshlrev_b32 v2, 16, v28
    v_and_b32 v3, 0xffff0000, v28
    v_fmac_f32 v136, v2, v48
    v_fmac_f32 v137, v3, v48
    v_lshlrev_b32 v2, 16, v29
    v_and_b32 v3, 0xffff0000, v29
    v_fmac_f32 v138, v2, v48
    v_fmac_f32 v139, v3, v48
    v_lshlrev_b32 v2, 16, v30
    v_and_b32 v3, 0xffff0000, v30
    v_fmac_f32 v140, v2, v48
    v_fmac_f32 v141, v3, v48
    v_lshlrev_b32 v2, 16, v31
    v_and_b32 v3, 0xffff0000, v31
    v_fmac_f32 v142, v2, v48
    v_fmac_f32 v143, v3, v48
    v_lshlrev_b32 v2, 16, v32
    v_and_b32 v3, 0xffff0000, v32
    v_fmac_f32 v136, v2, v49
    v_fmac_f32 v137, v3, v49
    v_lshlrev_b32 v2, 16, v33
    v_and_b32 v3, 0xffff0000, v33
    v_fmac_f32 v138, v2, v49
    v_fmac_f32 v139, v3, v49
    v_lshlrev_b32 v2, 16, v34
    v_and_b32 v3, 0xffff0000, v34
    v_fmac_f32 v140, v2, v49
    v_fmac_f32 v141, v3, v49
    v_lshlrev_b32 v2, 16, v35
    v_and_b32 v3, 0xffff0000, v35
    v_fmac_f32 v142, v2, v49
    v_fmac_f32 v143, v3, v49
    v_lshlrev_b32 v2, 16, v36
    v_and_b32 v3, 0xffff0000, v36
    v_fmac_f32 v136, v2, v50
    v_fmac_f32 v137, v3, v50
    v_lshlrev_b32 v2, 16, v37
    v_and_b32 v3, 0xffff0000, v37
    v_fmac_f32 v138, v2, v50
    v_fmac_f32 v139, v3, v50
    v_lshlrev_b32 v2, 16, v38
    v_and_b32 v3, 0xffff0000, v38
    v_fmac_f32 v140, v2, v50
    v_fmac_f32 v141, v3, v50
    v_lshlrev_b32 v2, 16, v39
    v_and_b32 v3, 0xffff0000, v39
    v_fmac_f32 v142, v2, v50
    v_fmac_f32 v143, v3, v50
    v_lshlrev_b32 v2, 16, v40
    v_and_b32 v3, 0xffff0000, v40
    v_fmac_f32 v136, v2, v51
    v_fmac_f32 v137, v3, v51
    v_lshlrev_b32 v2, 16, v41
    v_and_b32 v3, 0xffff0000, v41
    v_fmac_f32 v138, v2, v51
    v_fmac_f32 v139, v3, v51
    v_lshlrev_b32 v2, 16, v42
    v_and_b32 v3, 0xffff0000, v42
    v_fmac_f32 v140, v2, v51
    v_fmac_f32 v141, v3, v51
    v_lshlrev_b32 v2, 16, v43
    v_and_b32 v3, 0xffff0000, v43
    v_fmac_f32 v142, v2, v51
    v_fmac_f32 v143, v3, v51
    s_nop 1
    v_permlane32_swap_b32 v136, v140
    v_permlane32_swap_b32 v137, v141
    v_permlane32_swap_b32 v138, v142
    v_permlane32_swap_b32 v139, v143
    v_add_f32 v136, v136, v140
    v_add_f32 v137, v137, v141
    v_add_f32 v138, v138, v142
    v_add_f32 v139, v139, v143
    s_nop 1
    v_permlane16_swap_b32 v136, v138
    v_permlane16_swap_b32 v137, v139
    v_add_f32 v136, v136, v138
    v_add_f32 v137, v137, v139
    s_nop 1
    v_add_f32_dpp v136, v136, v136 row_ror:8 row_mask:0xf bank_mask:0xf
    v_add_f32_dpp v137, v137, v137 row_ror:8 row_mask:0xf bank_mask:0xf
    v_and_b32 v2, 7, v1
    v_lshlrev_b32 v2, 5, v2
    v_lshrrev_b32 v3, 5, v1
    v_lshl_add_u32 v2, v3, 4, v2
    v_bfe_u32 v3, v1, 4, 1
    v_lshl_add_u32 v2, v3, 3, v2
    s_lshl_b32 s37, s32, 8
    s_add_u32 s37, s37, 512
    v_add_u32 v2, s37, v2
    ds_write_b64 v2, v[136:137]
    s_add_u32 s32, s32, 1
    v_mov_b32 v2, 1
    v_mov_b32 v3, 3588
    s_waitcnt lgkmcnt(0)
    s_mov_b64 exec, 1
    ds_add_rtn_u32 v2, v3, v2
    s_waitcnt lgkmcnt(0)
    s_mov_b64 exec, -1
    v_readfirstlane_b32 s40, v2
    s_cmp_lg_u32 s40, 1
    s_cbranch_scc1 Lp0b
    s_mul_i32 s37, s60, 5120
    s_lshl_b32 s38, s61, 1
    s_add_u32 s37, s37, s38
    s_add_u32 s39, s37, 0x50000
    v_lshlrev_b32 v2, 2, v1
    v_add_u32 v3, 512, v2
    ds_read2st64_b32 v[136:137], v3 offset0:0 offset1:1
    s_waitcnt lgkmcnt(0)
    v_add_f32 v136, v136, v137
    buffer_store_dword v136, v2, s[28:31], s39 offen sc1
    s_waitcnt vmcnt(0)
    s_mul_i32 s37, s2, 128
    s_add_u32 s37, s37, 65536
    v_mov_b32 v2, s35
    v_mov_b32 v3, 0
    s_mov_b64 s[44:45], exec
    s_mov_b64 exec, 1
    buffer_store_dword v2, v3, s[28:31], s37 offen sc1
    s_mov_b64 exec, s[44:45]
    s_branch Lp0b
Lg1a:
    s_barrier
    s_getpc_b64 s[40:41]
Lpc:
    s_lshr_b32 s37, s2, 3
    s_sub_u32 s37, s37, 13
    s_lshl_b32 s37, s37, 1
    s_add_u32 s37, s37, s32
    s_max_i32 s37, s37, 0
    s_lshl_b32 s37, s37, 11
    v_lshl_add_u32 v2, v1, 4, s37
    v_min_u32 v2, Lcode_end-Lpc-2048, v2
    global_load_dwordx4 v[104:107], v2, s[40:41]
    global_load_dwordx4 v[108:111], v2, s[40:41] offset:1024
    s_waitcnt lgkmcnt(0)
    s_mul_i32 s35, s35, 0x9E3779B1
    s_add_u32 s35, s35, 0x7F4A7C15
    s_branch Lp0b
Lp0:
    s_mul_i32 s60, s34, 163840
    s_add_u32 s60, s60, 0x100000
    s_lshl_b32 s62, s32, 4
    s_add_u32 s62, s62, s33
    s_sub_u32 s62, s62, 48
    s_cmp_ge_u32 s62, 40
    s_cbranch_scc1 Lw0
    v_and_b32 v2, 15, v1
    v_min_u32 v2, 14, v2
    v_mul_u32_u24 v3, 52, v2
    v_lshrrev_b32 v3, 8, v3
    v_mul_u32_u24 v3, 1200, v3
    v_lshl_add_u32 v2, v2, 4, v3
    v_lshrrev_b32 v3, 4, v1
    v_mul_u32_u24 v3, 3840, v3
    s_mul_i32 s37, s62, 61440
    s_mul_i32 s38, s34, 80
    s_add_u32 s37, s37, s38
    v_add3_u32 v2, v2, v3, s37
    s_lshl_b32 s63, s32, 13
    s_add_u32 s63, s63, 10240
    s_mov_b32 m0, s63
    s_nop 0
    global_load_lds_dwordx4 v2, s[6:7]
    v_add_u32 v2, 15360, v2
    s_add_u32 m0, m0, 1024
    s_nop 0
    s_barrier
    global_load_lds_dwordx4 v2, s[6:7]
    v_add_u32 v2, 15360, v2
    s_add_u32 m0, m0, 1024
    s_nop 0
    global_load_lds_dwordx4 v2, s[6:7]
    v_add_u32 v2, 15360, v2
    s_add_u32 m0, m0, 1024
    s_nop 0
    global_load_lds_dwordx4 v2, s[6:7]
    v_lshrrev_b32 v2, 5, v1
    v_lshlrev_b32 v2, 3, v2
    v_bfe_u32 v3, v1, 2, 2
    v_add_u32 v2, v2, v3
    v_lshl_add_u32 v2, v2, 8, s63
    v_bfe_u32 v3, v1, 4, 1
    v_and_b32 v4, 3, v1
    v_mul_u32_u24 v5, 80, v3
    v_lshl_add_u32 v5, v4, 3, v5
    v_add_u32 v5, v5, v2
    v_lshl_add_u32 v3, v3, 2, v4
    v_or_b32 v3, 0x0c0c0c00, v3
    s_mov_b32 s38, 0x4040e18
    v_mov_b32 v4, 0x17151614
    v_perm_b32 v3, s38, v4, v3
    v_lshl_add_u32 v3, v3, 3, v2
    s_cmp_ge_u32 s62, 20
    s_cselect_b32 s38, 20, 0
    s_cselect_b32 s39, 8192, 0
    s_cselect_b32 s40, 0, 81920
    s_sub_u32 s38, s62, s38
    s_add_u32 s37, s60, s39
    s_lshr_b32 s39, s38, 2
    s_lshl_b32 s39, s39, 14
    s_add_u32 s37, s37, s39
    s_and_b32 s38, s38, 3
    s_lshl_b32 s38, s38, 11
    s_add_u32 s37, s37, s38
    s_add_u32 s64, s37, s40
    s_sub_u32 s40, 81920, s40
    s_add_u32 s65, s37, s40
    v_lshlrev_b32 v2, 4, v1
    s_waitcnt lgkmcnt(0)
    s_mul_i32 s35, s35, 0x9E3779B1
    s_add_u32 s35, s35, 0x7F4A7C15
    s_waitcnt vmcnt(0)
    ds_read_b64_tr_b16 v[12:13], v5 offset:0
    ds_read_b64_tr_b16 v[14:15], v5 offset:1024
    ds_read_b64_tr_b16 v[16:17], v3 offset:0
    ds_read_b64_tr_b16 v[18:19], v3 offset:1024
    ds_read_b64_tr_b16 v[20:21], v5 offset:40
    ds_read_b64_tr_b16 v[22:23], v5 offset:1064
    ds_read_b64_tr_b16 v[24:25], v3 offset:40
    ds_read_b64_tr_b16 v[26:27], v3 offset:1064
    s_waitcnt lgkmcnt(6)
    buffer_store_dwordx4 v[12:15], v2, s[28:31], s64 offen offset:0 sc1
    s_waitcnt lgkmcnt(4)
    buffer_store_dwordx4 v[16:19], v2, s[28:31], s64 offen offset:1024 sc1
    s_waitcnt lgkmcnt(2)
    buffer_store_dwordx4 v[20:23], v2, s[28:31], s65 offen offset:0 sc1
    s_waitcnt lgkmcnt(0)
    buffer_store_dwordx4 v[24:27], v2, s[28:31], s65 offen offset:1024 sc1
    s_waitcnt vmcnt(0)
    s_branch Lw1
Lw0:
    s_barrier
    s_waitcnt lgkmcnt(0)
    s_mul_i32 s35, s35, 0x9E3779B1
    s_add_u32 s35, s35, 0x7F4A7C15
    s_cmp_ge_u32 s32, 6
    s_cbranch_scc1 Lp0b
Lw1:
    v_mov_b32 v2, 1
    v_mov_b32 v3, 3600
    s_waitcnt lgkmcnt(0)
    s_mov_b64 exec, 1
    ds_add_rtn_u32 v2, v3, v2
    s_waitcnt lgkmcnt(0)
    s_mov_b64 exec, -1
    v_readfirstlane_b32 s40, v2
    s_cmp_lg_u32 s40, 2
    s_cbranch_scc1 Lp0b
    s_mul_i32 s37, s36, 128
    s_add_u32 s37, s37, 458752
    v_mov_b32 v2, s35
    v_mov_b32 v3, 0
    s_mov_b64 s[44:45], exec
    s_mov_b64 exec, 1
    buffer_store_dword v2, v3, s[28:31], s37 offen sc1
    s_mov_b64 exec, s[44:45]
Lp0b:
    s_mul_i32 s60, s34, 163840
    s_add_u32 s60, s60, 0x100000
    v_lshlrev_b32 v8, 4, v1
    v_lshlrev_b32 v10, 4, v0
    s_lshr_b32 s37, s32, 2
    s_mul_i32 s37, s37, 20
    s_and_b32 s38, s32, 3
    s_lshl_b32 s40, s33, 2
    s_add_u32 s40, s40, s38
    s_mul_i32 s40, s40, 40
    s_add_u32 s40, s40, s37
    s_lshl_b32 s63, s40, 10
    s_add_u32 s63, s63, 0x2100000
    s_lshl_b32 s61, s32, 11
    s_add_u32 s60, s60, s61
    s_add_u32 s61, s61, 10240
    s_barrier
    s_cmp_lg_u32 s32, 4
    s_cbranch_scc1 Lpr
    s_setprio 3
Lpr:
    v_cmp_gt_u32 vcc, 320, v0
    s_and_saveexec_b64 s[44:45], vcc
    s_cbranch_execz Lmp1
    s_mov_b32 s37, 0x50000
    buffer_load_dwordx4 v[200:203], v10, s[28:31], s37 offen sc1
    s_add_u32 s37, s37, 5120
    buffer_load_dwordx4 v[204:207], v10, s[28:31], s37 offen sc1
    s_add_u32 s37, s37, 5120
    buffer_load_dwordx4 v[208:211], v10, s[28:31], s37 offen sc1
    s_add_u32 s37, s37, 5120
    buffer_load_dwordx4 v[212:215], v10, s[28:31], s37 offen sc1
    s_add_u32 s37, s37, 5120
    buffer_load_dwordx4 v[216:219], v10, s[28:31], s37 offen sc1
Lmp1:
    s_mov_b64 exec, s[44:45]
    s_add_u32 s37, s60, 0
    s_add_u32 m0, s61, 0
    s_nop 0
    buffer_load_dwordx4 v8, s[28:31], s37 offen offset:0 sc1 lds
    buffer_load_dwordx4 v8, s[28:31], s37 offen offset:1024 sc1 lds
    buffer_load_dwordx4 v[12:15], v8, s[28:31], s63 offen offset:0 sc1
    buffer_load_dwordx4 v[16:19], v8, s[28:31], s63 offen offset:1024 sc1
    buffer_load_dwordx4 v[20:23], v8, s[28:31], s63 offen offset:2048 sc1
    buffer_load_dwordx4 v[24:27], v8, s[28:31], s63 offen offset:3072 sc1
    s_lshr_b32 s37, s32, 2
    s_lshl_b32 s37, s37, 13
    s_add_u32 s37, s37, 10240
    v_add_u32 v120, s37, v8
    s_add_u32 s37, s37, 65536
    v_add_u32 v121, s37, v8
    s_add_u32 s37, s37, 65536
    v_add_u32 v122, s37, v8
    s_add_u32 s37, s37, 65536
    v_cmp_gt_u32 vcc, 320, v0
    s_and_saveexec_b64 s[44:45], vcc
    s_cbranch_execz Lmp2
    s_waitcnt vmcnt(6)
    v_add_f32 v200, v200, v204
    v_add_f32 v208, v208, v212
    v_add_f32 v200, v200, v216
    v_add_f32 v200, v200, v208
    v_add_f32 v201, v201, v205
    v_add_f32 v209, v209, v213
    v_add_f32 v201, v201, v217
    v_add_f32 v201, v201, v209
    v_add_f32 v202, v202, v206
    v_add_f32 v210, v210, v214
    v_add_f32 v202, v202, v218
    v_add_f32 v202, v202, v210
    v_add_f32 v203, v203, v207
    v_add_f32 v211, v211, v215
    v_add_f32 v203, v203, v219
    v_add_f32 v203, v203, v211
    v_cmp_le_u32 vcc, 160, v0
    v_mov_b32 v4, 1.0
    s_nop 0
    v_cndmask_b32 v4, 0, v4, vcc
    v_cvt_pk_bf16_f32 v2, v200, v201
    v_lshlrev_b32 v200, 16, v2
    v_and_b32 v201, 0xffff0000, v2
    v_add_f32 v200, v200, v4
    v_add_f32 v201, v201, v4
    v_cvt_pk_bf16_f32 v2, v200, v201
    v_lshlrev_b32 v200, 16, v2
    v_and_b32 v201, 0xffff0000, v2
    v_cvt_pk_bf16_f32 v2, v202, v203
    v_lshlrev_b32 v202, 16, v2
    v_and_b32 v203, 0xffff0000, v2
    v_add_f32 v202, v202, v4
    v_add_f32 v203, v203, v4
    v_cvt_pk_bf16_f32 v2, v202, v203
    v_lshlrev_b32 v202, 16, v2
    v_and_b32 v203, 0xffff0000, v2
    v_add_u32 v2, 6656, v10
    v_add_u32 v3, 1536, v10
    v_cndmask_b32 v2, v2, v3, vcc
    ds_write_b128 v2, v[200:203]
Lmp2:
    s_mov_b64 exec, s[44:45]
    s_waitcnt vmcnt(4)
    s_waitcnt lgkmcnt(0)
    s_barrier
    v_bfe_u32 v2, v1, 3, 1
    v_lshlrev_b32 v2, 4, v2
    v_lshrrev_b32 v3, 5, v1
    v_lshl_add_u32 v2, v3, 3, v2
    v_and_b32 v4, 7, v1
    v_add_u32 v2, v2, v4
    s_lshr_b32 s37, s32, 2
    s_mul_i32 s38, s37, 1280
    s_add_u32 s38, s38, 4096
    v_lshl_add_u32 v2, v2, 2, s38
    ds_read_b32 v92, v2 offset:0
    ds_read_b32 v93, v2 offset:128
    ds_read_b32 v94, v2 offset:256
    ds_read_b32 v95, v2 offset:384
    ds_read_b32 v96, v2 offset:512
    ds_read_b32 v97, v2 offset:640
    ds_read_b32 v98, v2 offset:768
    ds_read_b32 v99, v2 offset:896
    ds_read_b32 v100, v2 offset:1024
    ds_read_b32 v101, v2 offset:1152
    s_add_u32 s38, s38, 2560
    v_lshl_add_u32 v10, v3, 5, s38
    ds_read_b128 v[104:107], v10 offset:0
    ds_read_b128 v[108:111], v10 offset:16
    ds_read_b128 v[112:115], v10 offset:64
    ds_read_b128 v[116:119], v10 offset:80
    ds_read_b128 v[200:203], v120 offset:0
    ds_read_b128 v[204:207], v120 offset:1024
    ds_read_b128 v[208:211], v120 offset:2048
    ds_read_b128 v[212:215], v120 offset:3072
    s_add_u32 s37, s60, 16384
    s_add_u32 m0, s61, 16384
    s_nop 0
    buffer_load_dwordx4 v8, s[28:31], s37 offen offset:0 sc1 lds
    buffer_load_dwordx4 v8, s[28:31], s37 offen offset:1024 sc1 lds
    s_add_u32 s63, s63, 4096
    buffer_load_dwordx4 v[28:31], v8, s[28:31], s63 offen offset:0 sc1
    buffer_load_dwordx4 v[32:35], v8, s[28:31], s63 offen offset:1024 sc1
    buffer_load_dwordx4 v[36:39], v8, s[28:31], s63 offen offset:2048 sc1
    buffer_load_dwordx4 v[40:43], v8, s[28:31], s63 offen offset:3072 sc1
    s_waitcnt vmcnt(9)
    v_lshlrev_b32 v2, 16, v12
    v_and_b32 v3, 0xffff0000, v12
    v_lshlrev_b32 v4, 16, v13
    v_and_b32 v5, 0xffff0000, v13
    s_waitcnt lgkmcnt(7)
    v_fmac_f32_dpp v104, v92, v2 row_newbcast:0 row_mask:0xf bank_mask:0xf
    v_fmac_f32_dpp v105, v92, v3 row_newbcast:1 row_mask:0xf bank_mask:0xf
    v_fmac_f32_dpp v106, v92, v4 row_newbcast:2 row_mask:0xf bank_mask:0xf
    v_fmac_f32_dpp v107, v92, v5 row_newbcast:3 row_mask:0xf bank_mask:0xf
    v_cvt_pk_bf16_f32 v12, v104, v105
    v_cvt_pk_bf16_f32 v13, v106, v107
    v_lshlrev_b32 v2, 16, v14
    v_and_b32 v3, 0xffff0000, v14
    v_lshlrev_b32 v4, 16, v15
    v_and_b32 v5, 0xffff0000, v15
    s_waitcnt lgkmcnt(6)
    v_fmac_f32_dpp v108, v92, v2 row_newbcast:4 row_mask:0xf bank_mask:0xf
    v_fmac_f32_dpp v109, v92, v3 row_newbcast:5 row_mask:0xf bank_mask:0xf
    v_fmac_f32_dpp v110, v92, v4 row_newbcast:6 row_mask:0xf bank_mask:0xf
    v_fmac_f32_dpp v111, v92, v5 row_newbcast:7 row_mask:0xf bank_mask:0xf
    v_cvt_pk_bf16_f32 v14, v108, v109
    v_cvt_pk_bf16_f32 v15, v110, v111
    s_nop 0
    s_setprio 3
    s_waitcnt lgkmcnt(3)
    v_mfma_f32_32x32x16_bf16 v[168:183], v[200:203], v[12:15], 0
    ds_read_b128 v[216:219], v120 offset:4096
    s_waitcnt vmcnt(8)
    v_lshlrev_b32 v2, 16, v16
    v_and_b32 v3, 0xffff0000, v16
    v_lshlrev_b32 v4, 16, v17
    v_and_b32 v5, 0xffff0000, v17
    v_fmac_f32_dpp v112, v92, v2 row_newbcast:8 row_mask:0xf bank_mask:0xf
    v_fmac_f32_dpp v113, v92, v3 row_newbcast:9 row_mask:0xf bank_mask:0xf
    v_fmac_f32_dpp v114, v92, v4 row_newbcast:10 row_mask:0xf bank_mask:0xf
    v_fmac_f32_dpp v115, v92, v5 row_newbcast:11 row_mask:0xf bank_mask:0xf
    v_cvt_pk_bf16_f32 v16, v112, v113
    v_cvt_pk_bf16_f32 v17, v114, v115
    ds_read_b128 v[104:107], v10 offset:128
    s_add_u32 s63, s63, 4096
    buffer_load_dwordx4 v[44:47], v8, s[28:31], s63 offen offset:0 sc1
    s_waitcnt lgkmcnt(4)
    v_mfma_f32_32x32x16_bf16 v[184:199], v[204:207], v[12:15], 0
    v_lshlrev_b32 v2, 16, v18
    v_and_b32 v3, 0xffff0000, v18
    v_lshlrev_b32 v4, 16, v19
    v_and_b32 v5, 0xffff0000, v19
    v_fmac_f32_dpp v116, v92, v2 row_newbcast:12 row_mask:0xf bank_mask:0xf
    v_fmac_f32_dpp v117, v92, v3 row_newbcast:13 row_mask:0xf bank_mask:0xf
    v_fmac_f32_dpp v118, v92, v4 row_newbcast:14 row_mask:0xf bank_mask:0xf
    v_fmac_f32_dpp v119, v92, v5 row_newbcast:15 row_mask:0xf bank_mask:0xf
    v_cvt_pk_bf16_f32 v18, v116, v117
    v_cvt_pk_bf16_f32 v19, v118, v119
    ds_read_b128 v[220:223], v120 offset:5120
    ds_read_b128 v[108:111], v10 offset:144
    buffer_load_dwordx4 v[48:51], v8, s[28:31], s63 offen offset:1024 sc1
    s_waitcnt lgkmcnt(5)
    v_mfma_f32_32x32x16_bf16 v[168:183], v[208:211], v[16:19], v[168:183]
    ds_read_b128 v[200:203], v120 offset:6144
    s_waitcnt vmcnt(9)
    v_lshlrev_b32 v2, 16, v20
    v_and_b32 v3, 0xffff0000, v20
    v_lshlrev_b32 v4, 16, v21
    v_and_b32 v5, 0xffff0000, v21
    s_waitcnt lgkmcnt(3)
    v_fmac_f32_dpp v104, v93, v2 row_newbcast:0 row_mask:0xf bank_mask:0xf
    v_fmac_f32_dpp v105, v93, v3 row_newbcast:1 row_mask:0xf bank_mask:0xf
    v_fmac_f32_dpp v106, v93, v4 row_newbcast:2 row_mask:0xf bank_mask:0xf
    v_fmac_f32_dpp v107, v93, v5 row_newbcast:3 row_mask:0xf bank_mask:0xf
    v_cvt_pk_bf16_f32 v20, v104, v105
    v_cvt_pk_bf16_f32 v21, v106, v107
    ds_read_b128 v[112:115], v10 offset:192
    buffer_load_dwordx4 v[52:55], v8, s[28:31], s63 offen offset:2048 sc1
    v_mfma_f32_32x32x16_bf16 v[184:199], v[212:215], v[16:19], v[184:199]
    v_lshlrev_b32 v2, 16, v22
    v_and_b32 v3, 0xffff0000, v22
    v_lshlrev_b32 v4, 16, v23
    v_and_b32 v5, 0xffff0000, v23
    s_waitcnt lgkmcnt(2)
    v_fmac_f32_dpp v108, v93, v2 row_newbcast:4 row_mask:0xf bank_mask:0xf
    v_fmac_f32_dpp v109, v93, v3 row_newbcast:5 row_mask:0xf bank_mask:0xf
    v_fmac_f32_dpp v110, v93, v4 row_newbcast:6 row_mask:0xf bank_mask:0xf
    v_fmac_f32_dpp v111, v93, v5 row_newbcast:7 row_mask:0xf bank_mask:0xf
    v_cvt_pk_bf16_f32 v22, v108, v109
    v_cvt_pk_bf16_f32 v23, v110, v111
    ds_read_b128 v[204:207], v120 offset:7168
    ds_read_b128 v[116:119], v10 offset:208
    buffer_load_dwordx4 v[56:59], v8, s[28:31], s63 offen offset:3072 sc1
    s_waitcnt vmcnt(8)
    s_barrier
    v_mfma_f32_32x32x16_bf16 v[168:183], v[216:219], v[20:23], v[168:183]
    ds_read_b128 v[208:211], v120 offset:16384
    v_lshlrev_b32 v2, 16, v24
    v_and_b32 v3, 0xffff0000, v24
    v_lshlrev_b32 v4, 16, v25
    v_and_b32 v5, 0xffff0000, v25
    s_waitcnt lgkmcnt(3)
    v_fmac_f32_dpp v112, v93, v2 row_newbcast:8 row_mask:0xf bank_mask:0xf
    v_fmac_f32_dpp v113, v93, v3 row_newbcast:9 row_mask:0xf bank_mask:0xf
    v_fmac_f32_dpp v114, v93, v4 row_newbcast:10 row_mask:0xf bank_mask:0xf
    v_fmac_f32_dpp v115, v93, v5 row_newbcast:11 row_mask:0xf bank_mask:0xf
    v_cvt_pk_bf16_f32 v24, v112, v113
    v_cvt_pk_bf16_f32 v25, v114, v115
    ds_read_b128 v[104:107], v10 offset:256
    s_add_u32 s37, s60, 32768
    s_add_u32 m0, s61, 32768
    s_nop 0
    buffer_load_dwordx4 v8, s[28:31], s37 offen offset:0 sc1 lds
    buffer_load_dwordx4 v8, s[28:31], s37 offen offset:1024 sc1 lds
    v_mfma_f32_32x32x16_bf16 v[184:199], v[220:223], v[20:23], v[184:199]
    v_lshlrev_b32 v2, 16, v26
    v_and_b32 v3, 0xffff0000, v26
    v_lshlrev_b32 v4, 16, v27
    v_and_b32 v5, 0xffff0000, v27
    s_waitcnt lgkmcnt(2)
    v_fmac_f32_dpp v116, v93, v2 row_newbcast:12 row_mask:0xf bank_mask:0xf
    v_fmac_f32_dpp v117, v93, v3 row_newbcast:13 row_mask:0xf bank_mask:0xf
    v_fmac_f32_dpp v118, v93, v4 row_newbcast:14 row_mask:0xf bank_mask:0xf
    v_fmac_f32_dpp v119, v93, v5 row_newbcast:15 row_mask:0xf bank_mask:0xf
    v_cvt_pk_bf16_f32 v26, v116, v117
    v_cvt_pk_bf16_f32 v27, v118, v119
    ds_read_b128 v[212:215], v120 offset:17408
    ds_read_b128 v[108:111], v10 offset:272
    v_mfma_f32_32x32x16_bf16 v[168:183], v[200:203], v[24:27], v[168:183]
    ds_read_b128 v[216:219], v120 offset:18432
    s_waitcnt vmcnt(9)
    v_lshlrev_b32 v2, 16, v28
    v_and_b32 v3, 0xffff0000, v28
    v_lshlrev_b32 v4, 16, v29
    v_and_b32 v5, 0xffff0000, v29
    s_waitcnt lgkmcnt(3)
    v_fmac_f32_dpp v104, v94, v2 row_newbcast:0 row_mask:0xf bank_mask:0xf
    v_fmac_f32_dpp v105, v94, v3 row_newbcast:1 row_mask:0xf bank_mask:0xf
    v_fmac_f32_dpp v106, v94, v4 row_newbcast:2 row_mask:0xf bank_mask:0xf
    v_fmac_f32_dpp v107, v94, v5 row_newbcast:3 row_mask:0xf bank_mask:0xf
    v_cvt_pk_bf16_f32 v28, v104, v105
    v_cvt_pk_bf16_f32 v29, v106, v107
    ds_read_b128 v[112:115], v10 offset:320
    s_add_u32 s63, s63, 4096
    buffer_load_dwordx4 v[60:63], v8, s[28:31], s63 offen offset:0 sc1
    v_mfma_f32_32x32x16_bf16 v[184:199], v[204:207], v[24:27], v[184:199]
    v_lshlrev_b32 v2, 16, v30
    v_and_b32 v3, 0xffff0000, v30
    v_lshlrev_b32 v4, 16, v31
    v_and_b32 v5, 0xffff0000, v31
    s_waitcnt lgkmcnt(2)
    v_fmac_f32_dpp v108, v94, v2 row_newbcast:4 row_mask:0xf bank_mask:0xf
    v_fmac_f32_dpp v109, v94, v3 row_newbcast:5 row_mask:0xf bank_mask:0xf
    v_fmac_f32_dpp v110, v94, v4 row_newbcast:6 row_mask:0xf bank_mask:0xf
    v_fmac_f32_dpp v111, v94, v5 row_newbcast:7 row_mask:0xf bank_mask:0xf
    v_cvt_pk_bf16_f32 v30, v108, v109
    v_cvt_pk_bf16_f32 v31, v110, v111
    ds_read_b128 v[220:223], v120 offset:19456
    ds_read_b128 v[116:119], v10 offset:336
    buffer_load_dwordx4 v[64:67], v8, s[28:31], s63 offen offset:1024 sc1
    s_setprio 2
    v_mfma_f32_32x32x16_bf16 v[168:183], v[208:211], v[28:31], v[168:183]
    ds_read_b128 v[200:203], v120 offset:20480
    s_waitcnt vmcnt(10)
    v_lshlrev_b32 v2, 16, v32
    v_and_b32 v3, 0xffff0000, v32
    v_lshlrev_b32 v4, 16, v33
    v_and_b32 v5, 0xffff0000, v33
    s_waitcnt lgkmcnt(3)
    v_fmac_f32_dpp v112, v94, v2 row_newbcast:8 row_mask:0xf bank_mask:0xf
    v_fmac_f32_dpp v113, v94, v3 row_newbcast:9 row_mask:0xf bank_mask:0xf
    v_fmac_f32_dpp v114, v94, v4 row_newbcast:10 row_mask:0xf bank_mask:0xf
    v_fmac_f32_dpp v115, v94, v5 row_newbcast:11 row_mask:0xf bank_mask:0xf
    v_cvt_pk_bf16_f32 v32, v112, v113
    v_cvt_pk_bf16_f32 v33, v114, v115
    ds_read_b128 v[104:107], v10 offset:384
    buffer_load_dwordx4 v[68:71], v8, s[28:31], s63 offen offset:2048 sc1
    v_mfma_f32_32x32x16_bf16 v[184:199], v[212:215], v[28:31], v[184:199]
    v_lshlrev_b32 v2, 16, v34
    v_and_b32 v3, 0xffff0000, v34
    v_lshlrev_b32 v4, 16, v35
    v_and_b32 v5, 0xffff0000, v35
    s_waitcnt lgkmcnt(2)
    v_fmac_f32_dpp v116, v94, v2 row_newbcast:12 row_mask:0xf bank_mask:0xf
    v_fmac_f32_dpp v117, v94, v3 row_newbcast:13 row_mask:0xf bank_mask:0xf
    v_fmac_f32_dpp v118, v94, v4 row_newbcast:14 row_mask:0xf bank_mask:0xf
    v_fmac_f32_dpp v119, v94, v5 row_newbcast:15 row_mask:0xf bank_mask:0xf
    v_cvt_pk_bf16_f32 v34, v116, v117
    v_cvt_pk_bf16_f32 v35, v118, v119
    ds_read_b128 v[204:207], v120 offset:21504
    ds_read_b128 v[108:111], v10 offset:400
    buffer_load_dwordx4 v[72:75], v8, s[28:31], s63 offen offset:3072 sc1
    v_mfma_f32_32x32x16_bf16 v[168:183], v[216:219], v[32:35], v[168:183]
    ds_read_b128 v[208:211], v120 offset:22528
    s_waitcnt vmcnt(11)
    v_lshlrev_b32 v2, 16, v36
    v_and_b32 v3, 0xffff0000, v36
    v_lshlrev_b32 v4, 16, v37
    v_and_b32 v5, 0xffff0000, v37
    s_waitcnt lgkmcnt(3)
    v_fmac_f32_dpp v104, v95, v2 row_newbcast:0 row_mask:0xf bank_mask:0xf
    v_fmac_f32_dpp v105, v95, v3 row_newbcast:1 row_mask:0xf bank_mask:0xf
    v_fmac_f32_dpp v106, v95, v4 row_newbcast:2 row_mask:0xf bank_mask:0xf
    v_fmac_f32_dpp v107, v95, v5 row_newbcast:3 row_mask:0xf bank_mask:0xf
    v_cvt_pk_bf16_f32 v36, v104, v105
    v_cvt_pk_bf16_f32 v37, v106, v107
    ds_read_b128 v[112:115], v10 offset:448
    s_add_u32 s37, s60, 49152
    s_add_u32 m0, s61, 49152
    s_nop 0
    buffer_load_dwordx4 v8, s[28:31], s37 offen offset:0 sc1 lds
    buffer_load_dwordx4 v8, s[28:31], s37 offen offset:1024 sc1 lds
    v_mfma_f32_32x32x16_bf16 v[184:199], v[220:223], v[32:35], v[184:199]
    v_lshlrev_b32 v2, 16, v38
    v_and_b32 v3, 0xffff0000, v38
    v_lshlrev_b32 v4, 16, v39
    v_and_b32 v5, 0xffff0000, v39
    s_waitcnt lgkmcnt(2)
    v_fmac_f32_dpp v108, v95, v2 row_newbcast:4 row_mask:0xf bank_mask:0xf
    v_fmac_f32_dpp v109, v95, v3 row_newbcast:5 row_mask:0xf bank_mask:0xf
    v_fmac_f32_dpp v110, v95, v4 row_newbcast:6 row_mask:0xf bank_mask:0xf
    v_fmac_f32_dpp v111, v95, v5 row_newbcast:7 row_mask:0xf bank_mask:0xf
    v_cvt_pk_bf16_f32 v38, v108, v109
    v_cvt_pk_bf16_f32 v39, v110, v111
    ds_read_b128 v[212:215], v120 offset:23552
    ds_read_b128 v[116:119], v10 offset:464
    s_waitcnt vmcnt(6)
    s_barrier
    v_mfma_f32_32x32x16_bf16 v[168:183], v[200:203], v[36:39], v[168:183]
    ds_read_b128 v[216:219], v120 offset:32768
    v_lshlrev_b32 v2, 16, v40
    v_and_b32 v3, 0xffff0000, v40
    v_lshlrev_b32 v4, 16, v41
    v_and_b32 v5, 0xffff0000, v41
    s_waitcnt lgkmcnt(3)
    v_fmac_f32_dpp v112, v95, v2 row_newbcast:8 row_mask:0xf bank_mask:0xf
    v_fmac_f32_dpp v113, v95, v3 row_newbcast:9 row_mask:0xf bank_mask:0xf
    v_fmac_f32_dpp v114, v95, v4 row_newbcast:10 row_mask:0xf bank_mask:0xf
    v_fmac_f32_dpp v115, v95, v5 row_newbcast:11 row_mask:0xf bank_mask:0xf
    v_cvt_pk_bf16_f32 v40, v112, v113
    v_cvt_pk_bf16_f32 v41, v114, v115
    ds_read_b128 v[104:107], v10 offset:512
    s_add_u32 s63, s63, 4096
    buffer_load_dwordx4 v[76:79], v8, s[28:31], s63 offen offset:0 sc1
    v_mfma_f32_32x32x16_bf16 v[184:199], v[204:207], v[36:39], v[184:199]
    v_lshlrev_b32 v2, 16, v42
    v_and_b32 v3, 0xffff0000, v42
    v_lshlrev_b32 v4, 16, v43
    v_and_b32 v5, 0xffff0000, v43
    s_waitcnt lgkmcnt(2)
    v_fmac_f32_dpp v116, v95, v2 row_newbcast:12 row_mask:0xf bank_mask:0xf
    v_fmac_f32_dpp v117, v95, v3 row_newbcast:13 row_mask:0xf bank_mask:0xf
    v_fmac_f32_dpp v118, v95, v4 row_newbcast:14 row_mask:0xf bank_mask:0xf
    v_fmac_f32_dpp v119, v95, v5 row_newbcast:15 row_mask:0xf bank_mask:0xf
    v_cvt_pk_bf16_f32 v42, v116, v117
    v_cvt_pk_bf16_f32 v43, v118, v119
    ds_read_b128 v[220:223], v120 offset:33792
    ds_read_b128 v[108:111], v10 offset:528
    buffer_load_dwordx4 v[80:83], v8, s[28:31], s63 offen offset:1024 sc1
    v_mfma_f32_32x32x16_bf16 v[168:183], v[208:211], v[40:43], v[168:183]
    ds_read_b128 v[200:203], v120 offset:34816
    v_lshlrev_b32 v2, 16, v44
    v_and_b32 v3, 0xffff0000, v44
    v_lshlrev_b32 v4, 16, v45
    v_and_b32 v5, 0xffff0000, v45
    s_waitcnt lgkmcnt(3)
    v_fmac_f32_dpp v104, v96, v2 row_newbcast:0 row_mask:0xf bank_mask:0xf
    v_fmac_f32_dpp v105, v96, v3 row_newbcast:1 row_mask:0xf bank_mask:0xf
    v_fmac_f32_dpp v106, v96, v4 row_newbcast:2 row_mask:0xf bank_mask:0xf
    v_fmac_f32_dpp v107, v96, v5 row_newbcast:3 row_mask:0xf bank_mask:0xf
    v_cvt_pk_bf16_f32 v44, v104, v105
    v_cvt_pk_bf16_f32 v45, v106, v107
    ds_read_b128 v[112:115], v10 offset:576
    buffer_load_dwordx4 v[84:87], v8, s[28:31], s63 offen offset:2048 sc1
    v_mfma_f32_32x32x16_bf16 v[184:199], v[212:215], v[40:43], v[184:199]
    v_lshlrev_b32 v2, 16, v46
    v_and_b32 v3, 0xffff0000, v46
    v_lshlrev_b32 v4, 16, v47
    v_and_b32 v5, 0xffff0000, v47
    s_waitcnt lgkmcnt(2)
    v_fmac_f32_dpp v108, v96, v2 row_newbcast:4 row_mask:0xf bank_mask:0xf
    v_fmac_f32_dpp v109, v96, v3 row_newbcast:5 row_mask:0xf bank_mask:0xf
    v_fmac_f32_dpp v110, v96, v4 row_newbcast:6 row_mask:0xf bank_mask:0xf
    v_fmac_f32_dpp v111, v96, v5 row_newbcast:7 row_mask:0xf bank_mask:0xf
    v_cvt_pk_bf16_f32 v46, v108, v109
    v_cvt_pk_bf16_f32 v47, v110, v111
    ds_read_b128 v[204:207], v120 offset:35840
    ds_read_b128 v[116:119], v10 offset:592
    buffer_load_dwordx4 v[88:91], v8, s[28:31], s63 offen offset:3072 sc1
    s_setprio 1
    v_mfma_f32_32x32x16_bf16 v[168:183], v[216:219], v[44:47], v[168:183]
    ds_read_b128 v[208:211], v120 offset:36864
    v_lshlrev_b32 v2, 16, v48
    v_and_b32 v3, 0xffff0000, v48
    v_lshlrev_b32 v4, 16, v49
    v_and_b32 v5, 0xffff0000, v49
    s_waitcnt lgkmcnt(3)
    v_fmac_f32_dpp v112, v96, v2 row_newbcast:8 row_mask:0xf bank_mask:0xf
    v_fmac_f32_dpp v113, v96, v3 row_newbcast:9 row_mask:0xf bank_mask:0xf
    v_fmac_f32_dpp v114, v96, v4 row_newbcast:10 row_mask:0xf bank_mask:0xf
    v_fmac_f32_dpp v115, v96, v5 row_newbcast:11 row_mask:0xf bank_mask:0xf
    v_cvt_pk_bf16_f32 v48, v112, v113
    v_cvt_pk_bf16_f32 v49, v114, v115
    ds_read_b128 v[104:107], v10 offset:640
    s_add_u32 s37, s60, 65536
    s_add_u32 m0, s61, 65536
    s_nop 0
    buffer_load_dwordx4 v8, s[28:31], s37 offen offset:0 sc1 lds
    buffer_load_dwordx4 v8, s[28:31], s37 offen offset:1024 sc1 lds
    v_mfma_f32_32x32x16_bf16 v[184:199], v[220:223], v[44:47], v[184:199]
    v_lshlrev_b32 v2, 16, v50
    v_and_b32 v3, 0xffff0000, v50
    v_lshlrev_b32 v4, 16, v51
    v_and_b32 v5, 0xffff0000, v51
    s_waitcnt lgkmcnt(2)
    v_fmac_f32_dpp v116, v96, v2 row_newbcast:12 row_mask:0xf bank_mask:0xf
    v_fmac_f32_dpp v117, v96, v3 row_newbcast:13 row_mask:0xf bank_mask:0xf
    v_fmac_f32_dpp v118, v96, v4 row_newbcast:14 row_mask:0xf bank_mask:0xf
    v_fmac_f32_dpp v119, v96, v5 row_newbcast:15 row_mask:0xf bank_mask:0xf
    v_cvt_pk_bf16_f32 v50, v116, v117
    v_cvt_pk_bf16_f32 v51, v118, v119
    ds_read_b128 v[212:215], v120 offset:37888
    ds_read_b128 v[108:111], v10 offset:656
    v_mfma_f32_32x32x16_bf16 v[168:183], v[200:203], v[48:51], v[168:183]
    ds_read_b128 v[216:219], v120 offset:38912
    v_lshlrev_b32 v2, 16, v52
    v_and_b32 v3, 0xffff0000, v52
    v_lshlrev_b32 v4, 16, v53
    v_and_b32 v5, 0xffff0000, v53
    s_waitcnt lgkmcnt(3)
    v_fmac_f32_dpp v104, v97, v2 row_newbcast:0 row_mask:0xf bank_mask:0xf
    v_fmac_f32_dpp v105, v97, v3 row_newbcast:1 row_mask:0xf bank_mask:0xf
    v_fmac_f32_dpp v106, v97, v4 row_newbcast:2 row_mask:0xf bank_mask:0xf
    v_fmac_f32_dpp v107, v97, v5 row_newbcast:3 row_mask:0xf bank_mask:0xf
    v_cvt_pk_bf16_f32 v52, v104, v105
    v_cvt_pk_bf16_f32 v53, v106, v107
    ds_read_b128 v[112:115], v10 offset:704
    v_mfma_f32_32x32x16_bf16 v[184:199], v[204:207], v[48:51], v[184:199]
    v_lshlrev_b32 v2, 16, v54
    v_and_b32 v3, 0xffff0000, v54
    v_lshlrev_b32 v4, 16, v55
    v_and_b32 v5, 0xffff0000, v55
    s_waitcnt lgkmcnt(2)
    v_fmac_f32_dpp v108, v97, v2 row_newbcast:4 row_mask:0xf bank_mask:0xf
    v_fmac_f32_dpp v109, v97, v3 row_newbcast:5 row_mask:0xf bank_mask:0xf
    v_fmac_f32_dpp v110, v97, v4 row_newbcast:6 row_mask:0xf bank_mask:0xf
    v_fmac_f32_dpp v111, v97, v5 row_newbcast:7 row_mask:0xf bank_mask:0xf
    v_cvt_pk_bf16_f32 v54, v108, v109
    v_cvt_pk_bf16_f32 v55, v110, v111
    ds_read_b128 v[220:223], v120 offset:39936
    ds_read_b128 v[116:119], v10 offset:720
    s_waitcnt vmcnt(6)
    s_barrier
    v_mfma_f32_32x32x16_bf16 v[168:183], v[208:211], v[52:55], v[168:183]
    ds_read_b128 v[200:203], v120 offset:49152
    v_lshlrev_b32 v2, 16, v56
    v_and_b32 v3, 0xffff0000, v56
    v_lshlrev_b32 v4, 16, v57
    v_and_b32 v5, 0xffff0000, v57
    s_waitcnt lgkmcnt(3)
    v_fmac_f32_dpp v112, v97, v2 row_newbcast:8 row_mask:0xf bank_mask:0xf
    v_fmac_f32_dpp v113, v97, v3 row_newbcast:9 row_mask:0xf bank_mask:0xf
    v_fmac_f32_dpp v114, v97, v4 row_newbcast:10 row_mask:0xf bank_mask:0xf
    v_fmac_f32_dpp v115, v97, v5 row_newbcast:11 row_mask:0xf bank_mask:0xf
    v_cvt_pk_bf16_f32 v56, v112, v113
    v_cvt_pk_bf16_f32 v57, v114, v115
    ds_read_b128 v[104:107], v10 offset:768
    s_add_u32 s37, s60, 81920
    s_add_u32 m0, s61, 81920
    s_nop 0
    buffer_load_dwordx4 v8, s[28:31], s37 offen offset:0 sc1 lds
    buffer_load_dwordx4 v8, s[28:31], s37 offen offset:1024 sc1 lds
    v_mfma_f32_32x32x16_bf16 v[184:199], v[212:215], v[52:55], v[184:199]
    v_lshlrev_b32 v2, 16, v58
    v_and_b32 v3, 0xffff0000, v58
    v_lshlrev_b32 v4, 16, v59
    v_and_b32 v5, 0xffff0000, v59
    s_waitcnt lgkmcnt(2)
    v_fmac_f32_dpp v116, v97, v2 row_newbcast:12 row_mask:0xf bank_mask:0xf
    v_fmac_f32_dpp v117, v97, v3 row_newbcast:13 row_mask:0xf bank_mask:0xf
    v_fmac_f32_dpp v118, v97, v4 row_newbcast:14 row_mask:0xf bank_mask:0xf
    v_fmac_f32_dpp v119, v97, v5 row_newbcast:15 row_mask:0xf bank_mask:0xf
    v_cvt_pk_bf16_f32 v58, v116, v117
    v_cvt_pk_bf16_f32 v59, v118, v119
    ds_read_b128 v[204:207], v120 offset:50176
    ds_read_b128 v[108:111], v10 offset:784
    v_mfma_f32_32x32x16_bf16 v[168:183], v[216:219], v[56:59], v[168:183]
    ds_read_b128 v[208:211], v120 offset:51200
    v_lshlrev_b32 v2, 16, v60
    v_and_b32 v3, 0xffff0000, v60
    v_lshlrev_b32 v4, 16, v61
    v_and_b32 v5, 0xffff0000, v61
    s_waitcnt lgkmcnt(3)
    v_fmac_f32_dpp v104, v98, v2 row_newbcast:0 row_mask:0xf bank_mask:0xf
    v_fmac_f32_dpp v105, v98, v3 row_newbcast:1 row_mask:0xf bank_mask:0xf
    v_fmac_f32_dpp v106, v98, v4 row_newbcast:2 row_mask:0xf bank_mask:0xf
    v_fmac_f32_dpp v107, v98, v5 row_newbcast:3 row_mask:0xf bank_mask:0xf
    v_cvt_pk_bf16_f32 v60, v104, v105
    v_cvt_pk_bf16_f32 v61, v106, v107
    ds_read_b128 v[112:115], v10 offset:832
    v_mfma_f32_32x32x16_bf16 v[184:199], v[220:223], v[56:59], v[184:199]
    v_lshlrev_b32 v2, 16, v62
    v_and_b32 v3, 0xffff0000, v62
    v_lshlrev_b32 v4, 16, v63
    v_and_b32 v5, 0xffff0000, v63
    s_waitcnt lgkmcnt(2)
    v_fmac_f32_dpp v108, v98, v2 row_newbcast:4 row_mask:0xf bank_mask:0xf
    v_fmac_f32_dpp v109, v98, v3 row_newbcast:5 row_mask:0xf bank_mask:0xf
    v_fmac_f32_dpp v110, v98, v4 row_newbcast:6 row_mask:0xf bank_mask:0xf
    v_fmac_f32_dpp v111, v98, v5 row_newbcast:7 row_mask:0xf bank_mask:0xf
    v_cvt_pk_bf16_f32 v62, v108, v109
    v_cvt_pk_bf16_f32 v63, v110, v111
    ds_read_b128 v[212:215], v120 offset:52224
    ds_read_b128 v[116:119], v10 offset:848
    s_setprio 0
    v_mfma_f32_32x32x16_bf16 v[168:183], v[200:203], v[60:63], v[168:183]
    ds_read_b128 v[216:219], v120 offset:53248
    v_lshlrev_b32 v2, 16, v64
    v_and_b32 v3, 0xffff0000, v64
    v_lshlrev_b32 v4, 16, v65
    v_and_b32 v5, 0xffff0000, v65
    s_waitcnt lgkmcnt(3)
    v_fmac_f32_dpp v112, v98, v2 row_newbcast:8 row_mask:0xf bank_mask:0xf
    v_fmac_f32_dpp v113, v98, v3 row_newbcast:9 row_mask:0xf bank_mask:0xf
    v_fmac_f32_dpp v114, v98, v4 row_newbcast:10 row_mask:0xf bank_mask:0xf
    v_fmac_f32_dpp v115, v98, v5 row_newbcast:11 row_mask:0xf bank_mask:0xf
    v_cvt_pk_bf16_f32 v64, v112, v113
    v_cvt_pk_bf16_f32 v65, v114, v115
    ds_read_b128 v[104:107], v10 offset:896
    s_add_u32 s37, s60, 98304
    s_add_u32 m0, s61, 98304
    s_nop 0
    buffer_load_dwordx4 v8, s[28:31], s37 offen offset:0 sc1 lds
    buffer_load_dwordx4 v8, s[28:31], s37 offen offset:1024 sc1 lds
    v_mfma_f32_32x32x16_bf16 v[184:199], v[204:207], v[60:63], v[184:199]
    v_lshlrev_b32 v2, 16, v66
    v_and_b32 v3, 0xffff0000, v66
    v_lshlrev_b32 v4, 16, v67
    v_and_b32 v5, 0xffff0000, v67
    s_waitcnt lgkmcnt(2)
    v_fmac_f32_dpp v116, v98, v2 row_newbcast:12 row_mask:0xf bank_mask:0xf
    v_fmac_f32_dpp v117, v98, v3 row_newbcast:13 row_mask:0xf bank_mask:0xf
    v_fmac_f32_dpp v118, v98, v4 row_newbcast:14 row_mask:0xf bank_mask:0xf
    v_fmac_f32_dpp v119, v98, v5 row_newbcast:15 row_mask:0xf bank_mask:0xf
    v_cvt_pk_bf16_f32 v66, v116, v117
    v_cvt_pk_bf16_f32 v67, v118, v119
    ds_read_b128 v[220:223], v120 offset:54272
    ds_read_b128 v[108:111], v10 offset:912
    v_mfma_f32_32x32x16_bf16 v[168:183], v[208:211], v[64:67], v[168:183]
    ds_read_b128 v[200:203], v120 offset:55296
    v_lshlrev_b32 v2, 16, v68
    v_and_b32 v3, 0xffff0000, v68
    v_lshlrev_b32 v4, 16, v69
    v_and_b32 v5, 0xffff0000, v69
    s_waitcnt lgkmcnt(3)
    v_fmac_f32_dpp v104, v99, v2 row_newbcast:0 row_mask:0xf bank_mask:0xf
    v_fmac_f32_dpp v105, v99, v3 row_newbcast:1 row_mask:0xf bank_mask:0xf
    v_fmac_f32_dpp v106, v99, v4 row_newbcast:2 row_mask:0xf bank_mask:0xf
    v_fmac_f32_dpp v107, v99, v5 row_newbcast:3 row_mask:0xf bank_mask:0xf
    v_cvt_pk_bf16_f32 v68, v104, v105
    v_cvt_pk_bf16_f32 v69, v106, v107
    ds_read_b128 v[112:115], v10 offset:960
    v_mfma_f32_32x32x16_bf16 v[184:199], v[212:215], v[64:67], v[184:199]
    v_lshlrev_b32 v2, 16, v70
    v_and_b32 v3, 0xffff0000, v70
    v_lshlrev_b32 v4, 16, v71
    v_and_b32 v5, 0xffff0000, v71
    s_waitcnt lgkmcnt(2)
    v_fmac_f32_dpp v108, v99, v2 row_newbcast:4 row_mask:0xf bank_mask:0xf
    v_fmac_f32_dpp v109, v99, v3 row_newbcast:5 row_mask:0xf bank_mask:0xf
    v_fmac_f32_dpp v110, v99, v4 row_newbcast:6 row_mask:0xf bank_mask:0xf
    v_fmac_f32_dpp v111, v99, v5 row_newbcast:7 row_mask:0xf bank_mask:0xf
    v_cvt_pk_bf16_f32 v70, v108, v109
    v_cvt_pk_bf16_f32 v71, v110, v111
    ds_read_b128 v[204:207], v120 offset:56320
    ds_read_b128 v[116:119], v10 offset:976
    s_waitcnt vmcnt(4)
    s_barrier
    v_mfma_f32_32x32x16_bf16 v[168:183], v[216:219], v[68:71], v[168:183]
    ds_read_b128 v[208:211], v121 offset:0
    v_lshlrev_b32 v2, 16, v72
    v_and_b32 v3, 0xffff0000, v72
    v_lshlrev_b32 v4, 16, v73
    v_and_b32 v5, 0xffff0000, v73
    s_waitcnt lgkmcnt(3)
    v_fmac_f32_dpp v112, v99, v2 row_newbcast:8 row_mask:0xf bank_mask:0xf
    v_fmac_f32_dpp v113, v99, v3 row_newbcast:9 row_mask:0xf bank_mask:0xf
    v_fmac_f32_dpp v114, v99, v4 row_newbcast:10 row_mask:0xf bank_mask:0xf
    v_fmac_f32_dpp v115, v99, v5 row_newbcast:11 row_mask:0xf bank_mask:0xf
    v_cvt_pk_bf16_f32 v72, v112, v113
    v_cvt_pk_bf16_f32 v73, v114, v115
    ds_read_b128 v[104:107], v10 offset:1024
    s_add_u32 s37, s60, 114688
    s_add_u32 m0, s61, 114688
    s_nop 0
    buffer_load_dwordx4 v8, s[28:31], s37 offen offset:0 sc1 lds
    buffer_load_dwordx4 v8, s[28:31], s37 offen offset:1024 sc1 lds
    v_mfma_f32_32x32x16_bf16 v[184:199], v[220:223], v[68:71], v[184:199]
    v_lshlrev_b32 v2, 16, v74
    v_and_b32 v3, 0xffff0000, v74
    v_lshlrev_b32 v4, 16, v75
    v_and_b32 v5, 0xffff0000, v75
    s_waitcnt lgkmcnt(2)
    v_fmac_f32_dpp v116, v99, v2 row_newbcast:12 row_mask:0xf bank_mask:0xf
    v_fmac_f32_dpp v117, v99, v3 row_newbcast:13 row_mask:0xf bank_mask:0xf
    v_fmac_f32_dpp v118, v99, v4 row_newbcast:14 row_mask:0xf bank_mask:0xf
    v_fmac_f32_dpp v119, v99, v5 row_newbcast:15 row_mask:0xf bank_mask:0xf
    v_cvt_pk_bf16_f32 v74, v116, v117
    v_cvt_pk_bf16_f32 v75, v118, v119
    ds_read_b128 v[212:215], v121 offset:1024
    ds_read_b128 v[108:111], v10 offset:1040
    v_mfma_f32_32x32x16_bf16 v[168:183], v[200:203], v[72:75], v[168:183]
    ds_read_b128 v[216:219], v121 offset:2048
    v_lshlrev_b32 v2, 16, v76
    v_and_b32 v3, 0xffff0000, v76
    v_lshlrev_b32 v4, 16, v77
    v_and_b32 v5, 0xffff0000, v77
    s_waitcnt lgkmcnt(3)
    v_fmac_f32_dpp v104, v100, v2 row_newbcast:0 row_mask:0xf bank_mask:0xf
    v_fmac_f32_dpp v105, v100, v3 row_newbcast:1 row_mask:0xf bank_mask:0xf
    v_fmac_f32_dpp v106, v100, v4 row_newbcast:2 row_mask:0xf bank_mask:0xf
    v_fmac_f32_dpp v107, v100, v5 row_newbcast:3 row_mask:0xf bank_mask:0xf
    v_cvt_pk_bf16_f32 v76, v104, v105
    v_cvt_pk_bf16_f32 v77, v106, v107
    ds_read_b128 v[112:115], v10 offset:1088
    v_mfma_f32_32x32x16_bf16 v[184:199], v[204:207], v[72:75], v[184:199]
    v_lshlrev_b32 v2, 16, v78
    v_and_b32 v3, 0xffff0000, v78
    v_lshlrev_b32 v4, 16, v79
    v_and_b32 v5, 0xffff0000, v79
    s_waitcnt lgkmcnt(2)
    v_fmac_f32_dpp v108, v100, v2 row_newbcast:4 row_mask:0xf bank_mask:0xf
    v_fmac_f32_dpp v109, v100, v3 row_newbcast:5 row_mask:0xf bank_mask:0xf
    v_fmac_f32_dpp v110, v100, v4 row_newbcast:6 row_mask:0xf bank_mask:0xf
    v_fmac_f32_dpp v111, v100, v5 row_newbcast:7 row_mask:0xf bank_mask:0xf
    v_cvt_pk_bf16_f32 v78, v108, v109
    v_cvt_pk_bf16_f32 v79, v110, v111
    ds_read_b128 v[220:223], v121 offset:3072
    ds_read_b128 v[116:119], v10 offset:1104
    s_setprio 3
    v_mfma_f32_32x32x16_bf16 v[168:183], v[208:211], v[76:79], v[168:183]
    ds_read_b128 v[200:203], v121 offset:4096
    v_lshlrev_b32 v2, 16, v80
    v_and_b32 v3, 0xffff0000, v80
    v_lshlrev_b32 v4, 16, v81
    v_and_b32 v5, 0xffff0000, v81
    s_waitcnt lgkmcnt(3)
    v_fmac_f32_dpp v112, v100, v2 row_newbcast:8 row_mask:0xf bank_mask:0xf
    v_fmac_f32_dpp v113, v100, v3 row_newbcast:9 row_mask:0xf bank_mask:0xf
    v_fmac_f32_dpp v114, v100, v4 row_newbcast:10 row_mask:0xf bank_mask:0xf
    v_fmac_f32_dpp v115, v100, v5 row_newbcast:11 row_mask:0xf bank_mask:0xf
    v_cvt_pk_bf16_f32 v80, v112, v113
    v_cvt_pk_bf16_f32 v81, v114, v115
    ds_read_b128 v[104:107], v10 offset:1152
    s_add_u32 s37, s60, 131072
    s_add_u32 m0, s61, 131072
    s_nop 0
    buffer_load_dwordx4 v8, s[28:31], s37 offen offset:0 sc1 lds
    buffer_load_dwordx4 v8, s[28:31], s37 offen offset:1024 sc1 lds
    v_mfma_f32_32x32x16_bf16 v[184:199], v[212:215], v[76:79], v[184:199]
    v_lshlrev_b32 v2, 16, v82
    v_and_b32 v3, 0xffff0000, v82
    v_lshlrev_b32 v4, 16, v83
    v_and_b32 v5, 0xffff0000, v83
    s_waitcnt lgkmcnt(2)
    v_fmac_f32_dpp v116, v100, v2 row_newbcast:12 row_mask:0xf bank_mask:0xf
    v_fmac_f32_dpp v117, v100, v3 row_newbcast:13 row_mask:0xf bank_mask:0xf
    v_fmac_f32_dpp v118, v100, v4 row_newbcast:14 row_mask:0xf bank_mask:0xf
    v_fmac_f32_dpp v119, v100, v5 row_newbcast:15 row_mask:0xf bank_mask:0xf
    v_cvt_pk_bf16_f32 v82, v116, v117
    v_cvt_pk_bf16_f32 v83, v118, v119
    ds_read_b128 v[204:207], v121 offset:5120
    ds_read_b128 v[108:111], v10 offset:1168
    v_mfma_f32_32x32x16_bf16 v[168:183], v[216:219], v[80:83], v[168:183]
    ds_read_b128 v[208:211], v121 offset:6144
    v_lshlrev_b32 v2, 16, v84
    v_and_b32 v3, 0xffff0000, v84
    v_lshlrev_b32 v4, 16, v85
    v_and_b32 v5, 0xffff0000, v85
    s_waitcnt lgkmcnt(3)
    v_fmac_f32_dpp v104, v101, v2 row_newbcast:0 row_mask:0xf bank_mask:0xf
    v_fmac_f32_dpp v105, v101, v3 row_newbcast:1 row_mask:0xf bank_mask:0xf
    v_fmac_f32_dpp v106, v101, v4 row_newbcast:2 row_mask:0xf bank_mask:0xf
    v_fmac_f32_dpp v107, v101, v5 row_newbcast:3 row_mask:0xf bank_mask:0xf
    v_cvt_pk_bf16_f32 v84, v104, v105
    v_cvt_pk_bf16_f32 v85, v106, v107
    ds_read_b128 v[112:115], v10 offset:1216
    v_mfma_f32_32x32x16_bf16 v[184:199], v[220:223], v[80:83], v[184:199]
    v_lshlrev_b32 v2, 16, v86
    v_and_b32 v3, 0xffff0000, v86
    v_lshlrev_b32 v4, 16, v87
    v_and_b32 v5, 0xffff0000, v87
    s_waitcnt lgkmcnt(2)
    v_fmac_f32_dpp v108, v101, v2 row_newbcast:4 row_mask:0xf bank_mask:0xf
    v_fmac_f32_dpp v109, v101, v3 row_newbcast:5 row_mask:0xf bank_mask:0xf
    v_fmac_f32_dpp v110, v101, v4 row_newbcast:6 row_mask:0xf bank_mask:0xf
    v_fmac_f32_dpp v111, v101, v5 row_newbcast:7 row_mask:0xf bank_mask:0xf
    v_cvt_pk_bf16_f32 v86, v108, v109
    v_cvt_pk_bf16_f32 v87, v110, v111
    ds_read_b128 v[212:215], v121 offset:7168
    ds_read_b128 v[116:119], v10 offset:1232
    s_nop 0
    s_waitcnt vmcnt(4)
    s_barrier
    v_mfma_f32_32x32x16_bf16 v[168:183], v[200:203], v[84:87], v[168:183]
    ds_read_b128 v[216:219], v121 offset:16384
    v_lshlrev_b32 v2, 16, v88
    v_and_b32 v3, 0xffff0000, v88
    v_lshlrev_b32 v4, 16, v89
    v_and_b32 v5, 0xffff0000, v89
    s_waitcnt lgkmcnt(3)
    v_fmac_f32_dpp v112, v101, v2 row_newbcast:8 row_mask:0xf bank_mask:0xf
    v_fmac_f32_dpp v113, v101, v3 row_newbcast:9 row_mask:0xf bank_mask:0xf
    v_fmac_f32_dpp v114, v101, v4 row_newbcast:10 row_mask:0xf bank_mask:0xf
    v_fmac_f32_dpp v115, v101, v5 row_newbcast:11 row_mask:0xf bank_mask:0xf
    v_cvt_pk_bf16_f32 v88, v112, v113
    v_cvt_pk_bf16_f32 v89, v114, v115
    s_add_u32 s37, s60, 147456
    s_add_u32 m0, s61, 0
    s_nop 0
    buffer_load_dwordx4 v8, s[28:31], s37 offen offset:0 sc1 lds
    buffer_load_dwordx4 v8, s[28:31], s37 offen offset:1024 sc1 lds
    v_mfma_f32_32x32x16_bf16 v[184:199], v[204:207], v[84:87], v[184:199]
    v_lshlrev_b32 v2, 16, v90
    v_and_b32 v3, 0xffff0000, v90
    v_lshlrev_b32 v4, 16, v91
    v_and_b32 v5, 0xffff0000, v91
    s_waitcnt lgkmcnt(1)
    v_fmac_f32_dpp v116, v101, v2 row_newbcast:12 row_mask:0xf bank_mask:0xf
    v_fmac_f32_dpp v117, v101, v3 row_newbcast:13 row_mask:0xf bank_mask:0xf
    v_fmac_f32_dpp v118, v101, v4 row_newbcast:14 row_mask:0xf bank_mask:0xf
    v_fmac_f32_dpp v119, v101, v5 row_newbcast:15 row_mask:0xf bank_mask:0xf
    v_cvt_pk_bf16_f32 v90, v116, v117
    v_cvt_pk_bf16_f32 v91, v118, v119
    ds_read_b128 v[220:223], v121 offset:17408
    s_nop 0
    v_mfma_f32_32x32x16_bf16 v[168:183], v[208:211], v[88:91], v[168:183]
    ds_read_b128 v[200:203], v121 offset:18432
    v_mfma_f32_32x32x16_bf16 v[184:199], v[212:215], v[88:91], v[184:199]
    ds_read_b128 v[204:207], v121 offset:19456
    s_setprio 2
    s_waitcnt lgkmcnt(3)
    v_mfma_f32_32x32x16_bf16 v[136:151], v[216:219], v[12:15], 0
    ds_read_b128 v[208:211], v121 offset:20480
    s_waitcnt lgkmcnt(3)
    v_mfma_f32_32x32x16_bf16 v[152:167], v[220:223], v[12:15], 0
    ds_read_b128 v[212:215], v121 offset:21504
    s_waitcnt lgkmcnt(3)
    v_mfma_f32_32x32x16_bf16 v[136:151], v[200:203], v[16:19], v[136:151]
    ds_read_b128 v[216:219], v121 offset:22528
    s_waitcnt lgkmcnt(3)
    v_mfma_f32_32x32x16_bf16 v[152:167], v[204:207], v[16:19], v[152:167]
    ds_read_b128 v[220:223], v121 offset:23552
    s_lshl_b32 s37, s32, 13
    s_add_u32 s38, s37, 26624
    v_add_u32 v10, s38, v8
    s_xor_b32 s37, s37, 32768
    s_add_u32 s37, s37, 26624
    v_add_u32 v11, s37, v8
    s_waitcnt lgkmcnt(3)
    v_mfma_f32_32x32x16_bf16 v[136:151], v[208:211], v[20:23], v[136:151]
    ds_read_b128 v[200:203], v121 offset:32768
    s_waitcnt lgkmcnt(3)
    v_mfma_f32_32x32x16_bf16 v[152:167], v[212:215], v[20:23], v[152:167]
    ds_read_b128 v[204:207], v121 offset:33792
    s_waitcnt lgkmcnt(3)
    v_mfma_f32_32x32x16_bf16 v[136:151], v[216:219], v[24:27], v[136:151]
    ds_read_b128 v[208:211], v121 offset:34816
    s_waitcnt lgkmcnt(3)
    v_mfma_f32_32x32x16_bf16 v[152:167], v[220:223], v[24:27], v[152:167]
    ds_read_b128 v[212:215], v121 offset:35840
    s_setprio 1
    s_waitcnt lgkmcnt(3)
    v_mfma_f32_32x32x16_bf16 v[136:151], v[200:203], v[28:31], v[136:151]
    ds_read_b128 v[216:219], v121 offset:36864
    s_waitcnt lgkmcnt(3)
    v_mfma_f32_32x32x16_bf16 v[152:167], v[204:207], v[28:31], v[152:167]
    ds_read_b128 v[220:223], v121 offset:37888
    s_waitcnt lgkmcnt(3)
    v_mfma_f32_32x32x16_bf16 v[136:151], v[208:211], v[32:35], v[136:151]
    ds_read_b128 v[200:203], v121 offset:38912
    s_waitcnt lgkmcnt(3)
    v_mfma_f32_32x32x16_bf16 v[152:167], v[212:215], v[32:35], v[152:167]
    ds_read_b128 v[204:207], v121 offset:39936
    s_waitcnt vmcnt(0)
    s_barrier
    s_waitcnt lgkmcnt(3)
    v_mfma_f32_32x32x16_bf16 v[136:151], v[216:219], v[36:39], v[136:151]
    ds_read_b128 v[208:211], v121 offset:49152
    s_waitcnt lgkmcnt(3)
    v_mfma_f32_32x32x16_bf16 v[152:167], v[220:223], v[36:39], v[152:167]
    ds_read_b128 v[212:215], v121 offset:50176
    s_waitcnt lgkmcnt(3)
    v_mfma_f32_32x32x16_bf16 v[136:151], v[200:203], v[40:43], v[136:151]
    ds_read_b128 v[216:219], v121 offset:51200
    s_waitcnt lgkmcnt(3)
    v_mfma_f32_32x32x16_bf16 v[152:167], v[204:207], v[40:43], v[152:167]
    ds_read_b128 v[220:223], v121 offset:52224
    s_min_u32 s39, s2, 199
    s_mul_i32 s40, s39, 1639
    s_lshr_b32 s40, s40, 16
    s_mul_i32 s37, s40, 40
    s_sub_u32 s39, s39, s37
    s_mul_i32 s67, s40, 10240
    s_lshl_b32 s37, s39, 8
    s_add_u32 s67, s67, s37
    s_add_u32 s67, s67, 0x60000
    s_lshl_b32 s39, s39, 7
    s_add_u32 s39, s39, 2560
    s_lshl_b32 s37, s40, 7
    s_mul_i32 s38, s32, 16
    s_add_u32 s37, s37, s38
    v_lshrrev_b32 v128, 3, v1
    v_add_u32 v128, s37, v128
    v_lshlrev_b32 v129, 1, v128
    v_mul_u32_u24 v128, 7680, v128
    v_and_b32 v130, 7, v1
    v_lshlrev_b32 v130, 4, v130
    v_add3_u32 v128, v128, v130, s39
    global_load_dwordx4 v[244:247], v128, s[20:21]
    v_add_u32 v128, 61440, v128
    global_load_dwordx4 v[248:251], v128, s[20:21]
    global_load_ushort v252, v129, s[18:19] offset:0
    global_load_ushort v253, v129, s[18:19] offset:16
    ds_write_b128 v10, v[168:171] offset:0
    s_setprio 0
    s_waitcnt lgkmcnt(4)
    v_mfma_f32_32x32x16_bf16 v[136:151], v[208:211], v[44:47], v[136:151]
    ds_read_b128 v[200:203], v121 offset:53248
    s_waitcnt lgkmcnt(4)
    v_mfma_f32_32x32x16_bf16 v[152:167], v[212:215], v[44:47], v[152:167]
    ds_read_b128 v[204:207], v121 offset:54272
    ds_write_b128 v10, v[172:175] offset:1024
    s_waitcnt lgkmcnt(5)
    v_mfma_f32_32x32x16_bf16 v[136:151], v[216:219], v[48:51], v[136:151]
    ds_read_b128 v[208:211], v121 offset:55296
    s_waitcnt lgkmcnt(5)
    v_mfma_f32_32x32x16_bf16 v[152:167], v[220:223], v[48:51], v[152:167]
    ds_read_b128 v[212:215], v121 offset:56320
    ds_write_b128 v10, v[176:179] offset:2048
    s_waitcnt lgkmcnt(5)
    v_mfma_f32_32x32x16_bf16 v[136:151], v[200:203], v[52:55], v[136:151]
    ds_read_b128 v[216:219], v122 offset:0
    s_waitcnt lgkmcnt(5)
    v_mfma_f32_32x32x16_bf16 v[152:167], v[204:207], v[52:55], v[152:167]
    ds_read_b128 v[220:223], v122 offset:1024
    ds_write_b128 v10, v[180:183] offset:3072
    s_waitcnt lgkmcnt(5)
    v_mfma_f32_32x32x16_bf16 v[136:151], v[208:211], v[56:59], v[136:151]
    ds_read_b128 v[200:203], v122 offset:2048
    s_waitcnt lgkmcnt(5)
    v_mfma_f32_32x32x16_bf16 v[152:167], v[212:215], v[56:59], v[152:167]
    ds_read_b128 v[204:207], v122 offset:3072
    ds_write_b128 v10, v[184:187] offset:4096
    s_setprio 3
    s_waitcnt lgkmcnt(5)
    v_mfma_f32_32x32x16_bf16 v[136:151], v[216:219], v[60:63], v[136:151]
    ds_read_b128 v[208:211], v122 offset:4096
    s_waitcnt lgkmcnt(5)
    v_mfma_f32_32x32x16_bf16 v[152:167], v[220:223], v[60:63], v[152:167]
    ds_read_b128 v[212:215], v122 offset:5120
    ds_write_b128 v10, v[188:191] offset:5120
    s_waitcnt lgkmcnt(5)
    v_mfma_f32_32x32x16_bf16 v[136:151], v[200:203], v[64:67], v[136:151]
    ds_read_b128 v[216:219], v122 offset:6144
    s_waitcnt lgkmcnt(5)
    v_mfma_f32_32x32x16_bf16 v[152:167], v[204:207], v[64:67], v[152:167]
    ds_read_b128 v[220:223], v122 offset:7168
    ds_write_b128 v10, v[192:195] offset:6144
    s_waitcnt lgkmcnt(5)
    v_mfma_f32_32x32x16_bf16 v[136:151], v[208:211], v[68:71], v[136:151]
    ds_read_b128 v[200:203], v120 offset:0
    s_waitcnt lgkmcnt(5)
    v_mfma_f32_32x32x16_bf16 v[152:167], v[212:215], v[68:71], v[152:167]
    ds_read_b128 v[204:207], v120 offset:1024
    ds_write_b128 v10, v[196:199] offset:7168
    s_waitcnt lgkmcnt(5)
    v_mfma_f32_32x32x16_bf16 v[136:151], v[216:219], v[72:75], v[136:151]
    ds_read_b128 v[208:211], v120 offset:2048
    s_waitcnt lgkmcnt(5)
    v_mfma_f32_32x32x16_bf16 v[152:167], v[220:223], v[72:75], v[152:167]
    ds_read_b128 v[212:215], v120 offset:3072
    s_setprio 2
    s_waitcnt lgkmcnt(4)
    v_mfma_f32_32x32x16_bf16 v[136:151], v[200:203], v[76:79], v[136:151]
    ds_read_b128 v[216:219], v120 offset:4096
    s_waitcnt lgkmcnt(4)
    v_mfma_f32_32x32x16_bf16 v[152:167], v[204:207], v[76:79], v[152:167]
    ds_read_b128 v[220:223], v120 offset:5120
    s_waitcnt lgkmcnt(3)
    v_mfma_f32_32x32x16_bf16 v[136:151], v[208:211], v[80:83], v[136:151]
    ds_read_b128 v[200:203], v120 offset:6144
    s_waitcnt lgkmcnt(3)
    v_mfma_f32_32x32x16_bf16 v[152:167], v[212:215], v[80:83], v[152:167]
    ds_read_b128 v[204:207], v120 offset:7168
    s_waitcnt lgkmcnt(3)
    v_mfma_f32_32x32x16_bf16 v[136:151], v[216:219], v[84:87], v[136:151]
    s_waitcnt lgkmcnt(2)
    v_mfma_f32_32x32x16_bf16 v[152:167], v[220:223], v[84:87], v[152:167]
    s_waitcnt lgkmcnt(1)
    v_mfma_f32_32x32x16_bf16 v[136:151], v[200:203], v[88:91], v[136:151]
    s_waitcnt lgkmcnt(0)
    v_mfma_f32_32x32x16_bf16 v[152:167], v[204:207], v[88:91], v[152:167]
    s_setprio 0
    s_lshl_b32 s37, s34, 4
    s_add_u32 s37, s37, s33
    s_mul_i32 s37, s37, 24576
    s_add_u32 s42, s37, 0x400000
    s_add_u32 s60, s37, 0x3e9800
    s_lshr_b32 s38, s32, 2
    s_mul_i32 s38, s38, 11264
    s_add_u32 s41, s38, 92160
    s_and_b32 s38, s32, 3
    s_lshl_b32 s39, s38, 10
    s_add_u32 s39, s39, s41
    s_mul_i32 s38, s38, 1792
    s_add_u32 s38, s38, s41
    s_add_u32 s38, s38, 4096
    v_and_b32 v3, 31, v1
    v_mul_u32_u24 v3, 56, v3
    v_add_u32 v3, s38, v3
    v_lshrrev_b32 v4, 5, v1
    v_lshl_add_u32 v4, v4, 4, v3
    v_lshl_add_u32 v5, v1, 4, s39
    v_lshl_add_u32 v6, v1, 4, s38
    v_mov_b32 v104, 0x3f80
    v_mov_b32 v105, 0
    s_waitcnt lgkmcnt(0)
    s_barrier
    ds_read_b128 v[208:211], v11 offset:2048
    ds_read_b128 v[212:215], v11 offset:3072
    ds_read_b128 v[216:219], v11 offset:4096
    ds_read_b128 v[220:223], v11 offset:5120
    ds_read_b128 v[200:203], v11 offset:6144
    ds_read_b128 v[204:207], v11 offset:7168
    ds_read_b128 v[112:115], v11 offset:0
    ds_read_b128 v[116:119], v11 offset:1024
    s_waitcnt lgkmcnt(7)
    v_add_f32 v144, v144, v208
    v_add_f32 v145, v145, v209
    v_add_f32 v146, v146, v210
    v_add_f32 v147, v147, v211
    s_waitcnt lgkmcnt(6)
    v_add_f32 v148, v148, v212
    v_add_f32 v149, v149, v213
    v_add_f32 v150, v150, v214
    v_add_f32 v151, v151, v215
    s_waitcnt lgkmcnt(5)
    v_add_f32 v152, v152, v216
    v_add_f32 v153, v153, v217
    v_add_f32 v154, v154, v218
    v_add_f32 v155, v155, v219
    s_waitcnt lgkmcnt(4)
    v_add_f32 v156, v156, v220
    v_add_f32 v157, v157, v221
    v_add_f32 v158, v158, v222
    v_add_f32 v159, v159, v223
    s_waitcnt lgkmcnt(3)
    v_add_f32 v160, v160, v200
    v_add_f32 v161, v161, v201
    v_add_f32 v162, v162, v202
    v_add_f32 v163, v163, v203
    v_cvt_pk_bf16_f32 v44, v144, v145
    v_cvt_pk_bf16_f32 v45, v146, v147
    v_cvt_pk_bf16_f32 v46, v148, v149
    v_cvt_pk_bf16_f32 v47, v150, v151
    v_cvt_pk_bf16_f32 v48, v152, v153
    v_cvt_pk_bf16_f32 v49, v154, v155
    v_cvt_pk_bf16_f32 v50, v156, v157
    v_cvt_pk_bf16_f32 v51, v158, v159
    v_cvt_pk_bf16_f32 v52, v160, v161
    v_cvt_pk_bf16_f32 v53, v162, v163
    ds_write2_b64 v4, v[48:49], v[50:51] offset0:0 offset1:1
    ds_write_b64 v4, v[52:53] offset:32
    ds_write_b64 v3, v[104:105] offset:40
    ds_write_b128 v5, v[44:47]
    buffer_store_dwordx4 v[44:47], v5, s[28:31], s60 offen sc1
    s_waitcnt lgkmcnt(1)
    ds_read_b128 v[64:67], v6
    ds_read_b128 v[68:71], v6 offset:1024
    s_waitcnt lgkmcnt(1)
    buffer_store_dwordx4 v[64:67], v6, s[28:31], s60 offen sc1
    s_mov_b32 exec_hi, 0xffff
    s_waitcnt lgkmcnt(0)
    buffer_store_dwordx4 v[68:71], v6, s[28:31], s60 offen offset:1024 sc1
    s_mov_b64 exec, -1
    v_lshlrev_b32 v2, 4, v1
    s_waitcnt lgkmcnt(0)
    v_add_f32 v164, v164, v204
    v_add_f32 v165, v165, v205
    v_add_f32 v166, v166, v206
    v_add_f32 v167, v167, v207
    s_waitcnt lgkmcnt(0)
    v_add_f32 v136, v136, v112
    v_add_f32 v137, v137, v113
    v_add_f32 v138, v138, v114
    v_add_f32 v139, v139, v115
    s_waitcnt lgkmcnt(0)
    v_add_f32 v140, v140, v116
    v_add_f32 v141, v141, v117
    v_add_f32 v142, v142, v118
    v_add_f32 v143, v143, v119
    s_mov_b32 s40, 0x3ea52b5c
    v_mul_f32 v136, s40, v136
    v_mul_f32 v137, s40, v137
    v_mul_f32 v138, s40, v138
    v_mul_f32 v139, s40, v139
    v_mul_f32 v140, s40, v140
    v_mul_f32 v141, s40, v141
    v_mul_f32 v142, s40, v142
    v_mul_f32 v143, s40, v143
    v_mul_f32 v164, s40, v164
    v_mul_f32 v165, s40, v165
    v_mul_f32 v166, s40, v166
    v_mul_f32 v167, s40, v167
    v_cvt_pk_bf16_f32 v56, v136, v137
    v_cvt_pk_bf16_f32 v57, v138, v139
    v_cvt_pk_bf16_f32 v58, v140, v141
    v_cvt_pk_bf16_f32 v59, v142, v143
    v_cvt_pk_bf16_f32 v60, v164, v165
    v_cvt_pk_bf16_f32 v61, v166, v167
    s_lshl_b32 s37, s32, 10
    s_add_u32 s37, s37, 10240
    v_add_u32 v2, s37, v2
    ds_write_b128 v2, v[56:59]
    s_lshl_b32 s37, s32, 8
    s_add_u32 s37, s37, 18432
    v_and_b32 v3, 31, v1
    v_lshl_add_u32 v3, v3, 3, s37
    ds_write_b64 v3, v[60:61]
    s_waitcnt vmcnt(0) lgkmcnt(0)
    s_barrier
    s_mov_b32 s46, s42
    s_cmp_lg_u32 s32, 0
    s_cbranch_scc1 Lf1
    s_mul_i32 s37, s36, 128
    s_add_u32 s37, s37, 98304
    v_mov_b32 v2, s35
    v_mov_b32 v3, 0
    s_mov_b64 s[44:45], exec
    s_mov_b64 exec, 1
    buffer_store_dword v2, v3, s[28:31], s37 offen sc1
    s_mov_b64 exec, s[44:45]
Lf1:
    v_lshlrev_b32 v252, 16, v252
    v_mul_f32 v2, 0xbfb8aa3b, v252
    v_exp_f32 v2, v2
    s_nop 0
    v_add_f32 v2, 1.0, v2
    v_rcp_f32 v2, v2
    s_nop 0
    v_mul_f32 v252, v252, v2
    v_cvt_pk_bf16_f32 v252, v252, v252
    v_and_b32 v252, 0xffff0000, v252
    v_lshlrev_b32 v253, 16, v253
    v_mul_f32 v2, 0xbfb8aa3b, v253
    v_exp_f32 v2, v2
    s_nop 0
    v_add_f32 v2, 1.0, v2
    v_rcp_f32 v2, v2
    s_nop 0
    v_mul_f32 v253, v253, v2
    v_cvt_pk_bf16_f32 v253, v253, v253
    v_and_b32 v253, 0xffff0000, v253
    v_lshlrev_b32 v2, 16, v244
    v_and_b32 v3, 0xffff0000, v244
    v_mul_f32 v136, v2, v252
    v_mul_f32 v137, v3, v252
    v_lshlrev_b32 v2, 16, v245
    v_and_b32 v3, 0xffff0000, v245
    v_mul_f32 v138, v2, v252
    v_mul_f32 v139, v3, v252
    v_lshlrev_b32 v2, 16, v246
    v_and_b32 v3, 0xffff0000, v246
    v_mul_f32 v140, v2, v252
    v_mul_f32 v141, v3, v252
    v_lshlrev_b32 v2, 16, v247
    v_and_b32 v3, 0xffff0000, v247
    v_mul_f32 v142, v2, v252
    v_mul_f32 v143, v3, v252
    v_lshlrev_b32 v2, 16, v248
    v_and_b32 v3, 0xffff0000, v248
    v_fmac_f32 v136, v2, v253
    v_fmac_f32 v137, v3, v253
    v_lshlrev_b32 v2, 16, v249
    v_and_b32 v3, 0xffff0000, v249
    v_fmac_f32 v138, v2, v253
    v_fmac_f32 v139, v3, v253
    v_lshlrev_b32 v2, 16, v250
    v_and_b32 v3, 0xffff0000, v250
    v_fmac_f32 v140, v2, v253
    v_fmac_f32 v141, v3, v253
    v_lshlrev_b32 v2, 16, v251
    v_and_b32 v3, 0xffff0000, v251
    v_fmac_f32 v142, v2, v253
    v_fmac_f32 v143, v3, v253
    s_nop 1
    v_permlane32_swap_b32 v136, v140
    v_permlane32_swap_b32 v137, v141
    v_permlane32_swap_b32 v138, v142
    v_permlane32_swap_b32 v139, v143
    v_add_f32 v136, v136, v140
    v_add_f32 v137, v137, v141
    v_add_f32 v138, v138, v142
    v_add_f32 v139, v139, v143
    s_nop 1
    v_permlane16_swap_b32 v136, v138
    v_permlane16_swap_b32 v137, v139
    v_add_f32 v136, v136, v138
    v_add_f32 v137, v137, v139
    s_nop 1
    v_add_f32_dpp v136, v136, v136 row_ror:8 row_mask:0xf bank_mask:0xf
    v_add_f32_dpp v137, v137, v137 row_ror:8 row_mask:0xf bank_mask:0xf
    v_and_b32 v2, 7, v1
    v_lshlrev_b32 v2, 5, v2
    v_lshrrev_b32 v3, 5, v1
    v_lshl_add_u32 v2, v3, 4, v2
    v_bfe_u32 v3, v1, 4, 1
    v_lshl_add_u32 v2, v3, 3, v2
    s_lshl_b32 s37, s32, 8
    s_add_u32 s37, s37, 512
    v_add_u32 v2, s37, v2
    ds_write_b64 v2, v[136:137]
    s_lshl_b32 s39, s2, 3
    s_add_u32 s39, s39, s32
    v_lshrrev_b32 v236, 3, v1
    v_and_b32 v237, 7, v1
    v_lshlrev_b32 v237, 4, v237
    s_cmp_ge_u32 s39, 1080
    s_cbranch_scc1 Lsj_d
    s_mul_i32 s40, s39, 2428
    s_lshr_b32 s40, s40, 16
    s_mul_i32 s37, s40, 27
    s_sub_u32 s41, s39, s37
    s_mul_i32 s37, s40, 55296
    s_lshl_b32 s38, s41, 7
    s_add_u32 s37, s37, s38
    v_mul_u32_u24 v236, 3456, v236
    v_add3_u32 v236, v236, v237, s37
    s_mov_b64 s[68:69], s[12:13]
    s_mov_b64 s[60:61], s[14:15]
    v_add_u32 v232, 0x0, v236
    v_add_u32 v233, 0x6c00, v236
    v_add_u32 v234, 0x0, v236
    v_add_u32 v235, 0x6c00, v236
    s_mul_i32 s64, s41, 160
    s_add_u32 s64, s64, s40
    s_lshl_b32 s64, s64, 10
    s_add_u32 s64, s64, 0x1b00000
    s_mov_b32 s65, 40960
    s_mov_b32 s66, 0
    s_branch Lsj_e
Lsj_d:
    s_cmp_ge_u32 s39, 1620
    s_cbranch_scc1 Lsj_o
    s_sub_u32 s39, s39, 1080
    s_mul_i32 s40, s39, 6554
    s_lshr_b32 s40, s40, 16
    s_mul_i32 s37, s40, 10
    s_sub_u32 s41, s39, s37
    s_mul_i32 s37, s40, 40960
    s_lshl_b32 s38, s41, 7
    s_add_u32 s37, s37, s38
    v_mul_u32_u24 v236, 1280, v236
    v_add3_u32 v236, v236, v237, s37
    s_mov_b64 s[68:69], s[16:17]
    s_mov_b64 s[60:61], s[16:17]
    v_add_u32 v232, 0x0, v236
    v_add_u32 v233, 0x2800, v236
    v_add_u32 v234, 0x5000, v236
    v_add_u32 v235, 0x7800, v236
    s_mul_i32 s64, s41, 216
    s_add_u32 s64, s64, s40
    s_lshl_b32 s64, s64, 10
    s_add_u32 s64, s64, 0x1800000
    s_mov_b32 s65, 55296
    s_mov_b32 s66, 1
    s_branch Lsj_e
Lsj_o:
    s_cmp_ge_u32 s39, 1820
    s_cselect_b32 s66, 2, 1
    s_min_u32 s39, s39, 1819
    s_sub_u32 s39, s39, 1620
    s_mul_i32 s40, s39, 6554
    s_lshr_b32 s40, s40, 16
    s_mul_i32 s37, s40, 10
    s_sub_u32 s41, s39, s37
    s_mul_i32 s64, s41, 80
    s_add_u32 s64, s64, s40
    s_lshl_b32 s64, s64, 10
    s_add_u32 s64, s64, 0x1700000
    s_mov_b32 s65, 20480
    s_lshl_b32 s38, s41, 7
    s_cmp_ge_u32 s40, 16
    s_cbranch_scc1 Lsj_r
    s_mul_i32 s37, s40, 51200
    s_add_u32 s37, s37, s38
    v_mul_u32_u24 v236, 1280, v236
    v_add3_u32 v236, v236, v237, s37
    s_mov_b64 s[68:69], s[8:9]
    s_mov_b64 s[60:61], s[8:9]
    v_add_u32 v232, 0x0, v236
    v_add_u32 v233, 0x2800, v236
    v_add_u32 v234, 0x6400, v236
    v_add_u32 v235, 0x8c00, v236
    s_branch Lsj_e
Lsj_r:
    s_sub_u32 s40, s40, 16
    s_mul_i32 s37, s40, 204800
    s_add_u32 s37, s37, 20480
    s_add_u32 s37, s37, s38
    v_and_b32 v236, 3, v236
    v_lshrrev_b32 v238, 5, v1
    v_mul_u32_u24 v238, 20, v238
    v_add_u32 v236, v236, v238
    v_mul_u32_u24 v236, 1280, v236
    v_add3_u32 v236, v236, v237, s37
    s_mov_b64 s[68:69], s[8:9]
    s_mov_b64 s[60:61], s[8:9]
    v_add_u32 v232, 0x0, v236
    v_add_u32 v233, 0xc800, v236
    v_add_u32 v234, 0x19000, v236
    v_add_u32 v235, 0x25800, v236
Lsj_e:
    v_bfe_u32 v236, v1, 4, 1
    v_lshrrev_b32 v237, 5, v1
    s_cmp_eq_u32 s66, 0
    s_cselect_b32 s37, 4, 2
    s_cselect_b32 s38, 2, 4
    v_lshlrev_b32 v236, s37, v236
    v_lshlrev_b32 v237, s38, v237
    v_bfe_u32 v238, v1, 2, 2
    v_add3_u32 v236, v236, v237, v238
    s_lshl_b32 s62, s32, 12
    s_add_u32 s62, s62, 20480
    v_lshl_add_u32 v236, v236, 7, s62
    v_and_b32 v237, 3, v1
    v_lshl_add_u32 v236, v237, 3, v236
    s_lshr_b32 s37, s32, 2
    s_mul_i32 s49, s37, 11264
    s_add_u32 s49, s49, 92160
    s_bfe_u32 s58, s32, 0x10001
    s_mul_i32 s48, s34, 393216
    s_add_u32 s48, s48, 0x400000
    s_and_b32 s38, s32, 1
    s_lshl_b32 s38, s38, 1
    s_lshl_b32 s37, s37, 2
    s_add_u32 s37, s37, s38
    s_lshl_b32 s38, s37, 10
    s_add_u32 s38, s38, 10240
    v_lshl_add_u32 v132, v1, 4, s38
    s_lshl_b32 s38, s37, 8
    s_add_u32 s38, s38, 18432
    v_lshl_add_u32 v133, v1, 3, s38
    ds_read_b128 v[12:15], v132
    ds_read_b128 v[16:19], v132 offset:1024
    ds_read_b64 v[10:11], v133
    v_lshlrev_b32 v7, 4, v1
    s_lshl_b32 s55, s58, 11
    s_add_u32 s55, s55, s49
    v_add_u32 v4, s55, v7
    s_mul_i32 s55, s58, 3584
    s_add_u32 s55, s55, s49
    s_add_u32 s55, s55, 4096
    v_and_b32 v133, 31, v1
    v_mul_u32_u24 v5, 56, v133
    v_add_u32 v5, 48, v5
    v_add_u32 v5, s55, v5
    v_lshrrev_b32 v133, 5, v1
    v_lshlrev_b32 v133, 2, v133
    v_bfe_u32 v6, v1, 2, 2
    v_add_u32 v133, v133, v6
    v_mul_u32_u24 v6, 56, v133
    v_add_u32 v6, s55, v6
    v_bfe_u32 v133, v1, 4, 1
    v_lshlrev_b32 v133, 2, v133
    v_and_b32 v116, 3, v1
    v_add_u32 v133, v133, v116
    v_min_u32 v133, 5, v133
    v_lshlrev_b32 v133, 3, v133
    v_add_u32 v6, v6, v133
    s_mul_i32 s56, s32, 3072
    s_add_u32 s59, s48, s56
    s_add_u32 s56, s56, 92160
    s_add_u32 s57, s56, 73728
    s_mov_b32 s53, s56
    s_mov_b32 s54, s33
    v_mov_b32 v84, 0
    v_mov_b32 v85, 0
    v_mov_b32 v86, 0
    v_mov_b32 v87, 0
    v_mov_b32 v88, 0
    v_mov_b32 v89, 0
    v_mov_b32 v90, 0
    v_mov_b32 v91, 0
    v_mov_b32 v92, 0
    v_mov_b32 v93, 0
    v_mov_b32 v94, 0
    v_mov_b32 v95, 0
    v_mov_b32 v96, 0
    v_mov_b32 v97, 0
    v_mov_b32 v98, 0
    v_mov_b32 v99, 0
    v_mov_b32 v100, 0
    v_mov_b32 v101, 0
    v_mov_b32 v102, 0
    v_mov_b32 v103, 0
    v_mov_b32 v104, 0
    v_mov_b32 v105, 0
    v_mov_b32 v106, 0
    v_mov_b32 v107, 0
    v_mov_b32 v108, 0
    v_mov_b32 v109, 0
    v_mov_b32 v110, 0
    v_mov_b32 v111, 0
    v_mov_b32 v112, 0
    v_mov_b32 v113, 0
    v_mov_b32 v114, 0
    v_mov_b32 v115, 0
    v_mov_b32 v76, 0
    v_mov_b32 v124, 0
    v_mov_b32 v77, 0
    v_mov_b32 v125, 0
    v_mov_b32 v78, 0
    v_mov_b32 v126, 0
    v_mov_b32 v79, 0
    v_mov_b32 v127, 0
    s_mov_b32 s50, 0
    s_mov_b32 s52, 0
    s_add_u32 s54, s54, 1
    s_and_b32 s54, s54, 15
    s_add_u32 s53, s53, 24576
    s_cmp_lg_u32 s32, 0
    s_cbranch_scc1 Lq1
    v_and_b32 v132, 15, v1
    s_lshl_b32 s37, s34, 7
    v_lshlrev_b32 v132, 11, v132
    s_add_u32 s37, s37, 0x18000
    v_add_u32 v132, s37, v132
    s_mov_b32 s46, 30000
Lp1_3:
    buffer_load_dword v133, v132, s[28:31], 0 offen sc1
    s_waitcnt vmcnt(0)
    v_cmp_ne_u32 vcc, s35, v133
    s_cbranch_vccz Lpe1_4
    s_sub_u32 s46, s46, 1
    s_cmp_gt_i32 s46, 0
    s_cbranch_scc1 Lp1_3
Lpe1_4:
Lq1:
    s_waitcnt lgkmcnt(0)
    s_barrier
    s_mul_i32 s55, s54, 24576
    s_add_u32 s55, s55, s59
    s_mov_b32 m0, s53
    s_add_u32 s54, s54, 1
    s_and_b32 s54, s54, 15
    s_add_u32 s53, s53, 24576
    s_cmp_ge_u32 s53, s57
    s_cselect_b32 s53, s56, s53
    buffer_load_dwordx4 v7, s[28:31], s55 offen offset:0 sc1 lds
    buffer_load_dwordx4 v7, s[28:31], s55 offen offset:1024 sc1 lds
    buffer_load_dwordx4 v7, s[28:31], s55 offen offset:2048 sc1 lds
    s_cmp_lg_u32 s32, 3
    s_cbranch_scc1 Lq3
    s_cmp_ge_u32 s2, 200
    s_cbranch_scc1 Lq3
    v_lshlrev_b32 v2, 2, v1
    v_add_u32 v3, 512, v2
    ds_read2st64_b32 v[136:137], v3 offset0:0 offset1:1
    ds_read2st64_b32 v[138:139], v3 offset0:2 offset1:3
    ds_read2st64_b32 v[140:141], v3 offset0:4 offset1:5
    ds_read2st64_b32 v[142:143], v3 offset0:6 offset1:7
    s_waitcnt lgkmcnt(0)
    v_add_f32 v136, v136, v140
    v_add_f32 v137, v137, v141
    v_add_f32 v138, v138, v142
    v_add_f32 v139, v139, v143
    v_add_f32 v136, v136, v138
    v_add_f32 v137, v137, v139
    v_add_f32 v136, v136, v137
    buffer_store_dword v136, v2, s[28:31], s67 offen sc1
Lq3:
    ds_read2_b64 v[128:131], v5 offset0:0 offset1:224
    ds_read_b128 v[116:119], v4
    ds_read_b64_tr_b16 v[120:121], v6
    ds_read_b64_tr_b16 v[122:123], v6 offset:448
    s_waitcnt lgkmcnt(3)
    v_mfma_f32_32x32x4_2b_bf16 v[20:51], v[128:129], v[10:11], 0
    s_nop 15
    s_nop 1
    s_waitcnt lgkmcnt(0)
    v_mfma_f32_32x32x16_bf16 v[20:35], v[116:119], v[12:15], v[20:35]
    v_mfma_f32_32x32x16_bf16 v[36:51], v[116:119], v[16:19], v[36:51]
    ds_read_b128 v[116:119], v4 offset:1024
    s_nop 10
    s_waitcnt lgkmcnt(0)
    s_add_u32 s52, s52, 1
    s_cmp_eq_u32 s52, 3
    s_movk_i32 s51, 24576
    s_cselect_b32 s51, 4294918144, s51
    s_cselect_b32 s52, 0, s52
    v_exp_f32 v20, v20
    v_exp_f32 v21, v21
    v_exp_f32 v22, v22
    s_waitcnt lgkmcnt(3)
    v_mfma_f32_32x32x16_bf16 v[100:115], v[124:127], v[76:79], v[100:115]
    v_exp_f32 v23, v23
    v_exp_f32 v24, v24
    ds_read_b64_tr_b16 v[124:125], v6 offset:896
    ds_read_b64_tr_b16 v[126:127], v6 offset:1344
    v_exp_f32 v25, v25
    v_exp_f32 v26, v26
    v_exp_f32 v27, v27
    v_mfma_f32_32x32x4_2b_bf16 v[52:83], v[130:131], v[10:11], 0
    v_cvt_pk_bf16_f32 v20, v20, v21
    v_cvt_pk_bf16_f32 v21, v22, v23
    s_add_u32 m0, s62, 0
    s_nop 0
    global_load_lds_dwordx4 v232, s[68:69]
    v_cvt_pk_bf16_f32 v22, v24, v25
    s_setprio 0
    v_cvt_pk_bf16_f32 v23, v26, v27
    v_exp_f32 v28, v28
    v_exp_f32 v29, v29
    v_exp_f32 v30, v30
    v_exp_f32 v31, v31
    v_exp_f32 v32, v32
    s_waitcnt lgkmcnt(2)
    v_mfma_f32_32x32x16_bf16 v[84:99], v[120:123], v[20:23], v[84:99]
    v_exp_f32 v33, v33
    v_exp_f32 v34, v34
    s_add_u32 m0, s62, 1024
    s_nop 0
    global_load_lds_dwordx4 v233, s[68:69]
    v_exp_f32 v35, v35
    v_cvt_pk_bf16_f32 v28, v28, v29
    v_cvt_pk_bf16_f32 v29, v30, v31
    v_cvt_pk_bf16_f32 v30, v32, v33
    v_cvt_pk_bf16_f32 v31, v34, v35
    v_exp_f32 v36, v36
    v_mfma_f32_32x32x16_bf16 v[52:67], v[116:119], v[12:15], v[52:67]
    v_exp_f32 v37, v37
    v_exp_f32 v38, v38
    v_exp_f32 v39, v39
    v_exp_f32 v40, v40
    s_waitcnt lgkmcnt(0)
    v_mfma_f32_32x32x16_bf16 v[84:99], v[124:127], v[28:31], v[84:99]
    v_exp_f32 v41, v41
    v_exp_f32 v42, v42
    v_exp_f32 v43, v43
    v_cvt_pk_bf16_f32 v36, v36, v37
    v_cvt_pk_bf16_f32 v37, v38, v39
    v_mfma_f32_32x32x16_bf16 v[68:83], v[116:119], v[16:19], v[68:83]
    v_cvt_pk_bf16_f32 v38, v40, v41
    v_cvt_pk_bf16_f32 v39, v42, v43
    v_exp_f32 v44, v44
    v_exp_f32 v45, v45
    s_waitcnt vmcnt(2)
    s_barrier
    s_setprio 3
    v_add_u32 v4, s51, v4
    v_exp_f32 v46, v46
    ds_read_b128 v[116:119], v4
    v_exp_f32 v47, v47
    v_exp_f32 v48, v48
    v_mfma_f32_32x32x16_bf16 v[100:115], v[120:123], v[36:39], v[100:115]
    v_exp_f32 v49, v49
    v_exp_f32 v50, v50
    ds_read_b64_tr_b16 v[120:121], v6 offset:1792
    ds_read_b64_tr_b16 v[122:123], v6 offset:2240
    v_exp_f32 v51, v51
    v_add_u32 v5, s51, v5
    v_cvt_pk_bf16_f32 v44, v44, v45
    ds_read2_b64 v[128:131], v5 offset0:0 offset1:224
    v_cvt_pk_bf16_f32 v45, v46, v47
    v_cvt_pk_bf16_f32 v46, v48, v49
    v_cvt_pk_bf16_f32 v47, v50, v51
    v_exp_f32 v52, v52
    s_setprio 2
    v_exp_f32 v53, v53
    v_exp_f32 v54, v54
    v_mfma_f32_32x32x16_bf16 v[100:115], v[124:127], v[44:47], v[100:115]
    v_exp_f32 v55, v55
    v_exp_f32 v56, v56
    ds_read_b64_tr_b16 v[124:125], v6 offset:2688
    ds_read_b64_tr_b16 v[126:127], v6 offset:3136
    v_exp_f32 v57, v57
    v_exp_f32 v58, v58
    v_exp_f32 v59, v59
    s_waitcnt lgkmcnt(2)
    v_mfma_f32_32x32x4_2b_bf16 v[20:51], v[128:129], v[10:11], 0
    v_cvt_pk_bf16_f32 v52, v52, v53
    v_cvt_pk_bf16_f32 v53, v54, v55
    v_cvt_pk_bf16_f32 v54, v56, v57
    s_mul_i32 s55, s54, 24576
    s_add_u32 s55, s55, s59
    s_mov_b32 m0, s53
    s_add_u32 s54, s54, 1
    s_and_b32 s54, s54, 15
    s_add_u32 s53, s53, 24576
    s_cmp_ge_u32 s53, s57
    s_cselect_b32 s53, s56, s53
    buffer_load_dwordx4 v7, s[28:31], s55 offen offset:0 sc1 lds
    v_cvt_pk_bf16_f32 v55, v58, v59
    v_exp_f32 v60, v60
    v_exp_f32 v61, v61
    v_exp_f32 v62, v62
    v_exp_f32 v63, v63
    v_exp_f32 v64, v64
    v_mfma_f32_32x32x16_bf16 v[84:99], v[120:123], v[52:55], v[84:99]
    v_exp_f32 v65, v65
    v_exp_f32 v66, v66
    v_exp_f32 v67, v67
    v_cvt_pk_bf16_f32 v60, v60, v61
    buffer_load_dwordx4 v7, s[28:31], s55 offen offset:1024 sc1 lds
    v_cvt_pk_bf16_f32 v61, v62, v63
    v_cvt_pk_bf16_f32 v62, v64, v65
    v_cvt_pk_bf16_f32 v63, v66, v67
    v_exp_f32 v68, v68
    v_mfma_f32_32x32x16_bf16 v[20:35], v[116:119], v[12:15], v[20:35]
    v_exp_f32 v69, v69
    v_exp_f32 v70, v70
    v_exp_f32 v71, v71
    v_exp_f32 v72, v72
    s_waitcnt lgkmcnt(0)
    v_mfma_f32_32x32x16_bf16 v[84:99], v[124:127], v[60:63], v[84:99]
    v_exp_f32 v73, v73
    v_exp_f32 v74, v74
    s_setprio 1
    buffer_load_dwordx4 v7, s[28:31], s55 offen offset:2048 sc1 lds
    v_exp_f32 v75, v75
    v_cvt_pk_bf16_f32 v68, v68, v69
    v_cvt_pk_bf16_f32 v69, v70, v71
    v_mfma_f32_32x32x16_bf16 v[36:51], v[116:119], v[16:19], v[36:51]
    v_cvt_pk_bf16_f32 v70, v72, v73
    v_cvt_pk_bf16_f32 v71, v74, v75
    ds_read_b128 v[116:119], v4 offset:1024
    v_exp_f32 v76, v76
    v_exp_f32 v77, v77
    v_exp_f32 v78, v78
    v_exp_f32 v79, v79
    v_exp_f32 v80, v80
    v_mfma_f32_32x32x16_bf16 v[100:115], v[120:123], v[68:71], v[100:115]
    v_exp_f32 v81, v81
    v_add_u32 v6, s51, v6
    v_exp_f32 v82, v82
    ds_read_b64_tr_b16 v[120:121], v6 offset:0
    ds_read_b64_tr_b16 v[122:123], v6 offset:448
    v_exp_f32 v83, v83
    v_cvt_pk_bf16_f32 v76, v76, v77
    v_cvt_pk_bf16_f32 v77, v78, v79
    v_cvt_pk_bf16_f32 v78, v80, v81
    v_cvt_pk_bf16_f32 v79, v82, v83
    s_add_u32 s52, s52, 1
    s_cmp_eq_u32 s52, 3
    s_movk_i32 s51, 24576
    s_cselect_b32 s51, 4294918144, s51
    s_cselect_b32 s52, 0, s52
    v_exp_f32 v20, v20
    v_exp_f32 v21, v21
    v_exp_f32 v22, v22
    s_waitcnt lgkmcnt(3)
    v_mfma_f32_32x32x16_bf16 v[100:115], v[124:127], v[76:79], v[100:115]
    v_exp_f32 v23, v23
    v_exp_f32 v24, v24
    ds_read_b64_tr_b16 v[124:125], v6 offset:896
    ds_read_b64_tr_b16 v[126:127], v6 offset:1344
    v_exp_f32 v25, v25
    v_exp_f32 v26, v26
    v_exp_f32 v27, v27
    v_mfma_f32_32x32x4_2b_bf16 v[52:83], v[130:131], v[10:11], 0
    v_cvt_pk_bf16_f32 v20, v20, v21
    v_cvt_pk_bf16_f32 v21, v22, v23
    s_add_u32 m0, s62, 2048
    s_nop 0
    global_load_lds_dwordx4 v234, s[60:61]
    v_cvt_pk_bf16_f32 v22, v24, v25
    s_setprio 0
    v_cvt_pk_bf16_f32 v23, v26, v27
    v_exp_f32 v28, v28
    v_exp_f32 v29, v29
    v_exp_f32 v30, v30
    v_exp_f32 v31, v31
    v_exp_f32 v32, v32
    s_waitcnt lgkmcnt(2)
    v_mfma_f32_32x32x16_bf16 v[84:99], v[120:123], v[20:23], v[84:99]
    v_exp_f32 v33, v33
    v_exp_f32 v34, v34
    v_exp_f32 v35, v35
    v_cvt_pk_bf16_f32 v28, v28, v29
    v_cvt_pk_bf16_f32 v29, v30, v31
    v_cvt_pk_bf16_f32 v30, v32, v33
    v_cvt_pk_bf16_f32 v31, v34, v35
    v_exp_f32 v36, v36
    v_mfma_f32_32x32x16_bf16 v[52:67], v[116:119], v[12:15], v[52:67]
    v_exp_f32 v37, v37
    v_exp_f32 v38, v38
    v_exp_f32 v39, v39
    v_exp_f32 v40, v40
    s_waitcnt lgkmcnt(0)
    v_mfma_f32_32x32x16_bf16 v[84:99], v[124:127], v[28:31], v[84:99]
    v_exp_f32 v41, v41
    v_exp_f32 v42, v42
    v_exp_f32 v43, v43
    v_cvt_pk_bf16_f32 v36, v36, v37
    v_cvt_pk_bf16_f32 v37, v38, v39
    v_mfma_f32_32x32x16_bf16 v[68:83], v[116:119], v[16:19], v[68:83]
    v_cvt_pk_bf16_f32 v38, v40, v41
    v_cvt_pk_bf16_f32 v39, v42, v43
    v_exp_f32 v44, v44
    v_exp_f32 v45, v45
    s_waitcnt vmcnt(1)
    s_barrier
    s_setprio 3
    v_add_u32 v4, s51, v4
    v_exp_f32 v46, v46
    ds_read_b128 v[116:119], v4
    v_exp_f32 v47, v47
    v_exp_f32 v48, v48
    v_mfma_f32_32x32x16_bf16 v[100:115], v[120:123], v[36:39], v[100:115]
    v_exp_f32 v49, v49
    v_exp_f32 v50, v50
    ds_read_b64_tr_b16 v[120:121], v6 offset:1792
    ds_read_b64_tr_b16 v[122:123], v6 offset:2240
    v_exp_f32 v51, v51
    v_add_u32 v5, s51, v5
    v_cvt_pk_bf16_f32 v44, v44, v45
    ds_read2_b64 v[128:131], v5 offset0:0 offset1:224
    v_cvt_pk_bf16_f32 v45, v46, v47
    v_cvt_pk_bf16_f32 v46, v48, v49
    v_cvt_pk_bf16_f32 v47, v50, v51
    v_exp_f32 v52, v52
    s_setprio 2
    v_exp_f32 v53, v53
    v_exp_f32 v54, v54
    v_mfma_f32_32x32x16_bf16 v[100:115], v[124:127], v[44:47], v[100:115]
    v_exp_f32 v55, v55
    v_exp_f32 v56, v56
    ds_read_b64_tr_b16 v[124:125], v6 offset:2688
    ds_read_b64_tr_b16 v[126:127], v6 offset:3136
    v_exp_f32 v57, v57
    v_exp_f32 v58, v58
    v_exp_f32 v59, v59
    s_waitcnt lgkmcnt(2)
    v_mfma_f32_32x32x4_2b_bf16 v[20:51], v[128:129], v[10:11], 0
    v_cvt_pk_bf16_f32 v52, v52, v53
    v_cvt_pk_bf16_f32 v53, v54, v55
    v_cvt_pk_bf16_f32 v54, v56, v57
    s_mul_i32 s55, s54, 24576
    s_add_u32 s55, s55, s59
    s_mov_b32 m0, s53
    s_add_u32 s54, s54, 1
    s_and_b32 s54, s54, 15
    s_add_u32 s53, s53, 24576
    s_cmp_ge_u32 s53, s57
    s_cselect_b32 s53, s56, s53
    buffer_load_dwordx4 v7, s[28:31], s55 offen offset:0 sc1 lds
    v_cvt_pk_bf16_f32 v55, v58, v59
    v_exp_f32 v60, v60
    v_exp_f32 v61, v61
    v_exp_f32 v62, v62
    v_exp_f32 v63, v63
    v_exp_f32 v64, v64
    v_mfma_f32_32x32x16_bf16 v[84:99], v[120:123], v[52:55], v[84:99]
    v_exp_f32 v65, v65
    v_exp_f32 v66, v66
    v_exp_f32 v67, v67
    v_cvt_pk_bf16_f32 v60, v60, v61
    buffer_load_dwordx4 v7, s[28:31], s55 offen offset:1024 sc1 lds
    v_cvt_pk_bf16_f32 v61, v62, v63
    v_cvt_pk_bf16_f32 v62, v64, v65
    v_cvt_pk_bf16_f32 v63, v66, v67
    v_exp_f32 v68, v68
    v_mfma_f32_32x32x16_bf16 v[20:35], v[116:119], v[12:15], v[20:35]
    v_exp_f32 v69, v69
    v_exp_f32 v70, v70
    v_exp_f32 v71, v71
    v_exp_f32 v72, v72
    s_waitcnt lgkmcnt(0)
    v_mfma_f32_32x32x16_bf16 v[84:99], v[124:127], v[60:63], v[84:99]
    v_exp_f32 v73, v73
    v_exp_f32 v74, v74
    s_setprio 1
    buffer_load_dwordx4 v7, s[28:31], s55 offen offset:2048 sc1 lds
    v_exp_f32 v75, v75
    v_cvt_pk_bf16_f32 v68, v68, v69
    v_cvt_pk_bf16_f32 v69, v70, v71
    v_mfma_f32_32x32x16_bf16 v[36:51], v[116:119], v[16:19], v[36:51]
    v_cvt_pk_bf16_f32 v70, v72, v73
    v_cvt_pk_bf16_f32 v71, v74, v75
    ds_read_b128 v[116:119], v4 offset:1024
    v_exp_f32 v76, v76
    v_exp_f32 v77, v77
    v_exp_f32 v78, v78
    v_exp_f32 v79, v79
    v_exp_f32 v80, v80
    v_mfma_f32_32x32x16_bf16 v[100:115], v[120:123], v[68:71], v[100:115]
    v_exp_f32 v81, v81
    v_add_u32 v6, s51, v6
    v_exp_f32 v82, v82
    ds_read_b64_tr_b16 v[120:121], v6 offset:0
    ds_read_b64_tr_b16 v[122:123], v6 offset:448
    v_exp_f32 v83, v83
    v_cvt_pk_bf16_f32 v76, v76, v77
    v_cvt_pk_bf16_f32 v77, v78, v79
    v_cvt_pk_bf16_f32 v78, v80, v81
    v_cvt_pk_bf16_f32 v79, v82, v83
    s_add_u32 s52, s52, 1
    s_cmp_eq_u32 s52, 3
    s_movk_i32 s51, 24576
    s_cselect_b32 s51, 4294918144, s51
    s_cselect_b32 s52, 0, s52
    v_exp_f32 v20, v20
    v_exp_f32 v21, v21
    v_exp_f32 v22, v22
    s_waitcnt lgkmcnt(3)
    v_mfma_f32_32x32x16_bf16 v[100:115], v[124:127], v[76:79], v[100:115]
    v_exp_f32 v23, v23
    v_exp_f32 v24, v24
    ds_read_b64_tr_b16 v[124:125], v6 offset:896
    ds_read_b64_tr_b16 v[126:127], v6 offset:1344
    v_exp_f32 v25, v25
    v_exp_f32 v26, v26
    v_exp_f32 v27, v27
    v_mfma_f32_32x32x4_2b_bf16 v[52:83], v[130:131], v[10:11], 0
    v_cvt_pk_bf16_f32 v20, v20, v21
    v_cvt_pk_bf16_f32 v21, v22, v23
    s_add_u32 m0, s62, 3072
    s_nop 0
    global_load_lds_dwordx4 v235, s[60:61]
    v_cvt_pk_bf16_f32 v22, v24, v25
    s_setprio 0
    v_cvt_pk_bf16_f32 v23, v26, v27
    v_exp_f32 v28, v28
    v_exp_f32 v29, v29
    v_exp_f32 v30, v30
    v_exp_f32 v31, v31
    v_exp_f32 v32, v32
    s_waitcnt lgkmcnt(2)
    v_mfma_f32_32x32x16_bf16 v[84:99], v[120:123], v[20:23], v[84:99]
    v_exp_f32 v33, v33
    v_exp_f32 v34, v34
    v_exp_f32 v35, v35
    v_cvt_pk_bf16_f32 v28, v28, v29
    v_cvt_pk_bf16_f32 v29, v30, v31
    v_cvt_pk_bf16_f32 v30, v32, v33
    v_cvt_pk_bf16_f32 v31, v34, v35
    v_exp_f32 v36, v36
    v_mfma_f32_32x32x16_bf16 v[52:67], v[116:119], v[12:15], v[52:67]
    v_exp_f32 v37, v37
    v_exp_f32 v38, v38
    v_exp_f32 v39, v39
    v_exp_f32 v40, v40
    s_waitcnt lgkmcnt(0)
    v_mfma_f32_32x32x16_bf16 v[84:99], v[124:127], v[28:31], v[84:99]
    v_exp_f32 v41, v41
    v_exp_f32 v42, v42
    v_exp_f32 v43, v43
    v_cvt_pk_bf16_f32 v36, v36, v37
    v_cvt_pk_bf16_f32 v37, v38, v39
    v_mfma_f32_32x32x16_bf16 v[68:83], v[116:119], v[16:19], v[68:83]
    v_cvt_pk_bf16_f32 v38, v40, v41
    v_cvt_pk_bf16_f32 v39, v42, v43
    v_exp_f32 v44, v44
    v_exp_f32 v45, v45
    s_waitcnt vmcnt(1)
    s_barrier
    s_setprio 3
    v_add_u32 v4, s51, v4
    v_exp_f32 v46, v46
    ds_read_b128 v[116:119], v4
    v_exp_f32 v47, v47
    v_exp_f32 v48, v48
    v_mfma_f32_32x32x16_bf16 v[100:115], v[120:123], v[36:39], v[100:115]
    v_exp_f32 v49, v49
    v_exp_f32 v50, v50
    ds_read_b64_tr_b16 v[120:121], v6 offset:1792
    ds_read_b64_tr_b16 v[122:123], v6 offset:2240
    v_exp_f32 v51, v51
    v_add_u32 v5, s51, v5
    v_cvt_pk_bf16_f32 v44, v44, v45
    ds_read2_b64 v[128:131], v5 offset0:0 offset1:224
    v_cvt_pk_bf16_f32 v45, v46, v47
    v_cvt_pk_bf16_f32 v46, v48, v49
    v_cvt_pk_bf16_f32 v47, v50, v51
    v_exp_f32 v52, v52
    s_setprio 2
    v_exp_f32 v53, v53
    v_exp_f32 v54, v54
    v_mfma_f32_32x32x16_bf16 v[100:115], v[124:127], v[44:47], v[100:115]
    v_exp_f32 v55, v55
    v_exp_f32 v56, v56
    ds_read_b64_tr_b16 v[124:125], v6 offset:2688
    ds_read_b64_tr_b16 v[126:127], v6 offset:3136
    v_exp_f32 v57, v57
    v_exp_f32 v58, v58
    v_exp_f32 v59, v59
    s_waitcnt lgkmcnt(2)
    v_mfma_f32_32x32x4_2b_bf16 v[20:51], v[128:129], v[10:11], 0
    v_cvt_pk_bf16_f32 v52, v52, v53
    v_cvt_pk_bf16_f32 v53, v54, v55
    v_cvt_pk_bf16_f32 v54, v56, v57
    s_mul_i32 s55, s54, 24576
    s_add_u32 s55, s55, s59
    s_mov_b32 m0, s53
    s_add_u32 s54, s54, 1
    s_and_b32 s54, s54, 15
    s_add_u32 s53, s53, 24576
    s_cmp_ge_u32 s53, s57
    s_cselect_b32 s53, s56, s53
    buffer_load_dwordx4 v7, s[28:31], s55 offen offset:0 sc1 lds
    v_cvt_pk_bf16_f32 v55, v58, v59
    v_exp_f32 v60, v60
    v_exp_f32 v61, v61
    v_exp_f32 v62, v62
    v_exp_f32 v63, v63
    v_exp_f32 v64, v64
    v_mfma_f32_32x32x16_bf16 v[84:99], v[120:123], v[52:55], v[84:99]
    v_exp_f32 v65, v65
    v_exp_f32 v66, v66
    v_exp_f32 v67, v67
    v_cvt_pk_bf16_f32 v60, v60, v61
    buffer_load_dwordx4 v7, s[28:31], s55 offen offset:1024 sc1 lds
    v_cvt_pk_bf16_f32 v61, v62, v63
    v_cvt_pk_bf16_f32 v62, v64, v65
    v_cvt_pk_bf16_f32 v63, v66, v67
    v_exp_f32 v68, v68
    v_mfma_f32_32x32x16_bf16 v[20:35], v[116:119], v[12:15], v[20:35]
    v_exp_f32 v69, v69
    v_exp_f32 v70, v70
    v_exp_f32 v71, v71
    v_exp_f32 v72, v72
    s_waitcnt lgkmcnt(0)
    v_mfma_f32_32x32x16_bf16 v[84:99], v[124:127], v[60:63], v[84:99]
    v_exp_f32 v73, v73
    v_exp_f32 v74, v74
    s_setprio 1
    buffer_load_dwordx4 v7, s[28:31], s55 offen offset:2048 sc1 lds
    v_exp_f32 v75, v75
    v_cvt_pk_bf16_f32 v68, v68, v69
    v_cvt_pk_bf16_f32 v69, v70, v71
    v_mfma_f32_32x32x16_bf16 v[36:51], v[116:119], v[16:19], v[36:51]
    v_cvt_pk_bf16_f32 v70, v72, v73
    v_cvt_pk_bf16_f32 v71, v74, v75
    ds_read_b128 v[116:119], v4 offset:1024
    v_exp_f32 v76, v76
    v_exp_f32 v77, v77
    v_exp_f32 v78, v78
    v_exp_f32 v79, v79
    v_exp_f32 v80, v80
    v_mfma_f32_32x32x16_bf16 v[100:115], v[120:123], v[68:71], v[100:115]
    v_exp_f32 v81, v81
    v_add_u32 v6, s51, v6
    v_exp_f32 v82, v82
    ds_read_b64_tr_b16 v[120:121], v6 offset:0
    ds_read_b64_tr_b16 v[122:123], v6 offset:448
    v_exp_f32 v83, v83
    v_cvt_pk_bf16_f32 v76, v76, v77
    v_cvt_pk_bf16_f32 v77, v78, v79
    v_cvt_pk_bf16_f32 v78, v80, v81
    v_cvt_pk_bf16_f32 v79, v82, v83
    s_add_u32 s52, s52, 1
    s_cmp_eq_u32 s52, 3
    s_movk_i32 s51, 24576
    s_cselect_b32 s51, 4294918144, s51
    s_cselect_b32 s52, 0, s52
    v_exp_f32 v20, v20
    v_exp_f32 v21, v21
    v_exp_f32 v22, v22
    s_waitcnt lgkmcnt(3)
    v_mfma_f32_32x32x16_bf16 v[100:115], v[124:127], v[76:79], v[100:115]
    v_exp_f32 v23, v23
    v_exp_f32 v24, v24
    ds_read_b64_tr_b16 v[124:125], v6 offset:896
    ds_read_b64_tr_b16 v[126:127], v6 offset:1344
    v_exp_f32 v25, v25
    v_exp_f32 v26, v26
    v_exp_f32 v27, v27
    v_mfma_f32_32x32x4_2b_bf16 v[52:83], v[130:131], v[10:11], 0
    v_cvt_pk_bf16_f32 v20, v20, v21
    v_cvt_pk_bf16_f32 v21, v22, v23
    v_cvt_pk_bf16_f32 v22, v24, v25
    s_setprio 0
    v_cvt_pk_bf16_f32 v23, v26, v27
    v_exp_f32 v28, v28
    v_exp_f32 v29, v29
    v_exp_f32 v30, v30
    v_exp_f32 v31, v31
    v_exp_f32 v32, v32
    s_waitcnt lgkmcnt(2)
    v_mfma_f32_32x32x16_bf16 v[84:99], v[120:123], v[20:23], v[84:99]
    v_exp_f32 v33, v33
    v_exp_f32 v34, v34
    v_exp_f32 v35, v35
    v_cvt_pk_bf16_f32 v28, v28, v29
    v_cvt_pk_bf16_f32 v29, v30, v31
    v_cvt_pk_bf16_f32 v30, v32, v33
    v_cvt_pk_bf16_f32 v31, v34, v35
    v_exp_f32 v36, v36
    v_mfma_f32_32x32x16_bf16 v[52:67], v[116:119], v[12:15], v[52:67]
    v_exp_f32 v37, v37
    v_exp_f32 v38, v38
    v_exp_f32 v39, v39
    v_exp_f32 v40, v40
    s_waitcnt lgkmcnt(0)
    v_mfma_f32_32x32x16_bf16 v[84:99], v[124:127], v[28:31], v[84:99]
    v_exp_f32 v41, v41
    v_exp_f32 v42, v42
    v_exp_f32 v43, v43
    v_cvt_pk_bf16_f32 v36, v36, v37
    v_cvt_pk_bf16_f32 v37, v38, v39
    v_mfma_f32_32x32x16_bf16 v[68:83], v[116:119], v[16:19], v[68:83]
    v_cvt_pk_bf16_f32 v38, v40, v41
    v_cvt_pk_bf16_f32 v39, v42, v43
    v_exp_f32 v44, v44
    v_exp_f32 v45, v45
    s_waitcnt vmcnt(0)
    s_barrier
    s_setprio 3
    v_add_u32 v4, s51, v4
    v_exp_f32 v46, v46
    ds_read_b128 v[116:119], v4
    v_exp_f32 v47, v47
    v_exp_f32 v48, v48
    v_mfma_f32_32x32x16_bf16 v[100:115], v[120:123], v[36:39], v[100:115]
    v_exp_f32 v49, v49
    v_exp_f32 v50, v50
    ds_read_b64_tr_b16 v[120:121], v6 offset:1792
    ds_read_b64_tr_b16 v[122:123], v6 offset:2240
    v_exp_f32 v51, v51
    v_add_u32 v5, s51, v5
    v_cvt_pk_bf16_f32 v44, v44, v45
    ds_read2_b64 v[128:131], v5 offset0:0 offset1:224
    v_cvt_pk_bf16_f32 v45, v46, v47
    v_cvt_pk_bf16_f32 v46, v48, v49
    v_cvt_pk_bf16_f32 v47, v50, v51
    v_exp_f32 v52, v52
    s_setprio 2
    v_exp_f32 v53, v53
    v_exp_f32 v54, v54
    v_mfma_f32_32x32x16_bf16 v[100:115], v[124:127], v[44:47], v[100:115]
    v_exp_f32 v55, v55
    v_exp_f32 v56, v56
    ds_read_b64_tr_b16 v[124:125], v6 offset:2688
    ds_read_b64_tr_b16 v[126:127], v6 offset:3136
    v_exp_f32 v57, v57
    v_exp_f32 v58, v58
    v_exp_f32 v59, v59
    s_waitcnt lgkmcnt(2)
    v_mfma_f32_32x32x4_2b_bf16 v[20:51], v[128:129], v[10:11], 0
    v_cvt_pk_bf16_f32 v52, v52, v53
    v_cvt_pk_bf16_f32 v53, v54, v55
    v_cvt_pk_bf16_f32 v54, v56, v57
    s_mul_i32 s55, s54, 24576
    s_add_u32 s55, s55, s59
    s_mov_b32 m0, s53
    s_add_u32 s54, s54, 1
    s_and_b32 s54, s54, 15
    s_add_u32 s53, s53, 24576
    s_cmp_ge_u32 s53, s57
    s_cselect_b32 s53, s56, s53
    buffer_load_dwordx4 v7, s[28:31], s55 offen offset:0 sc1 lds
    v_cvt_pk_bf16_f32 v55, v58, v59
    v_exp_f32 v60, v60
    v_exp_f32 v61, v61
    v_exp_f32 v62, v62
    v_exp_f32 v63, v63
    v_exp_f32 v64, v64
    v_mfma_f32_32x32x16_bf16 v[84:99], v[120:123], v[52:55], v[84:99]
    v_exp_f32 v65, v65
    v_exp_f32 v66, v66
    v_exp_f32 v67, v67
    v_cvt_pk_bf16_f32 v60, v60, v61
    buffer_load_dwordx4 v7, s[28:31], s55 offen offset:1024 sc1 lds
    v_cvt_pk_bf16_f32 v61, v62, v63
    v_cvt_pk_bf16_f32 v62, v64, v65
    v_cvt_pk_bf16_f32 v63, v66, v67
    v_exp_f32 v68, v68
    v_mfma_f32_32x32x16_bf16 v[20:35], v[116:119], v[12:15], v[20:35]
    v_exp_f32 v69, v69
    v_exp_f32 v70, v70
    v_exp_f32 v71, v71
    v_exp_f32 v72, v72
    s_waitcnt lgkmcnt(0)
    v_mfma_f32_32x32x16_bf16 v[84:99], v[124:127], v[60:63], v[84:99]
    v_exp_f32 v73, v73
    v_exp_f32 v74, v74
    s_setprio 1
    buffer_load_dwordx4 v7, s[28:31], s55 offen offset:2048 sc1 lds
    v_exp_f32 v75, v75
    v_cvt_pk_bf16_f32 v68, v68, v69
    v_cvt_pk_bf16_f32 v69, v70, v71
    v_mfma_f32_32x32x16_bf16 v[36:51], v[116:119], v[16:19], v[36:51]
    v_cvt_pk_bf16_f32 v70, v72, v73
    v_cvt_pk_bf16_f32 v71, v74, v75
    ds_read_b128 v[116:119], v4 offset:1024
    v_exp_f32 v76, v76
    v_exp_f32 v77, v77
    v_exp_f32 v78, v78
    v_exp_f32 v79, v79
    v_exp_f32 v80, v80
    v_mfma_f32_32x32x16_bf16 v[100:115], v[120:123], v[68:71], v[100:115]
    v_exp_f32 v81, v81
    v_add_u32 v6, s51, v6
    v_exp_f32 v82, v82
    ds_read_b64_tr_b16 v[120:121], v6 offset:0
    ds_read_b64_tr_b16 v[122:123], v6 offset:448
    v_exp_f32 v83, v83
    v_cvt_pk_bf16_f32 v76, v76, v77
    v_cvt_pk_bf16_f32 v77, v78, v79
    v_cvt_pk_bf16_f32 v78, v80, v81
    v_cvt_pk_bf16_f32 v79, v82, v83
    s_lshl_b32 s37, s2, 3
    s_add_u32 s37, s37, s32
    s_and_b32 s37, s37, 255
    s_lshl_b32 s37, s37, 12
    s_add_u32 s37, s37, 0x2400000
    s_cmp_eq_u32 s66, 2
    s_cselect_b32 s64, s37, s64
    s_cselect_b32 s65, 1024, s65
    ds_read_b64_tr_b16 v[216:217], v236 offset:0
    ds_read_b64_tr_b16 v[218:219], v236 offset:1024
    ds_read_b64_tr_b16 v[220:221], v236 offset:32
    ds_read_b64_tr_b16 v[222:223], v236 offset:1056
    ds_read_b64_tr_b16 v[224:225], v236 offset:64
    ds_read_b64_tr_b16 v[226:227], v236 offset:1088
    ds_read_b64_tr_b16 v[228:229], v236 offset:96
    ds_read_b64_tr_b16 v[230:231], v236 offset:1120
    s_add_u32 s52, s52, 1
    s_cmp_eq_u32 s52, 3
    s_movk_i32 s51, 24576
    s_cselect_b32 s51, 4294918144, s51
    s_cselect_b32 s52, 0, s52
    v_exp_f32 v20, v20
    v_exp_f32 v21, v21
    v_exp_f32 v22, v22
    s_waitcnt lgkmcnt(3)
    v_mfma_f32_32x32x16_bf16 v[100:115], v[124:127], v[76:79], v[100:115]
    v_exp_f32 v23, v23
    v_exp_f32 v24, v24
    ds_read_b64_tr_b16 v[124:125], v6 offset:896
    ds_read_b64_tr_b16 v[126:127], v6 offset:1344
    v_exp_f32 v25, v25
    v_exp_f32 v26, v26
    v_exp_f32 v27, v27
    v_mfma_f32_32x32x4_2b_bf16 v[52:83], v[130:131], v[10:11], 0
    v_cvt_pk_bf16_f32 v20, v20, v21
    v_cvt_pk_bf16_f32 v21, v22, v23
    s_nop 0
    v_cvt_pk_bf16_f32 v22, v24, v25
    s_setprio 0
    v_cvt_pk_bf16_f32 v23, v26, v27
    v_exp_f32 v28, v28
    v_exp_f32 v29, v29
    v_exp_f32 v30, v30
    v_exp_f32 v31, v31
    v_exp_f32 v32, v32
    s_waitcnt lgkmcnt(2)
    v_mfma_f32_32x32x16_bf16 v[84:99], v[120:123], v[20:23], v[84:99]
    v_exp_f32 v33, v33
    v_exp_f32 v34, v34
    buffer_store_dwordx4 v[216:219], v7, s[28:31], s64 offen sc1
    s_add_u32 s64, s64, s65
    v_exp_f32 v35, v35
    v_cvt_pk_bf16_f32 v28, v28, v29
    v_cvt_pk_bf16_f32 v29, v30, v31
    v_cvt_pk_bf16_f32 v30, v32, v33
    v_cvt_pk_bf16_f32 v31, v34, v35
    v_exp_f32 v36, v36
    v_mfma_f32_32x32x16_bf16 v[52:67], v[116:119], v[12:15], v[52:67]
    v_exp_f32 v37, v37
    v_exp_f32 v38, v38
    buffer_store_dwordx4 v[220:223], v7, s[28:31], s64 offen sc1
    s_add_u32 s64, s64, s65
    v_exp_f32 v39, v39
    v_exp_f32 v40, v40
    s_waitcnt lgkmcnt(0)
    v_mfma_f32_32x32x16_bf16 v[84:99], v[124:127], v[28:31], v[84:99]
    v_exp_f32 v41, v41
    v_exp_f32 v42, v42
    v_exp_f32 v43, v43
    v_cvt_pk_bf16_f32 v36, v36, v37
    v_cvt_pk_bf16_f32 v37, v38, v39
    v_mfma_f32_32x32x16_bf16 v[68:83], v[116:119], v[16:19], v[68:83]
    v_cvt_pk_bf16_f32 v38, v40, v41
    v_cvt_pk_bf16_f32 v39, v42, v43
    v_exp_f32 v44, v44
    v_exp_f32 v45, v45
    s_waitcnt vmcnt(2)
    s_barrier
    s_setprio 3
    v_add_u32 v4, s51, v4
    v_exp_f32 v46, v46
    ds_read_b128 v[116:119], v4
    v_exp_f32 v47, v47
    v_exp_f32 v48, v48
    v_mfma_f32_32x32x16_bf16 v[100:115], v[120:123], v[36:39], v[100:115]
    v_exp_f32 v49, v49
    v_exp_f32 v50, v50
    ds_read_b64_tr_b16 v[120:121], v6 offset:1792
    ds_read_b64_tr_b16 v[122:123], v6 offset:2240
    v_exp_f32 v51, v51
    v_add_u32 v5, s51, v5
    v_cvt_pk_bf16_f32 v44, v44, v45
    ds_read2_b64 v[128:131], v5 offset0:0 offset1:224
    v_cvt_pk_bf16_f32 v45, v46, v47
    v_cvt_pk_bf16_f32 v46, v48, v49
    v_cvt_pk_bf16_f32 v47, v50, v51
    v_exp_f32 v52, v52
    s_setprio 2
    v_exp_f32 v53, v53
    v_exp_f32 v54, v54
    v_mfma_f32_32x32x16_bf16 v[100:115], v[124:127], v[44:47], v[100:115]
    v_exp_f32 v55, v55
    v_exp_f32 v56, v56
    ds_read_b64_tr_b16 v[124:125], v6 offset:2688
    ds_read_b64_tr_b16 v[126:127], v6 offset:3136
    v_exp_f32 v57, v57
    v_exp_f32 v58, v58
    v_exp_f32 v59, v59
    s_waitcnt lgkmcnt(2)
    v_mfma_f32_32x32x4_2b_bf16 v[20:51], v[128:129], v[10:11], 0
    v_cvt_pk_bf16_f32 v52, v52, v53
    v_cvt_pk_bf16_f32 v53, v54, v55
    v_cvt_pk_bf16_f32 v54, v56, v57
    s_mul_i32 s55, s54, 24576
    s_add_u32 s55, s55, s59
    s_mov_b32 m0, s53
    s_add_u32 s54, s54, 1
    s_and_b32 s54, s54, 15
    s_add_u32 s53, s53, 24576
    s_cmp_ge_u32 s53, s57
    s_cselect_b32 s53, s56, s53
    buffer_load_dwordx4 v7, s[28:31], s55 offen offset:0 sc1 lds
    v_cvt_pk_bf16_f32 v55, v58, v59
    v_exp_f32 v60, v60
    v_exp_f32 v61, v61
    v_exp_f32 v62, v62
    v_exp_f32 v63, v63
    v_exp_f32 v64, v64
    v_mfma_f32_32x32x16_bf16 v[84:99], v[120:123], v[52:55], v[84:99]
    v_exp_f32 v65, v65
    v_exp_f32 v66, v66
    v_exp_f32 v67, v67
    v_cvt_pk_bf16_f32 v60, v60, v61
    buffer_load_dwordx4 v7, s[28:31], s55 offen offset:1024 sc1 lds
    v_cvt_pk_bf16_f32 v61, v62, v63
    v_cvt_pk_bf16_f32 v62, v64, v65
    v_cvt_pk_bf16_f32 v63, v66, v67
    v_exp_f32 v68, v68
    v_mfma_f32_32x32x16_bf16 v[20:35], v[116:119], v[12:15], v[20:35]
    v_exp_f32 v69, v69
    v_exp_f32 v70, v70
    v_exp_f32 v71, v71
    v_exp_f32 v72, v72
    s_waitcnt lgkmcnt(0)
    v_mfma_f32_32x32x16_bf16 v[84:99], v[124:127], v[60:63], v[84:99]
    v_exp_f32 v73, v73
    v_exp_f32 v74, v74
    s_setprio 1
    buffer_load_dwordx4 v7, s[28:31], s55 offen offset:2048 sc1 lds
    v_exp_f32 v75, v75
    v_cvt_pk_bf16_f32 v68, v68, v69
    v_cvt_pk_bf16_f32 v69, v70, v71
    v_mfma_f32_32x32x16_bf16 v[36:51], v[116:119], v[16:19], v[36:51]
    v_cvt_pk_bf16_f32 v70, v72, v73
    v_cvt_pk_bf16_f32 v71, v74, v75
    ds_read_b128 v[116:119], v4 offset:1024
    v_exp_f32 v76, v76
    v_exp_f32 v77, v77
    v_exp_f32 v78, v78
    v_exp_f32 v79, v79
    v_exp_f32 v80, v80
    v_mfma_f32_32x32x16_bf16 v[100:115], v[120:123], v[68:71], v[100:115]
    v_exp_f32 v81, v81
    v_add_u32 v6, s51, v6
    v_exp_f32 v82, v82
    ds_read_b64_tr_b16 v[120:121], v6 offset:0
    ds_read_b64_tr_b16 v[122:123], v6 offset:448
    v_exp_f32 v83, v83
    v_cvt_pk_bf16_f32 v76, v76, v77
    v_cvt_pk_bf16_f32 v77, v78, v79
    v_cvt_pk_bf16_f32 v78, v80, v81
    v_cvt_pk_bf16_f32 v79, v82, v83
    s_add_u32 s52, s52, 1
    s_cmp_eq_u32 s52, 3
    s_movk_i32 s51, 24576
    s_cselect_b32 s51, 4294918144, s51
    s_cselect_b32 s52, 0, s52
    v_exp_f32 v20, v20
    v_exp_f32 v21, v21
    v_exp_f32 v22, v22
    s_waitcnt lgkmcnt(3)
    v_mfma_f32_32x32x16_bf16 v[100:115], v[124:127], v[76:79], v[100:115]
    v_exp_f32 v23, v23
    v_exp_f32 v24, v24
    ds_read_b64_tr_b16 v[124:125], v6 offset:896
    ds_read_b64_tr_b16 v[126:127], v6 offset:1344
    v_exp_f32 v25, v25
    v_exp_f32 v26, v26
    v_exp_f32 v27, v27
    v_mfma_f32_32x32x4_2b_bf16 v[52:83], v[130:131], v[10:11], 0
    v_cvt_pk_bf16_f32 v20, v20, v21
    v_cvt_pk_bf16_f32 v21, v22, v23
    buffer_store_dwordx4 v[224:227], v7, s[28:31], s64 offen sc1
    s_add_u32 s64, s64, s65
    v_cvt_pk_bf16_f32 v22, v24, v25
    s_setprio 0
    v_cvt_pk_bf16_f32 v23, v26, v27
    v_exp_f32 v28, v28
    v_exp_f32 v29, v29
    v_exp_f32 v30, v30
    v_exp_f32 v31, v31
    v_exp_f32 v32, v32
    s_waitcnt lgkmcnt(2)
    v_mfma_f32_32x32x16_bf16 v[84:99], v[120:123], v[20:23], v[84:99]
    v_exp_f32 v33, v33
    v_exp_f32 v34, v34
    buffer_store_dwordx4 v[228:231], v7, s[28:31], s64 offen sc1
    s_add_u32 s64, s64, s65
    v_exp_f32 v35, v35
    v_cvt_pk_bf16_f32 v28, v28, v29
    v_cvt_pk_bf16_f32 v29, v30, v31
    v_cvt_pk_bf16_f32 v30, v32, v33
    v_cvt_pk_bf16_f32 v31, v34, v35
    v_exp_f32 v36, v36
    v_mfma_f32_32x32x16_bf16 v[52:67], v[116:119], v[12:15], v[52:67]
    v_exp_f32 v37, v37
    v_exp_f32 v38, v38
    v_exp_f32 v39, v39
    v_exp_f32 v40, v40
    s_waitcnt lgkmcnt(0)
    v_mfma_f32_32x32x16_bf16 v[84:99], v[124:127], v[28:31], v[84:99]
    v_exp_f32 v41, v41
    v_exp_f32 v42, v42
    v_exp_f32 v43, v43
    v_cvt_pk_bf16_f32 v36, v36, v37
    v_cvt_pk_bf16_f32 v37, v38, v39
    v_mfma_f32_32x32x16_bf16 v[68:83], v[116:119], v[16:19], v[68:83]
    v_cvt_pk_bf16_f32 v38, v40, v41
    v_cvt_pk_bf16_f32 v39, v42, v43
    v_exp_f32 v44, v44
    v_exp_f32 v45, v45
    s_waitcnt vmcnt(2)
    s_barrier
    s_setprio 3
    v_add_u32 v4, s51, v4
    v_exp_f32 v46, v46
    ds_read_b128 v[116:119], v4
    v_exp_f32 v47, v47
    v_exp_f32 v48, v48
    v_mfma_f32_32x32x16_bf16 v[100:115], v[120:123], v[36:39], v[100:115]
    v_exp_f32 v49, v49
    v_exp_f32 v50, v50
    ds_read_b64_tr_b16 v[120:121], v6 offset:1792
    ds_read_b64_tr_b16 v[122:123], v6 offset:2240
    v_exp_f32 v51, v51
    v_add_u32 v5, s51, v5
    v_cvt_pk_bf16_f32 v44, v44, v45
    ds_read2_b64 v[128:131], v5 offset0:0 offset1:224
    v_cvt_pk_bf16_f32 v45, v46, v47
    v_cvt_pk_bf16_f32 v46, v48, v49
    v_cvt_pk_bf16_f32 v47, v50, v51
    v_exp_f32 v52, v52
    s_setprio 2
    v_exp_f32 v53, v53
    v_exp_f32 v54, v54
    v_mfma_f32_32x32x16_bf16 v[100:115], v[124:127], v[44:47], v[100:115]
    v_exp_f32 v55, v55
    v_exp_f32 v56, v56
    ds_read_b64_tr_b16 v[124:125], v6 offset:2688
    ds_read_b64_tr_b16 v[126:127], v6 offset:3136
    v_exp_f32 v57, v57
    v_exp_f32 v58, v58
    v_exp_f32 v59, v59
    s_waitcnt lgkmcnt(2)
    v_mfma_f32_32x32x4_2b_bf16 v[20:51], v[128:129], v[10:11], 0
    v_cvt_pk_bf16_f32 v52, v52, v53
    v_cvt_pk_bf16_f32 v53, v54, v55
    v_cvt_pk_bf16_f32 v54, v56, v57
    s_mul_i32 s55, s54, 24576
    s_add_u32 s55, s55, s59
    s_mov_b32 m0, s53
    s_add_u32 s54, s54, 1
    s_and_b32 s54, s54, 15
    s_add_u32 s53, s53, 24576
    s_cmp_ge_u32 s53, s57
    s_cselect_b32 s53, s56, s53
    buffer_load_dwordx4 v7, s[28:31], s55 offen offset:0 sc1 lds
    v_cvt_pk_bf16_f32 v55, v58, v59
    v_exp_f32 v60, v60
    v_exp_f32 v61, v61
    v_exp_f32 v62, v62
    v_exp_f32 v63, v63
    v_exp_f32 v64, v64
    v_mfma_f32_32x32x16_bf16 v[84:99], v[120:123], v[52:55], v[84:99]
    v_exp_f32 v65, v65
    v_exp_f32 v66, v66
    v_exp_f32 v67, v67
    v_cvt_pk_bf16_f32 v60, v60, v61
    buffer_load_dwordx4 v7, s[28:31], s55 offen offset:1024 sc1 lds
    v_cvt_pk_bf16_f32 v61, v62, v63
    v_cvt_pk_bf16_f32 v62, v64, v65
    v_cvt_pk_bf16_f32 v63, v66, v67
    v_exp_f32 v68, v68
    v_mfma_f32_32x32x16_bf16 v[20:35], v[116:119], v[12:15], v[20:35]
    v_exp_f32 v69, v69
    v_exp_f32 v70, v70
    v_exp_f32 v71, v71
    v_exp_f32 v72, v72
    s_waitcnt lgkmcnt(0)
    v_mfma_f32_32x32x16_bf16 v[84:99], v[124:127], v[60:63], v[84:99]
    v_exp_f32 v73, v73
    v_exp_f32 v74, v74
    s_setprio 1
    buffer_load_dwordx4 v7, s[28:31], s55 offen offset:2048 sc1 lds
    v_exp_f32 v75, v75
    v_cvt_pk_bf16_f32 v68, v68, v69
    v_cvt_pk_bf16_f32 v69, v70, v71
    v_mfma_f32_32x32x16_bf16 v[36:51], v[116:119], v[16:19], v[36:51]
    v_cvt_pk_bf16_f32 v70, v72, v73
    v_cvt_pk_bf16_f32 v71, v74, v75
    ds_read_b128 v[116:119], v4 offset:1024
    v_exp_f32 v76, v76
    v_exp_f32 v77, v77
    v_exp_f32 v78, v78
    v_exp_f32 v79, v79
    v_exp_f32 v80, v80
    v_mfma_f32_32x32x16_bf16 v[100:115], v[120:123], v[68:71], v[100:115]
    v_exp_f32 v81, v81
    v_add_u32 v6, s51, v6
    v_exp_f32 v82, v82
    ds_read_b64_tr_b16 v[120:121], v6 offset:0
    ds_read_b64_tr_b16 v[122:123], v6 offset:448
    v_exp_f32 v83, v83
    v_cvt_pk_bf16_f32 v76, v76, v77
    v_cvt_pk_bf16_f32 v77, v78, v79
    v_cvt_pk_bf16_f32 v78, v80, v81
    v_cvt_pk_bf16_f32 v79, v82, v83
    s_add_u32 s52, s52, 1
    s_cmp_eq_u32 s52, 3
    s_movk_i32 s51, 24576
    s_cselect_b32 s51, 4294918144, s51
    s_cselect_b32 s52, 0, s52
    v_exp_f32 v20, v20
    v_exp_f32 v21, v21
    v_exp_f32 v22, v22
    s_waitcnt lgkmcnt(3)
    v_mfma_f32_32x32x16_bf16 v[100:115], v[124:127], v[76:79], v[100:115]
    v_exp_f32 v23, v23
    v_exp_f32 v24, v24
    ds_read_b64_tr_b16 v[124:125], v6 offset:896
    ds_read_b64_tr_b16 v[126:127], v6 offset:1344
    v_exp_f32 v25, v25
    v_exp_f32 v26, v26
    v_exp_f32 v27, v27
    v_mfma_f32_32x32x4_2b_bf16 v[52:83], v[130:131], v[10:11], 0
    v_cvt_pk_bf16_f32 v20, v20, v21
    v_cvt_pk_bf16_f32 v21, v22, v23
    v_cvt_pk_bf16_f32 v22, v24, v25
    s_setprio 0
    v_cvt_pk_bf16_f32 v23, v26, v27
    v_exp_f32 v28, v28
    v_exp_f32 v29, v29
    v_exp_f32 v30, v30
    v_exp_f32 v31, v31
    v_exp_f32 v32, v32
    s_waitcnt lgkmcnt(2)
    v_mfma_f32_32x32x16_bf16 v[84:99], v[120:123], v[20:23], v[84:99]
    v_exp_f32 v33, v33
    v_exp_f32 v34, v34
    v_exp_f32 v35, v35
    v_cvt_pk_bf16_f32 v28, v28, v29
    v_cvt_pk_bf16_f32 v29, v30, v31
    v_cvt_pk_bf16_f32 v30, v32, v33
    v_cvt_pk_bf16_f32 v31, v34, v35
    v_exp_f32 v36, v36
    v_mfma_f32_32x32x16_bf16 v[52:67], v[116:119], v[12:15], v[52:67]
    v_exp_f32 v37, v37
    v_exp_f32 v38, v38
    v_exp_f32 v39, v39
    v_exp_f32 v40, v40
    s_waitcnt lgkmcnt(0)
    v_mfma_f32_32x32x16_bf16 v[84:99], v[124:127], v[28:31], v[84:99]
    v_exp_f32 v41, v41
    v_exp_f32 v42, v42
    v_exp_f32 v43, v43
    v_cvt_pk_bf16_f32 v36, v36, v37
    v_cvt_pk_bf16_f32 v37, v38, v39
    v_mfma_f32_32x32x16_bf16 v[68:83], v[116:119], v[16:19], v[68:83]
    v_cvt_pk_bf16_f32 v38, v40, v41
    v_cvt_pk_bf16_f32 v39, v42, v43
    v_exp_f32 v44, v44
    v_exp_f32 v45, v45
    s_waitcnt vmcnt(0)
    s_barrier
    s_setprio 3
    v_add_u32 v4, s51, v4
    v_exp_f32 v46, v46
    ds_read_b128 v[116:119], v4
    v_exp_f32 v47, v47
    v_exp_f32 v48, v48
    v_mfma_f32_32x32x16_bf16 v[100:115], v[120:123], v[36:39], v[100:115]
    v_exp_f32 v49, v49
    v_exp_f32 v50, v50
    ds_read_b64_tr_b16 v[120:121], v6 offset:1792
    ds_read_b64_tr_b16 v[122:123], v6 offset:2240
    v_exp_f32 v51, v51
    v_add_u32 v5, s51, v5
    v_cvt_pk_bf16_f32 v44, v44, v45
    ds_read2_b64 v[128:131], v5 offset0:0 offset1:224
    v_cvt_pk_bf16_f32 v45, v46, v47
    v_cvt_pk_bf16_f32 v46, v48, v49
    v_cvt_pk_bf16_f32 v47, v50, v51
    v_exp_f32 v52, v52
    s_setprio 2
    v_exp_f32 v53, v53
    v_exp_f32 v54, v54
    v_mfma_f32_32x32x16_bf16 v[100:115], v[124:127], v[44:47], v[100:115]
    v_exp_f32 v55, v55
    v_exp_f32 v56, v56
    ds_read_b64_tr_b16 v[124:125], v6 offset:2688
    ds_read_b64_tr_b16 v[126:127], v6 offset:3136
    v_exp_f32 v57, v57
    v_exp_f32 v58, v58
    v_exp_f32 v59, v59
    s_waitcnt lgkmcnt(2)
    v_mfma_f32_32x32x4_2b_bf16 v[20:51], v[128:129], v[10:11], 0
    v_cvt_pk_bf16_f32 v52, v52, v53
    v_cvt_pk_bf16_f32 v53, v54, v55
    v_cvt_pk_bf16_f32 v54, v56, v57
    s_mul_i32 s55, s54, 24576
    s_add_u32 s55, s55, s59
    s_mov_b32 m0, s53
    s_add_u32 s54, s54, 1
    s_and_b32 s54, s54, 15
    s_add_u32 s53, s53, 24576
    s_cmp_ge_u32 s53, s57
    s_cselect_b32 s53, s56, s53
    buffer_load_dwordx4 v7, s[28:31], s55 offen offset:0 sc1 lds
    v_cvt_pk_bf16_f32 v55, v58, v59
    v_exp_f32 v60, v60
    v_exp_f32 v61, v61
    v_exp_f32 v62, v62
    v_exp_f32 v63, v63
    v_exp_f32 v64, v64
    v_mfma_f32_32x32x16_bf16 v[84:99], v[120:123], v[52:55], v[84:99]
    v_exp_f32 v65, v65
    v_exp_f32 v66, v66
    v_exp_f32 v67, v67
    v_cvt_pk_bf16_f32 v60, v60, v61
    buffer_load_dwordx4 v7, s[28:31], s55 offen offset:1024 sc1 lds
    v_cvt_pk_bf16_f32 v61, v62, v63
    v_cvt_pk_bf16_f32 v62, v64, v65
    v_cvt_pk_bf16_f32 v63, v66, v67
    v_exp_f32 v68, v68
    v_mfma_f32_32x32x16_bf16 v[20:35], v[116:119], v[12:15], v[20:35]
    v_exp_f32 v69, v69
    v_exp_f32 v70, v70
    v_exp_f32 v71, v71
    v_exp_f32 v72, v72
    s_waitcnt lgkmcnt(0)
    v_mfma_f32_32x32x16_bf16 v[84:99], v[124:127], v[60:63], v[84:99]
    v_exp_f32 v73, v73
    v_exp_f32 v74, v74
    s_setprio 1
    buffer_load_dwordx4 v7, s[28:31], s55 offen offset:2048 sc1 lds
    v_exp_f32 v75, v75
    v_cvt_pk_bf16_f32 v68, v68, v69
    v_cvt_pk_bf16_f32 v69, v70, v71
    v_mfma_f32_32x32x16_bf16 v[36:51], v[116:119], v[16:19], v[36:51]
    v_cvt_pk_bf16_f32 v70, v72, v73
    v_cvt_pk_bf16_f32 v71, v74, v75
    ds_read_b128 v[116:119], v4 offset:1024
    v_exp_f32 v76, v76
    v_exp_f32 v77, v77
    v_exp_f32 v78, v78
    v_exp_f32 v79, v79
    v_exp_f32 v80, v80
    v_mfma_f32_32x32x16_bf16 v[100:115], v[120:123], v[68:71], v[100:115]
    v_exp_f32 v81, v81
    v_add_u32 v6, s51, v6
    v_exp_f32 v82, v82
    ds_read_b64_tr_b16 v[120:121], v6 offset:0
    ds_read_b64_tr_b16 v[122:123], v6 offset:448
    v_exp_f32 v83, v83
    v_cvt_pk_bf16_f32 v76, v76, v77
    v_cvt_pk_bf16_f32 v77, v78, v79
    v_cvt_pk_bf16_f32 v78, v80, v81
    v_cvt_pk_bf16_f32 v79, v82, v83
    v_mov_b32 v2, 1
    v_mov_b32 v3, 3592
    s_waitcnt lgkmcnt(0)
    s_mov_b64 exec, 1
    ds_add_rtn_u32 v2, v3, v2
    s_waitcnt lgkmcnt(0)
    s_mov_b64 exec, -1
    v_readfirstlane_b32 s40, v2
    s_cmp_lg_u32 s40, 7
    s_cbranch_scc1 Lq2
    s_mul_i32 s37, s2, 128
    s_add_u32 s37, s37, 262144
    v_mov_b32 v2, s35
    v_mov_b32 v3, 0
    s_mov_b64 s[44:45], exec
    s_mov_b64 exec, 1
    buffer_store_dword v2, v3, s[28:31], s37 offen sc1
    s_mov_b64 exec, s[44:45]
Lq2:
    s_add_u32 s52, s52, 1
    s_cmp_eq_u32 s52, 3
    s_movk_i32 s51, 24576
    s_cselect_b32 s51, 4294918144, s51
    s_cselect_b32 s52, 0, s52
    v_exp_f32 v20, v20
    v_exp_f32 v21, v21
    v_exp_f32 v22, v22
    s_waitcnt lgkmcnt(3)
    v_mfma_f32_32x32x16_bf16 v[100:115], v[124:127], v[76:79], v[100:115]
    v_exp_f32 v23, v23
    v_exp_f32 v24, v24
    ds_read_b64_tr_b16 v[124:125], v6 offset:896
    ds_read_b64_tr_b16 v[126:127], v6 offset:1344
    v_exp_f32 v25, v25
    v_exp_f32 v26, v26
    v_exp_f32 v27, v27
    v_mfma_f32_32x32x4_2b_bf16 v[52:83], v[130:131], v[10:11], 0
    v_cvt_pk_bf16_f32 v20, v20, v21
    v_cvt_pk_bf16_f32 v21, v22, v23
    v_cvt_pk_bf16_f32 v22, v24, v25
    s_setprio 0
    v_cvt_pk_bf16_f32 v23, v26, v27
    v_exp_f32 v28, v28
    v_exp_f32 v29, v29
    v_exp_f32 v30, v30
    v_exp_f32 v31, v31
    v_exp_f32 v32, v32
    s_waitcnt lgkmcnt(2)
    v_mfma_f32_32x32x16_bf16 v[84:99], v[120:123], v[20:23], v[84:99]
    v_exp_f32 v33, v33
    v_exp_f32 v34, v34
    v_exp_f32 v35, v35
    v_cvt_pk_bf16_f32 v28, v28, v29
    v_cvt_pk_bf16_f32 v29, v30, v31
    v_cvt_pk_bf16_f32 v30, v32, v33
    v_cvt_pk_bf16_f32 v31, v34, v35
    v_exp_f32 v36, v36
    v_mfma_f32_32x32x16_bf16 v[52:67], v[116:119], v[12:15], v[52:67]
    v_exp_f32 v37, v37
    v_exp_f32 v38, v38
    v_exp_f32 v39, v39
    v_exp_f32 v40, v40
    s_waitcnt lgkmcnt(0)
    v_mfma_f32_32x32x16_bf16 v[84:99], v[124:127], v[28:31], v[84:99]
    v_exp_f32 v41, v41
    v_exp_f32 v42, v42
    v_exp_f32 v43, v43
    v_cvt_pk_bf16_f32 v36, v36, v37
    v_cvt_pk_bf16_f32 v37, v38, v39
    v_mfma_f32_32x32x16_bf16 v[68:83], v[116:119], v[16:19], v[68:83]
    v_cvt_pk_bf16_f32 v38, v40, v41
    v_cvt_pk_bf16_f32 v39, v42, v43
    v_exp_f32 v44, v44
    v_exp_f32 v45, v45
    s_waitcnt vmcnt(0)
    s_barrier
    s_setprio 3
    v_add_u32 v4, s51, v4
    v_exp_f32 v46, v46
    ds_read_b128 v[116:119], v4
    v_exp_f32 v47, v47
    v_exp_f32 v48, v48
    v_mfma_f32_32x32x16_bf16 v[100:115], v[120:123], v[36:39], v[100:115]
    v_exp_f32 v49, v49
    v_exp_f32 v50, v50
    ds_read_b64_tr_b16 v[120:121], v6 offset:1792
    ds_read_b64_tr_b16 v[122:123], v6 offset:2240
    v_exp_f32 v51, v51
    v_add_u32 v5, s51, v5
    v_cvt_pk_bf16_f32 v44, v44, v45
    ds_read2_b64 v[128:131], v5 offset0:0 offset1:224
    v_cvt_pk_bf16_f32 v45, v46, v47
    v_cvt_pk_bf16_f32 v46, v48, v49
    v_cvt_pk_bf16_f32 v47, v50, v51
    v_exp_f32 v52, v52
    s_setprio 2
    v_exp_f32 v53, v53
    v_exp_f32 v54, v54
    v_mfma_f32_32x32x16_bf16 v[100:115], v[124:127], v[44:47], v[100:115]
    v_exp_f32 v55, v55
    v_exp_f32 v56, v56
    ds_read_b64_tr_b16 v[124:125], v6 offset:2688
    ds_read_b64_tr_b16 v[126:127], v6 offset:3136
    v_exp_f32 v57, v57
    v_exp_f32 v58, v58
    v_exp_f32 v59, v59
    s_waitcnt lgkmcnt(2)
    v_mfma_f32_32x32x4_2b_bf16 v[20:51], v[128:129], v[10:11], 0
    v_cvt_pk_bf16_f32 v52, v52, v53
    v_cvt_pk_bf16_f32 v53, v54, v55
    v_cvt_pk_bf16_f32 v54, v56, v57
    s_mul_i32 s55, s54, 24576
    s_add_u32 s55, s55, s59
    s_mov_b32 m0, s53
    s_add_u32 s54, s54, 1
    s_and_b32 s54, s54, 15
    s_add_u32 s53, s53, 24576
    s_cmp_ge_u32 s53, s57
    s_cselect_b32 s53, s56, s53
    buffer_load_dwordx4 v7, s[28:31], s55 offen offset:0 sc1 lds
    v_cvt_pk_bf16_f32 v55, v58, v59
    v_exp_f32 v60, v60
    v_exp_f32 v61, v61
    v_exp_f32 v62, v62
    v_exp_f32 v63, v63
    v_exp_f32 v64, v64
    v_mfma_f32_32x32x16_bf16 v[84:99], v[120:123], v[52:55], v[84:99]
    v_exp_f32 v65, v65
    v_exp_f32 v66, v66
    v_exp_f32 v67, v67
    v_cvt_pk_bf16_f32 v60, v60, v61
    buffer_load_dwordx4 v7, s[28:31], s55 offen offset:1024 sc1 lds
    v_cvt_pk_bf16_f32 v61, v62, v63
    v_cvt_pk_bf16_f32 v62, v64, v65
    v_cvt_pk_bf16_f32 v63, v66, v67
    v_exp_f32 v68, v68
    v_mfma_f32_32x32x16_bf16 v[20:35], v[116:119], v[12:15], v[20:35]
    v_exp_f32 v69, v69
    v_exp_f32 v70, v70
    v_exp_f32 v71, v71
    v_exp_f32 v72, v72
    s_waitcnt lgkmcnt(0)
    v_mfma_f32_32x32x16_bf16 v[84:99], v[124:127], v[60:63], v[84:99]
    v_exp_f32 v73, v73
    v_exp_f32 v74, v74
    s_setprio 1
    buffer_load_dwordx4 v7, s[28:31], s55 offen offset:2048 sc1 lds
    v_exp_f32 v75, v75
    v_cvt_pk_bf16_f32 v68, v68, v69
    v_cvt_pk_bf16_f32 v69, v70, v71
    v_mfma_f32_32x32x16_bf16 v[36:51], v[116:119], v[16:19], v[36:51]
    v_cvt_pk_bf16_f32 v70, v72, v73
    v_cvt_pk_bf16_f32 v71, v74, v75
    ds_read_b128 v[116:119], v4 offset:1024
    v_exp_f32 v76, v76
    v_exp_f32 v77, v77
    v_exp_f32 v78, v78
    v_exp_f32 v79, v79
    v_exp_f32 v80, v80
    v_mfma_f32_32x32x16_bf16 v[100:115], v[120:123], v[68:71], v[100:115]
    v_exp_f32 v81, v81
    v_add_u32 v6, s51, v6
    v_exp_f32 v82, v82
    ds_read_b64_tr_b16 v[120:121], v6 offset:0
    ds_read_b64_tr_b16 v[122:123], v6 offset:448
    v_exp_f32 v83, v83
    v_cvt_pk_bf16_f32 v76, v76, v77
    v_cvt_pk_bf16_f32 v77, v78, v79
    v_cvt_pk_bf16_f32 v78, v80, v81
    v_cvt_pk_bf16_f32 v79, v82, v83
    s_mov_b32 s42, 0x40000
    v_lshlrev_b32 v132, 7, v1
    s_cmp_lg_u32 s32, 7
    s_cbranch_scc1 Lfr0
    buffer_load_dword v136, v132, s[28:31], s42 offen sc1
    v_add_u32 v132, 8192, v132
    buffer_load_dword v137, v132, s[28:31], s42 offen sc1
    v_add_u32 v132, 8192, v132
    buffer_load_dword v138, v132, s[28:31], s42 offen sc1
    v_add_u32 v132, 8192, v132
    buffer_load_dword v139, v132, s[28:31], s42 offen sc1
    v_add_u32 v132, 8192, v132
    v_add_u32 v132, 0xffff8000, v132
Lfr0:
    s_add_u32 s52, s52, 1
    s_cmp_eq_u32 s52, 3
    s_movk_i32 s51, 24576
    s_cselect_b32 s51, 4294918144, s51
    s_cselect_b32 s52, 0, s52
    v_exp_f32 v20, v20
    v_exp_f32 v21, v21
    v_exp_f32 v22, v22
    s_waitcnt lgkmcnt(3)
    v_mfma_f32_32x32x16_bf16 v[100:115], v[124:127], v[76:79], v[100:115]
    v_exp_f32 v23, v23
    v_exp_f32 v24, v24
    ds_read_b64_tr_b16 v[124:125], v6 offset:896
    ds_read_b64_tr_b16 v[126:127], v6 offset:1344
    v_exp_f32 v25, v25
    v_exp_f32 v26, v26
    v_exp_f32 v27, v27
    v_mfma_f32_32x32x4_2b_bf16 v[52:83], v[130:131], v[10:11], 0
    v_cvt_pk_bf16_f32 v20, v20, v21
    v_cvt_pk_bf16_f32 v21, v22, v23
    v_cvt_pk_bf16_f32 v22, v24, v25
    s_setprio 0
    v_cvt_pk_bf16_f32 v23, v26, v27
    v_exp_f32 v28, v28
    v_exp_f32 v29, v29
    v_exp_f32 v30, v30
    v_exp_f32 v31, v31
    v_exp_f32 v32, v32
    s_waitcnt lgkmcnt(2)
    v_mfma_f32_32x32x16_bf16 v[84:99], v[120:123], v[20:23], v[84:99]
    v_exp_f32 v33, v33
    v_exp_f32 v34, v34
    v_exp_f32 v35, v35
    v_cvt_pk_bf16_f32 v28, v28, v29
    v_cvt_pk_bf16_f32 v29, v30, v31
    v_cvt_pk_bf16_f32 v30, v32, v33
    v_cvt_pk_bf16_f32 v31, v34, v35
    v_exp_f32 v36, v36
    v_mfma_f32_32x32x16_bf16 v[52:67], v[116:119], v[12:15], v[52:67]
    v_exp_f32 v37, v37
    v_exp_f32 v38, v38
    v_exp_f32 v39, v39
    v_exp_f32 v40, v40
    s_waitcnt lgkmcnt(0)
    v_mfma_f32_32x32x16_bf16 v[84:99], v[124:127], v[28:31], v[84:99]
    v_exp_f32 v41, v41
    v_exp_f32 v42, v42
    v_exp_f32 v43, v43
    v_cvt_pk_bf16_f32 v36, v36, v37
    v_cvt_pk_bf16_f32 v37, v38, v39
    v_mfma_f32_32x32x16_bf16 v[68:83], v[116:119], v[16:19], v[68:83]
    v_cvt_pk_bf16_f32 v38, v40, v41
    v_cvt_pk_bf16_f32 v39, v42, v43
    v_exp_f32 v44, v44
    v_exp_f32 v45, v45
    s_waitcnt vmcnt(0)
    s_barrier
    s_setprio 3
    v_add_u32 v4, s51, v4
    v_exp_f32 v46, v46
    ds_read_b128 v[116:119], v4
    v_exp_f32 v47, v47
    v_exp_f32 v48, v48
    v_mfma_f32_32x32x16_bf16 v[100:115], v[120:123], v[36:39], v[100:115]
    v_exp_f32 v49, v49
    v_exp_f32 v50, v50
    ds_read_b64_tr_b16 v[120:121], v6 offset:1792
    ds_read_b64_tr_b16 v[122:123], v6 offset:2240
    v_exp_f32 v51, v51
    v_add_u32 v5, s51, v5
    v_cvt_pk_bf16_f32 v44, v44, v45
    ds_read2_b64 v[128:131], v5 offset0:0 offset1:224
    v_cvt_pk_bf16_f32 v45, v46, v47
    v_cvt_pk_bf16_f32 v46, v48, v49
    v_cvt_pk_bf16_f32 v47, v50, v51
    v_exp_f32 v52, v52
    s_setprio 2
    v_exp_f32 v53, v53
    v_exp_f32 v54, v54
    v_mfma_f32_32x32x16_bf16 v[100:115], v[124:127], v[44:47], v[100:115]
    v_exp_f32 v55, v55
    v_exp_f32 v56, v56
    ds_read_b64_tr_b16 v[124:125], v6 offset:2688
    ds_read_b64_tr_b16 v[126:127], v6 offset:3136
    v_exp_f32 v57, v57
    v_exp_f32 v58, v58
    v_exp_f32 v59, v59
    s_waitcnt lgkmcnt(2)
    v_mfma_f32_32x32x4_2b_bf16 v[20:51], v[128:129], v[10:11], 0
    v_cvt_pk_bf16_f32 v52, v52, v53
    v_cvt_pk_bf16_f32 v53, v54, v55
    v_cvt_pk_bf16_f32 v54, v56, v57
    s_mul_i32 s55, s54, 24576
    s_add_u32 s55, s55, s59
    s_mov_b32 m0, s53
    s_add_u32 s54, s54, 1
    s_and_b32 s54, s54, 15
    s_add_u32 s53, s53, 24576
    s_cmp_ge_u32 s53, s57
    s_cselect_b32 s53, s56, s53
    buffer_load_dwordx4 v7, s[28:31], s55 offen offset:0 sc1 lds
    v_cvt_pk_bf16_f32 v55, v58, v59
    v_exp_f32 v60, v60
    v_exp_f32 v61, v61
    v_exp_f32 v62, v62
    v_exp_f32 v63, v63
    v_exp_f32 v64, v64
    v_mfma_f32_32x32x16_bf16 v[84:99], v[120:123], v[52:55], v[84:99]
    v_exp_f32 v65, v65
    v_exp_f32 v66, v66
    v_exp_f32 v67, v67
    v_cvt_pk_bf16_f32 v60, v60, v61
    buffer_load_dwordx4 v7, s[28:31], s55 offen offset:1024 sc1 lds
    v_cvt_pk_bf16_f32 v61, v62, v63
    v_cvt_pk_bf16_f32 v62, v64, v65
    v_cvt_pk_bf16_f32 v63, v66, v67
    v_exp_f32 v68, v68
    v_mfma_f32_32x32x16_bf16 v[20:35], v[116:119], v[12:15], v[20:35]
    v_exp_f32 v69, v69
    v_exp_f32 v70, v70
    v_exp_f32 v71, v71
    v_exp_f32 v72, v72
    s_waitcnt lgkmcnt(0)
    v_mfma_f32_32x32x16_bf16 v[84:99], v[124:127], v[60:63], v[84:99]
    v_exp_f32 v73, v73
    v_exp_f32 v74, v74
    s_setprio 1
    buffer_load_dwordx4 v7, s[28:31], s55 offen offset:2048 sc1 lds
    v_exp_f32 v75, v75
    v_cvt_pk_bf16_f32 v68, v68, v69
    v_cvt_pk_bf16_f32 v69, v70, v71
    v_mfma_f32_32x32x16_bf16 v[36:51], v[116:119], v[16:19], v[36:51]
    v_cvt_pk_bf16_f32 v70, v72, v73
    v_cvt_pk_bf16_f32 v71, v74, v75
    ds_read_b128 v[116:119], v4 offset:1024
    v_exp_f32 v76, v76
    v_exp_f32 v77, v77
    v_exp_f32 v78, v78
    v_exp_f32 v79, v79
    v_exp_f32 v80, v80
    v_mfma_f32_32x32x16_bf16 v[100:115], v[120:123], v[68:71], v[100:115]
    v_exp_f32 v81, v81
    v_add_u32 v6, s51, v6
    v_exp_f32 v82, v82
    ds_read_b64_tr_b16 v[120:121], v6 offset:0
    ds_read_b64_tr_b16 v[122:123], v6 offset:448
    v_exp_f32 v83, v83
    v_cvt_pk_bf16_f32 v76, v76, v77
    v_cvt_pk_bf16_f32 v77, v78, v79
    v_cvt_pk_bf16_f32 v78, v80, v81
    v_cvt_pk_bf16_f32 v79, v82, v83
    s_cmp_lg_u32 s32, 7
    s_cbranch_scc1 Lfr2
    s_mov_b32 s46, 30000
Lfr1:
    v_xor_b32 v136, s35, v136
    v_xor_b32 v137, s35, v137
    v_xor_b32 v138, s35, v138
    v_xor_b32 v139, s35, v139
    v_or3_b32 v136, v136, v137, v138
    v_or_b32 v136, v136, v139
    v_cmp_ne_u32 vcc, 0, v136
    s_cbranch_vccz Lfr2
    buffer_load_dword v136, v132, s[28:31], s42 offen sc1
    v_add_u32 v132, 8192, v132
    buffer_load_dword v137, v132, s[28:31], s42 offen sc1
    v_add_u32 v132, 8192, v132
    buffer_load_dword v138, v132, s[28:31], s42 offen sc1
    v_add_u32 v132, 8192, v132
    buffer_load_dword v139, v132, s[28:31], s42 offen sc1
    v_add_u32 v132, 8192, v132
    v_add_u32 v132, 0xffff8000, v132
    s_waitcnt vmcnt(0)
    s_sub_u32 s46, s46, 1
    s_cmp_gt_i32 s46, 0
    s_cbranch_scc1 Lfr1
Lfr2:
    s_and_b32 s37, s43, 7
    s_and_b32 s38, s32, 3
    s_mul_i32 s60, s37, 100
    s_add_u32 s60, s60, s38
    s_lshl_b32 s60, s60, 10
    s_add_u32 s60, s60, 0x1700000
    s_mul_i32 s61, s37, 270
    s_lshl_b32 s38, s38, 1
    s_add_u32 s61, s61, s38
    s_lshl_b32 s61, s61, 10
    s_add_u32 s61, s61, 0x1800000
    s_sub_u32 s62, s61, s60
    s_lshr_b32 s63, s32, 2
    s_add_u32 s52, s52, 1
    s_cmp_eq_u32 s52, 3
    s_movk_i32 s51, 24576
    s_cselect_b32 s51, 4294918144, s51
    s_cselect_b32 s52, 0, s52
    v_exp_f32 v20, v20
    v_exp_f32 v21, v21
    v_exp_f32 v22, v22
    s_waitcnt lgkmcnt(3)
    v_mfma_f32_32x32x16_bf16 v[100:115], v[124:127], v[76:79], v[100:115]
    v_exp_f32 v23, v23
    v_exp_f32 v24, v24
    ds_read_b64_tr_b16 v[124:125], v6 offset:896
    ds_read_b64_tr_b16 v[126:127], v6 offset:1344
    v_exp_f32 v25, v25
    v_exp_f32 v26, v26
    v_exp_f32 v27, v27
    v_mfma_f32_32x32x4_2b_bf16 v[52:83], v[130:131], v[10:11], 0
    v_cvt_pk_bf16_f32 v20, v20, v21
    v_cvt_pk_bf16_f32 v21, v22, v23
    v_cvt_pk_bf16_f32 v22, v24, v25
    s_setprio 0
    v_cvt_pk_bf16_f32 v23, v26, v27
    v_exp_f32 v28, v28
    v_exp_f32 v29, v29
    v_exp_f32 v30, v30
    v_exp_f32 v31, v31
    v_exp_f32 v32, v32
    s_waitcnt lgkmcnt(2)
    v_mfma_f32_32x32x16_bf16 v[84:99], v[120:123], v[20:23], v[84:99]
    v_exp_f32 v33, v33
    v_exp_f32 v34, v34
    v_exp_f32 v35, v35
    v_cvt_pk_bf16_f32 v28, v28, v29
    v_cvt_pk_bf16_f32 v29, v30, v31
    v_cvt_pk_bf16_f32 v30, v32, v33
    v_cvt_pk_bf16_f32 v31, v34, v35
    v_exp_f32 v36, v36
    v_mfma_f32_32x32x16_bf16 v[52:67], v[116:119], v[12:15], v[52:67]
    v_exp_f32 v37, v37
    v_exp_f32 v38, v38
    v_exp_f32 v39, v39
    v_exp_f32 v40, v40
    s_waitcnt lgkmcnt(0)
    v_mfma_f32_32x32x16_bf16 v[84:99], v[124:127], v[28:31], v[84:99]
    v_exp_f32 v41, v41
    v_exp_f32 v42, v42
    v_exp_f32 v43, v43
    v_cvt_pk_bf16_f32 v36, v36, v37
    v_cvt_pk_bf16_f32 v37, v38, v39
    v_mfma_f32_32x32x16_bf16 v[68:83], v[116:119], v[16:19], v[68:83]
    v_cvt_pk_bf16_f32 v38, v40, v41
    v_cvt_pk_bf16_f32 v39, v42, v43
    v_exp_f32 v44, v44
    v_exp_f32 v45, v45
    s_waitcnt vmcnt(0)
    s_barrier
    s_cmp_lt_u32 s32, 4
    s_cbranch_scc1 Ls2a
    s_cmp_ge_u32 s2, 216
    s_cbranch_scc1 Ls2a
    s_and_b32 s37, s2, 1
    s_lshl_b32 s37, s37, 2
    s_add_u32 s37, s37, s32
    s_mul_i32 s37, s37, 320
    s_add_u32 s37, s37, 0x60f00
    v_min_u32 v132, 39, v1
    v_cmp_lt_u32 vcc, 19, v132
    v_lshlrev_b32 v132, 4, v132
    v_mov_b32 v133, 0xfffff4c0
    v_cndmask_b32 v133, 0, v133, vcc
    v_add_u32 v132, v132, v133
    v_add_u32 v132, s37, v132
    s_mov_b32 s37, 0
    buffer_load_dwordx4 v[216:219], v132, s[28:31], s37 offen sc1
    s_add_u32 s37, s37, 10240
    buffer_load_dwordx4 v[220:223], v132, s[28:31], s37 offen sc1
    s_add_u32 s37, s37, 10240
    buffer_load_dwordx4 v[224:227], v132, s[28:31], s37 offen sc1
    s_add_u32 s37, s37, 10240
    buffer_load_dwordx4 v[228:231], v132, s[28:31], s37 offen sc1
    s_add_u32 s37, s37, 10240
    buffer_load_dwordx4 v[232:235], v132, s[28:31], s37 offen sc1
    s_add_u32 s37, s37, 10240
Ls2a:
    s_setprio 3
    v_add_u32 v4, s51, v4
    v_exp_f32 v46, v46
    ds_read_b128 v[116:119], v4
    v_exp_f32 v47, v47
    v_exp_f32 v48, v48
    v_mfma_f32_32x32x16_bf16 v[100:115], v[120:123], v[36:39], v[100:115]
    v_exp_f32 v49, v49
    v_exp_f32 v50, v50
    ds_read_b64_tr_b16 v[120:121], v6 offset:1792
    ds_read_b64_tr_b16 v[122:123], v6 offset:2240
    v_exp_f32 v51, v51
    v_add_u32 v5, s51, v5
    v_cvt_pk_bf16_f32 v44, v44, v45
    ds_read2_b64 v[128:131], v5 offset0:0 offset1:224
    v_cvt_pk_bf16_f32 v45, v46, v47
    v_cvt_pk_bf16_f32 v46, v48, v49
    v_cvt_pk_bf16_f32 v47, v50, v51
    v_exp_f32 v52, v52
    s_setprio 2
    v_exp_f32 v53, v53
    v_exp_f32 v54, v54
    v_mfma_f32_32x32x16_bf16 v[100:115], v[124:127], v[44:47], v[100:115]
    v_exp_f32 v55, v55
    v_exp_f32 v56, v56
    ds_read_b64_tr_b16 v[124:125], v6 offset:2688
    ds_read_b64_tr_b16 v[126:127], v6 offset:3136
    v_exp_f32 v57, v57
    v_exp_f32 v58, v58
    v_exp_f32 v59, v59
    s_waitcnt lgkmcnt(2)
    v_mfma_f32_32x32x4_2b_bf16 v[20:51], v[128:129], v[10:11], 0
    v_cvt_pk_bf16_f32 v52, v52, v53
    v_cvt_pk_bf16_f32 v53, v54, v55
    v_cvt_pk_bf16_f32 v54, v56, v57
    s_mul_i32 s55, s54, 24576
    s_add_u32 s55, s55, s59
    s_mov_b32 m0, s53
    s_add_u32 s54, s54, 1
    s_and_b32 s54, s54, 15
    s_add_u32 s53, s53, 24576
    s_cmp_ge_u32 s53, s57
    s_cselect_b32 s53, s56, s53
    buffer_load_dwordx4 v7, s[28:31], s55 offen offset:0 sc1 lds
    v_cvt_pk_bf16_f32 v55, v58, v59
    v_exp_f32 v60, v60
    v_exp_f32 v61, v61
    v_exp_f32 v62, v62
    v_exp_f32 v63, v63
    v_exp_f32 v64, v64
    v_mfma_f32_32x32x16_bf16 v[84:99], v[120:123], v[52:55], v[84:99]
    v_exp_f32 v65, v65
    v_exp_f32 v66, v66
    v_exp_f32 v67, v67
    v_cvt_pk_bf16_f32 v60, v60, v61
    buffer_load_dwordx4 v7, s[28:31], s55 offen offset:1024 sc1 lds
    v_cvt_pk_bf16_f32 v61, v62, v63
    v_cvt_pk_bf16_f32 v62, v64, v65
    v_cvt_pk_bf16_f32 v63, v66, v67
    v_exp_f32 v68, v68
    v_mfma_f32_32x32x16_bf16 v[20:35], v[116:119], v[12:15], v[20:35]
    v_exp_f32 v69, v69
    v_exp_f32 v70, v70
    v_exp_f32 v71, v71
    v_exp_f32 v72, v72
    s_waitcnt lgkmcnt(0)
    v_mfma_f32_32x32x16_bf16 v[84:99], v[124:127], v[60:63], v[84:99]
    v_exp_f32 v73, v73
    v_exp_f32 v74, v74
    s_setprio 1
    buffer_load_dwordx4 v7, s[28:31], s55 offen offset:2048 sc1 lds
    v_exp_f32 v75, v75
    v_cvt_pk_bf16_f32 v68, v68, v69
    v_cvt_pk_bf16_f32 v69, v70, v71
    v_mfma_f32_32x32x16_bf16 v[36:51], v[116:119], v[16:19], v[36:51]
    v_cvt_pk_bf16_f32 v70, v72, v73
    v_cvt_pk_bf16_f32 v71, v74, v75
    ds_read_b128 v[116:119], v4 offset:1024
    v_exp_f32 v76, v76
    v_exp_f32 v77, v77
    s_cmp_lg_u32 s63, 0
    s_mov_b32 s41, 0x0
    s_cmov_b32 s41, 0xf000
    s_add_u32 s41, s41, s60
    buffer_load_dwordx4 v[136:139], v7, s[28:31], s41 offen sc1
    v_exp_f32 v78, v78
    v_exp_f32 v79, v79
    v_exp_f32 v80, v80
    v_mfma_f32_32x32x16_bf16 v[100:115], v[120:123], v[68:71], v[100:115]
    v_exp_f32 v81, v81
    v_add_u32 v6, s51, v6
    v_exp_f32 v82, v82
    ds_read_b64_tr_b16 v[120:121], v6 offset:0
    ds_read_b64_tr_b16 v[122:123], v6 offset:448
    v_exp_f32 v83, v83
    v_cvt_pk_bf16_f32 v76, v76, v77
    v_cvt_pk_bf16_f32 v77, v78, v79
    s_cmp_lg_u32 s63, 0
    s_mov_b32 s41, 0x5000
    s_cmov_b32 s41, 0x14000
    s_add_u32 s41, s41, s60
    buffer_load_dwordx4 v[140:143], v7, s[28:31], s41 offen sc1
    v_cvt_pk_bf16_f32 v78, v80, v81
    v_cvt_pk_bf16_f32 v79, v82, v83
    s_add_u32 s52, s52, 1
    s_cmp_eq_u32 s52, 3
    s_movk_i32 s51, 24576
    s_cselect_b32 s51, 4294918144, s51
    s_cselect_b32 s52, 0, s52
    v_exp_f32 v20, v20
    v_exp_f32 v21, v21
    v_exp_f32 v22, v22
    s_waitcnt lgkmcnt(3)
    v_mfma_f32_32x32x16_bf16 v[100:115], v[124:127], v[76:79], v[100:115]
    v_exp_f32 v23, v23
    v_exp_f32 v24, v24
    ds_read_b64_tr_b16 v[124:125], v6 offset:896
    ds_read_b64_tr_b16 v[126:127], v6 offset:1344
    v_exp_f32 v25, v25
    v_exp_f32 v26, v26
    v_exp_f32 v27, v27
    v_mfma_f32_32x32x4_2b_bf16 v[52:83], v[130:131], v[10:11], 0
    v_cvt_pk_bf16_f32 v20, v20, v21
    v_cvt_pk_bf16_f32 v21, v22, v23
    s_cmp_lg_u32 s63, 0
    s_mov_b32 s41, 0xa000
    s_cmov_b32 s41, 0x10000
    s_add_u32 s41, s41, s60
    buffer_load_dwordx4 v[144:147], v7, s[28:31], s41 offen sc1
    v_cvt_pk_bf16_f32 v22, v24, v25
    s_setprio 0
    v_cvt_pk_bf16_f32 v23, v26, v27
    v_exp_f32 v28, v28
    v_exp_f32 v29, v29
    v_exp_f32 v30, v30
    v_exp_f32 v31, v31
    v_exp_f32 v32, v32
    s_waitcnt lgkmcnt(2)
    v_mfma_f32_32x32x16_bf16 v[84:99], v[120:123], v[20:23], v[84:99]
    v_exp_f32 v33, v33
    v_exp_f32 v34, v34
    s_cmp_lg_u32 s63, 0
    s_mov_b32 s41, 0x1000
    s_cmov_b32 s41, 0x15000
    s_add_u32 s41, s41, s60
    buffer_load_dwordx4 v[148:151], v7, s[28:31], s41 offen sc1
    v_exp_f32 v35, v35
    v_cvt_pk_bf16_f32 v28, v28, v29
    v_cvt_pk_bf16_f32 v29, v30, v31
    v_cvt_pk_bf16_f32 v30, v32, v33
    v_cvt_pk_bf16_f32 v31, v34, v35
    v_exp_f32 v36, v36
    v_mfma_f32_32x32x16_bf16 v[52:67], v[116:119], v[12:15], v[52:67]
    v_exp_f32 v37, v37
    v_exp_f32 v38, v38
    s_cmp_lg_u32 s63, 0
    s_mov_b32 s41, 0x6000
    s_cmov_b32 s41, 0x11000
    s_add_u32 s41, s41, s60
    buffer_load_dwordx4 v[152:155], v7, s[28:31], s41 offen sc1
    v_exp_f32 v39, v39
    v_exp_f32 v40, v40
    s_waitcnt lgkmcnt(0)
    v_mfma_f32_32x32x16_bf16 v[84:99], v[124:127], v[28:31], v[84:99]
    v_exp_f32 v41, v41
    v_exp_f32 v42, v42
    v_exp_f32 v43, v43
    s_cmp_lg_u32 s63, 0
    s_mov_b32 s41, 0xb000
    s_cmov_b32 s41, 0x16000
    s_add_u32 s41, s41, s60
    buffer_load_dwordx4 v[156:159], v7, s[28:31], s41 offen sc1
    v_cvt_pk_bf16_f32 v36, v36, v37
    v_cvt_pk_bf16_f32 v37, v38, v39
    v_mfma_f32_32x32x16_bf16 v[68:83], v[116:119], v[16:19], v[68:83]
    v_cvt_pk_bf16_f32 v38, v40, v41
    v_cvt_pk_bf16_f32 v39, v42, v43
    v_exp_f32 v44, v44
    v_exp_f32 v45, v45
    s_waitcnt vmcnt(6)
    s_barrier
    s_cmp_lt_u32 s32, 4
    s_cbranch_scc1 Ls2b
    s_cmp_ge_u32 s2, 216
    s_cbranch_scc1 Ls2b
    s_mul_i32 s37, s2, 20
    s_mul_i32 s38, s32, 5
    s_add_u32 s37, s37, s38
    s_lshl_b32 s37, s37, 10
    s_add_u32 s37, s37, 0x1afb000
    buffer_load_dwordx4 v[236:239], v7, s[28:31], s37 offen offset:0 sc1
    buffer_load_dwordx4 v[240:243], v7, s[28:31], s37 offen offset:1024 sc1
    buffer_load_dwordx4 v[244:247], v7, s[28:31], s37 offen offset:2048 sc1
    buffer_load_dwordx4 v[248:251], v7, s[28:31], s37 offen offset:3072 sc1
    s_add_u32 s37, s37, 4096
    buffer_load_dwordx4 v[252:255], v7, s[28:31], s37 offen sc1
Ls2b:
    s_setprio 3
    v_add_u32 v4, s51, v4
    v_exp_f32 v46, v46
    ds_read_b128 v[116:119], v4
    v_exp_f32 v47, v47
    v_exp_f32 v48, v48
    v_mfma_f32_32x32x16_bf16 v[100:115], v[120:123], v[36:39], v[100:115]
    v_exp_f32 v49, v49
    v_exp_f32 v50, v50
    ds_read_b64_tr_b16 v[120:121], v6 offset:1792
    ds_read_b64_tr_b16 v[122:123], v6 offset:2240
    v_exp_f32 v51, v51
    v_add_u32 v5, s51, v5
    v_cvt_pk_bf16_f32 v44, v44, v45
    ds_read2_b64 v[128:131], v5 offset0:0 offset1:224
    v_cvt_pk_bf16_f32 v45, v46, v47
    v_cvt_pk_bf16_f32 v46, v48, v49
    v_cvt_pk_bf16_f32 v47, v50, v51
    v_exp_f32 v52, v52
    s_setprio 2
    v_exp_f32 v53, v53
    v_exp_f32 v54, v54
    v_mfma_f32_32x32x16_bf16 v[100:115], v[124:127], v[44:47], v[100:115]
    v_exp_f32 v55, v55
    v_exp_f32 v56, v56
    ds_read_b64_tr_b16 v[124:125], v6 offset:2688
    ds_read_b64_tr_b16 v[126:127], v6 offset:3136
    v_exp_f32 v57, v57
    v_exp_f32 v58, v58
    v_exp_f32 v59, v59
    s_waitcnt lgkmcnt(2)
    v_mfma_f32_32x32x4_2b_bf16 v[20:51], v[128:129], v[10:11], 0
    v_cvt_pk_bf16_f32 v52, v52, v53
    v_cvt_pk_bf16_f32 v53, v54, v55
    v_cvt_pk_bf16_f32 v54, v56, v57
    s_mul_i32 s55, s54, 24576
    s_add_u32 s55, s55, s59
    s_mov_b32 m0, s53
    s_add_u32 s54, s54, 1
    s_and_b32 s54, s54, 15
    s_add_u32 s53, s53, 24576
    s_cmp_ge_u32 s53, s57
    s_cselect_b32 s53, s56, s53
    buffer_load_dwordx4 v7, s[28:31], s55 offen offset:0 sc1 lds
    v_cvt_pk_bf16_f32 v55, v58, v59
    v_exp_f32 v60, v60
    v_exp_f32 v61, v61
    v_exp_f32 v62, v62
    v_exp_f32 v63, v63
    v_exp_f32 v64, v64
    v_mfma_f32_32x32x16_bf16 v[84:99], v[120:123], v[52:55], v[84:99]
    v_exp_f32 v65, v65
    v_exp_f32 v66, v66
    v_exp_f32 v67, v67
    v_cvt_pk_bf16_f32 v60, v60, v61
    buffer_load_dwordx4 v7, s[28:31], s55 offen offset:1024 sc1 lds
    v_cvt_pk_bf16_f32 v61, v62, v63
    v_cvt_pk_bf16_f32 v62, v64, v65
    v_cvt_pk_bf16_f32 v63, v66, v67
    v_exp_f32 v68, v68
    v_mfma_f32_32x32x16_bf16 v[20:35], v[116:119], v[12:15], v[20:35]
    v_exp_f32 v69, v69
    v_exp_f32 v70, v70
    v_exp_f32 v71, v71
    v_exp_f32 v72, v72
    s_waitcnt lgkmcnt(0)
    v_mfma_f32_32x32x16_bf16 v[84:99], v[124:127], v[60:63], v[84:99]
    v_exp_f32 v73, v73
    v_exp_f32 v74, v74
    s_setprio 1
    buffer_load_dwordx4 v7, s[28:31], s55 offen offset:2048 sc1 lds
    v_exp_f32 v75, v75
    v_cvt_pk_bf16_f32 v68, v68, v69
    v_cvt_pk_bf16_f32 v69, v70, v71
    v_mfma_f32_32x32x16_bf16 v[36:51], v[116:119], v[16:19], v[36:51]
    v_cvt_pk_bf16_f32 v70, v72, v73
    v_cvt_pk_bf16_f32 v71, v74, v75
    ds_read_b128 v[116:119], v4 offset:1024
    v_exp_f32 v76, v76
    v_exp_f32 v77, v77
    s_cmp_lg_u32 s63, 0
    s_mov_b32 s41, 0x2000
    s_cmov_b32 s41, 0x12000
    s_add_u32 s41, s41, s60
    buffer_load_dwordx4 v[160:163], v7, s[28:31], s41 offen sc1
    v_exp_f32 v78, v78
    v_exp_f32 v79, v79
    v_exp_f32 v80, v80
    v_mfma_f32_32x32x16_bf16 v[100:115], v[120:123], v[68:71], v[100:115]
    v_exp_f32 v81, v81
    v_add_u32 v6, s51, v6
    v_exp_f32 v82, v82
    ds_read_b64_tr_b16 v[120:121], v6 offset:0
    ds_read_b64_tr_b16 v[122:123], v6 offset:448
    v_exp_f32 v83, v83
    v_cvt_pk_bf16_f32 v76, v76, v77
    v_cvt_pk_bf16_f32 v77, v78, v79
    s_cmp_lg_u32 s63, 0
    s_mov_b32 s41, 0x7000
    s_cmov_b32 s41, 0x17000
    s_add_u32 s41, s41, s60
    buffer_load_dwordx4 v[164:167], v7, s[28:31], s41 offen sc1
    v_cvt_pk_bf16_f32 v78, v80, v81
    v_cvt_pk_bf16_f32 v79, v82, v83
    s_add_u32 s52, s52, 1
    s_cmp_eq_u32 s52, 3
    s_movk_i32 s51, 24576
    s_cselect_b32 s51, 4294918144, s51
    s_cselect_b32 s52, 0, s52
    v_exp_f32 v20, v20
    v_exp_f32 v21, v21
    v_exp_f32 v22, v22
    s_waitcnt lgkmcnt(3)
    v_mfma_f32_32x32x16_bf16 v[100:115], v[124:127], v[76:79], v[100:115]
    v_exp_f32 v23, v23
    v_exp_f32 v24, v24
    ds_read_b64_tr_b16 v[124:125], v6 offset:896
    ds_read_b64_tr_b16 v[126:127], v6 offset:1344
    v_exp_f32 v25, v25
    v_exp_f32 v26, v26
    v_exp_f32 v27, v27
    v_mfma_f32_32x32x4_2b_bf16 v[52:83], v[130:131], v[10:11], 0
    v_cvt_pk_bf16_f32 v20, v20, v21
    v_cvt_pk_bf16_f32 v21, v22, v23
    s_cmp_lg_u32 s63, 0
    s_mov_b32 s41, 0xc000
    s_cmov_b32 s41, 0x13000
    s_add_u32 s41, s41, s60
    buffer_load_dwordx4 v[168:171], v7, s[28:31], s41 offen sc1
    v_cvt_pk_bf16_f32 v22, v24, v25
    s_setprio 0
    v_cvt_pk_bf16_f32 v23, v26, v27
    v_exp_f32 v28, v28
    v_exp_f32 v29, v29
    v_exp_f32 v30, v30
    v_exp_f32 v31, v31
    v_exp_f32 v32, v32
    s_waitcnt lgkmcnt(2)
    v_mfma_f32_32x32x16_bf16 v[84:99], v[120:123], v[20:23], v[84:99]
    v_exp_f32 v33, v33
    v_exp_f32 v34, v34
    s_cmp_lg_u32 s63, 0
    s_mov_b32 s41, 0x3000
    s_cmov_b32 s41, 0x18000
    s_add_u32 s41, s41, s60
    buffer_load_dwordx4 v[172:175], v7, s[28:31], s41 offen sc1
    v_exp_f32 v35, v35
    v_cvt_pk_bf16_f32 v28, v28, v29
    v_cvt_pk_bf16_f32 v29, v30, v31
    v_cvt_pk_bf16_f32 v30, v32, v33
    v_cvt_pk_bf16_f32 v31, v34, v35
    v_exp_f32 v36, v36
    v_mfma_f32_32x32x16_bf16 v[52:67], v[116:119], v[12:15], v[52:67]
    v_exp_f32 v37, v37
    v_exp_f32 v38, v38
    s_cmp_lg_u32 s63, 0
    s_mov_b32 s41, 0x8000
    s_cmov_b32 s41, 0x28800
    s_cselect_b32 s40, s61, s60
    s_add_u32 s41, s41, s40
    buffer_load_dwordx4 v[176:179], v7, s[28:31], s41 offen sc1
    v_exp_f32 v39, v39
    v_exp_f32 v40, v40
    s_waitcnt lgkmcnt(0)
    v_mfma_f32_32x32x16_bf16 v[84:99], v[124:127], v[28:31], v[84:99]
    v_exp_f32 v41, v41
    v_exp_f32 v42, v42
    v_exp_f32 v43, v43
    s_cmp_lg_u32 s63, 0
    s_mov_b32 s41, 0xd000
    s_cmov_b32 s41, 0x36000
    s_cselect_b32 s40, s61, s60
    s_add_u32 s41, s41, s40
    buffer_load_dwordx4 v[180:183], v7, s[28:31], s41 offen sc1
    v_cvt_pk_bf16_f32 v36, v36, v37
    v_cvt_pk_bf16_f32 v37, v38, v39
    v_mfma_f32_32x32x16_bf16 v[68:83], v[116:119], v[16:19], v[68:83]
    v_cvt_pk_bf16_f32 v38, v40, v41
    v_cvt_pk_bf16_f32 v39, v42, v43
    v_exp_f32 v44, v44
    v_exp_f32 v45, v45
    s_waitcnt vmcnt(6)
    s_barrier
    s_setprio 3
    v_add_u32 v4, s51, v4
    v_exp_f32 v46, v46
    ds_read_b128 v[116:119], v4
    v_exp_f32 v47, v47
    v_exp_f32 v48, v48
    v_mfma_f32_32x32x16_bf16 v[100:115], v[120:123], v[36:39], v[100:115]
    v_exp_f32 v49, v49
    v_exp_f32 v50, v50
    ds_read_b64_tr_b16 v[120:121], v6 offset:1792
    ds_read_b64_tr_b16 v[122:123], v6 offset:2240
    v_exp_f32 v51, v51
    v_add_u32 v5, s51, v5
    v_cvt_pk_bf16_f32 v44, v44, v45
    ds_read2_b64 v[128:131], v5 offset0:0 offset1:224
    v_cvt_pk_bf16_f32 v45, v46, v47
    v_cvt_pk_bf16_f32 v46, v48, v49
    v_cvt_pk_bf16_f32 v47, v50, v51
    v_exp_f32 v52, v52
    s_setprio 2
    v_exp_f32 v53, v53
    v_exp_f32 v54, v54
    v_mfma_f32_32x32x16_bf16 v[100:115], v[124:127], v[44:47], v[100:115]
    v_exp_f32 v55, v55
    v_exp_f32 v56, v56
    ds_read_b64_tr_b16 v[124:125], v6 offset:2688
    ds_read_b64_tr_b16 v[126:127], v6 offset:3136
    v_exp_f32 v57, v57
    v_exp_f32 v58, v58
    v_exp_f32 v59, v59
    s_waitcnt lgkmcnt(2)
    v_mfma_f32_32x32x4_2b_bf16 v[20:51], v[128:129], v[10:11], 0
    v_cvt_pk_bf16_f32 v52, v52, v53
    v_cvt_pk_bf16_f32 v53, v54, v55
    v_cvt_pk_bf16_f32 v54, v56, v57
    s_mul_i32 s55, s54, 24576
    s_add_u32 s55, s55, s59
    s_mov_b32 m0, s53
    s_add_u32 s54, s54, 1
    s_and_b32 s54, s54, 15
    s_add_u32 s53, s53, 24576
    s_cmp_ge_u32 s53, s57
    s_cselect_b32 s53, s56, s53
    buffer_load_dwordx4 v7, s[28:31], s55 offen offset:0 sc1 lds
    v_cvt_pk_bf16_f32 v55, v58, v59
    v_exp_f32 v60, v60
    v_exp_f32 v61, v61
    v_exp_f32 v62, v62
    v_exp_f32 v63, v63
    v_exp_f32 v64, v64
    v_mfma_f32_32x32x16_bf16 v[84:99], v[120:123], v[52:55], v[84:99]
    v_exp_f32 v65, v65
    v_exp_f32 v66, v66
    v_exp_f32 v67, v67
    v_cvt_pk_bf16_f32 v60, v60, v61
    buffer_load_dwordx4 v7, s[28:31], s55 offen offset:1024 sc1 lds
    v_cvt_pk_bf16_f32 v61, v62, v63
    v_cvt_pk_bf16_f32 v62, v64, v65
    v_cvt_pk_bf16_f32 v63, v66, v67
    v_exp_f32 v68, v68
    v_mfma_f32_32x32x16_bf16 v[20:35], v[116:119], v[12:15], v[20:35]
    v_exp_f32 v69, v69
    v_exp_f32 v70, v70
    v_exp_f32 v71, v71
    v_exp_f32 v72, v72
    s_waitcnt lgkmcnt(0)
    v_mfma_f32_32x32x16_bf16 v[84:99], v[124:127], v[60:63], v[84:99]
    v_exp_f32 v73, v73
    v_exp_f32 v74, v74
    s_setprio 1
    buffer_load_dwordx4 v7, s[28:31], s55 offen offset:2048 sc1 lds
    v_exp_f32 v75, v75
    v_cvt_pk_bf16_f32 v68, v68, v69
    v_cvt_pk_bf16_f32 v69, v70, v71
    v_mfma_f32_32x32x16_bf16 v[36:51], v[116:119], v[16:19], v[36:51]
    v_cvt_pk_bf16_f32 v70, v72, v73
    v_cvt_pk_bf16_f32 v71, v74, v75
    ds_read_b128 v[116:119], v4 offset:1024
    v_exp_f32 v76, v76
    v_exp_f32 v77, v77
    s_cmp_lg_u32 s63, 0
    s_mov_b32 s41, 0x4000
    s_cmov_b32 s41, 0x28c00
    s_cselect_b32 s40, s61, s60
    s_add_u32 s41, s41, s40
    buffer_load_dwordx4 v[184:187], v7, s[28:31], s41 offen sc1
    v_exp_f32 v78, v78
    v_exp_f32 v79, v79
    v_exp_f32 v80, v80
    v_mfma_f32_32x32x16_bf16 v[100:115], v[120:123], v[68:71], v[100:115]
    v_exp_f32 v81, v81
    v_add_u32 v6, s51, v6
    v_exp_f32 v82, v82
    ds_read_b64_tr_b16 v[120:121], v6 offset:0
    ds_read_b64_tr_b16 v[122:123], v6 offset:448
    v_exp_f32 v83, v83
    v_cvt_pk_bf16_f32 v76, v76, v77
    v_cvt_pk_bf16_f32 v77, v78, v79
    s_cmp_lg_u32 s63, 0
    s_mov_b32 s41, 0x9000
    s_cmov_b32 s41, 0x36400
    s_cselect_b32 s40, s61, s60
    s_add_u32 s41, s41, s40
    buffer_load_dwordx4 v[188:191], v7, s[28:31], s41 offen sc1
    v_cvt_pk_bf16_f32 v78, v80, v81
    v_cvt_pk_bf16_f32 v79, v82, v83
    s_mov_b32 s67, 0
    s_cmp_lt_u32 s32, 4
    s_cbranch_scc1 Lu2
    s_cmp_ge_u32 s2, 216
    s_cbranch_scc1 Lu2
    v_add_f32 v216, v216, v220
    v_add_f32 v224, v224, v228
    v_add_f32 v216, v216, v232
    v_add_f32 v216, v216, v224
    v_add_f32 v217, v217, v221
    v_add_f32 v225, v225, v229
    v_add_f32 v217, v217, v233
    v_add_f32 v217, v217, v225
    v_add_f32 v218, v218, v222
    v_add_f32 v226, v226, v230
    v_add_f32 v218, v218, v234
    v_add_f32 v218, v218, v226
    v_add_f32 v219, v219, v223
    v_add_f32 v227, v227, v231
    v_add_f32 v219, v219, v235
    v_add_f32 v219, v219, v227
    v_cmp_gt_u32 vcc, 20, v1
    v_mov_b32 v224, 1.0
    v_min_u32 v132, 39, v1
    v_cndmask_b32 v224, 0, v224, vcc
    v_cvt_pk_bf16_f32 v2, v216, v217
    v_lshlrev_b32 v216, 16, v2
    v_and_b32 v217, 0xffff0000, v2
    v_add_f32 v216, v216, v224
    v_add_f32 v217, v217, v224
    v_cvt_pk_bf16_f32 v220, v216, v217
    v_cvt_pk_bf16_f32 v2, v218, v219
    v_lshlrev_b32 v218, 16, v2
    v_and_b32 v219, 0xffff0000, v2
    v_add_f32 v218, v218, v224
    v_add_f32 v219, v219, v224
    v_cvt_pk_bf16_f32 v221, v218, v219
    s_lshl_b32 s37, s32, 9
    s_add_u32 s37, s37, 20480
    v_lshrrev_b32 v133, 2, v132
    v_lshl_add_u32 v133, v133, 5, s37
    v_and_b32 v2, 1, v132
    v_lshl_add_u32 v133, v2, 4, v133
    v_bfe_u32 v2, v132, 1, 1
    v_lshl_add_u32 v133, v2, 3, v133
    ds_write_b64 v133, v[220:221]
    v_and_b32 v2, 31, v1
    v_lshrrev_b32 v3, 5, v1
    v_lshl_add_u32 v132, v3, 4, s37
    v_mul_u32_u24 v133, 160, v2
    v_add_u32 v132, v132, v133
    v_cmp_gt_u32 vcc, 2, v2
    s_waitcnt lgkmcnt(0)
    v_mov_b32 v216, 0
    v_mov_b32 v217, 0
    v_mov_b32 v218, 0
    v_mov_b32 v219, 0
    v_mov_b32 v220, 0
    v_mov_b32 v221, 0
    v_mov_b32 v222, 0
    v_mov_b32 v223, 0
    v_mov_b32 v224, 0
    v_mov_b32 v225, 0
    v_mov_b32 v226, 0
    v_mov_b32 v227, 0
    v_mov_b32 v228, 0
    v_mov_b32 v229, 0
    v_mov_b32 v230, 0
    v_mov_b32 v231, 0
    v_mov_b32 v232, 0
    v_mov_b32 v233, 0
    v_mov_b32 v234, 0
    v_mov_b32 v235, 0
    s_and_saveexec_b64 s[44:45], vcc
    ds_read_b128 v[216:219], v132 offset:0
    ds_read_b128 v[220:223], v132 offset:32
    ds_read_b128 v[224:227], v132 offset:64
    ds_read_b128 v[228:231], v132 offset:96
    ds_read_b128 v[232:235], v132 offset:128
    s_mov_b64 exec, s[44:45]
    s_waitcnt lgkmcnt(0)
    v_mfma_f32_32x32x16_bf16 v[200:215], v[236:239], v[216:219], 0
    v_mfma_f32_32x32x16_bf16 v[200:215], v[240:243], v[220:223], v[200:215]
    v_mfma_f32_32x32x16_bf16 v[200:215], v[244:247], v[224:227], v[200:215]
    v_mfma_f32_32x32x16_bf16 v[200:215], v[248:251], v[228:231], v[200:215]
    v_mfma_f32_32x32x16_bf16 v[200:215], v[252:255], v[232:235], v[200:215]
    s_lshl_b32 s37, s32, 8
    s_add_u32 s37, s37, 23552
    v_lshl_add_u32 v132, v2, 7, s37
    v_lshl_add_u32 v132, v3, 4, v132
    s_nop 7
    s_and_saveexec_b64 s[44:45], vcc
    ds_write_b128 v132, v[200:203] offset:0
    ds_write_b128 v132, v[204:207] offset:32
    ds_write_b128 v132, v[208:211] offset:64
    ds_write_b128 v132, v[212:215] offset:96
    s_mov_b64 exec, s[44:45]
    v_mov_b32 v2, 1
    v_mov_b32 v3, 3596
    s_waitcnt lgkmcnt(0)
    s_mov_b64 exec, 1
    ds_add_rtn_u32 v2, v3, v2
    s_waitcnt lgkmcnt(0)
    s_mov_b64 exec, -1
    v_readfirstlane_b32 s40, v2
    s_cmp_lg_u32 s40, 3
    s_cbranch_scc1 Lu2
    v_lshlrev_b32 v2, 2, v1
    v_add_u32 v2, 24576, v2
    ds_read2st64_b32 v[200:201], v2 offset0:0 offset1:1
    ds_read2st64_b32 v[202:203], v2 offset0:2 offset1:3
    s_waitcnt lgkmcnt(0)
    v_add_f32 v200, v200, v202
    v_add_f32 v201, v201, v203
    v_add_f32 v200, v200, v201
    v_mov_b32 v201, v200
    s_nop 1
    v_permlane32_swap_b32 v200, v201
    v_cvt_pk_bf16_f32 v202, v200, v200
    v_and_b32 v202, 0xffff0000, v202
    v_sub_f32 v204, v200, v202
    v_cvt_pk_bf16_f32 v203, v201, v201
    v_and_b32 v203, 0xffff0000, v203
    v_sub_f32 v205, v201, v203
    v_cvt_pk_bf16_f32 v208, v202, v204
    v_cvt_pk_bf16_f32 v209, v202, v203
    v_cvt_pk_bf16_f32 v210, v205, v203
    v_mov_b32 v211, 0
    s_lshl_b32 s37, s2, 9
    s_add_u32 s37, s37, 0x2000000
    s_mov_b32 exec_hi, 0
    buffer_store_dwordx4 v[208:211], v7, s[28:31], s37 offen sc1
    s_mov_b32 exec_hi, -1
    s_mov_b32 s67, 1
    s_nop 0
Lu2:
    s_add_u32 s52, s52, 1
    s_cmp_eq_u32 s52, 3
    s_movk_i32 s51, 24576
    s_cselect_b32 s51, 4294918144, s51
    s_cselect_b32 s52, 0, s52
    v_exp_f32 v20, v20
    v_exp_f32 v21, v21
    v_exp_f32 v22, v22
    s_waitcnt lgkmcnt(3)
    v_mfma_f32_32x32x16_bf16 v[100:115], v[124:127], v[76:79], v[100:115]
    v_exp_f32 v23, v23
    v_exp_f32 v24, v24
    ds_read_b64_tr_b16 v[124:125], v6 offset:896
    ds_read_b64_tr_b16 v[126:127], v6 offset:1344
    v_exp_f32 v25, v25
    v_exp_f32 v26, v26
    v_exp_f32 v27, v27
    v_mfma_f32_32x32x4_2b_bf16 v[52:83], v[130:131], v[10:11], 0
    v_cvt_pk_bf16_f32 v20, v20, v21
    v_cvt_pk_bf16_f32 v21, v22, v23
    s_cmp_lg_u32 s63, 0
    s_mov_b32 s41, 0xe000
    s_cmov_b32 s41, 0x2a800
    s_cselect_b32 s40, s61, s60
    s_add_u32 s41, s41, s40
    buffer_load_dwordx4 v[192:195], v7, s[28:31], s41 offen sc1
    v_cvt_pk_bf16_f32 v22, v24, v25
    s_setprio 0
    v_cvt_pk_bf16_f32 v23, v26, v27
    v_exp_f32 v28, v28
    v_exp_f32 v29, v29
    v_exp_f32 v30, v30
    v_exp_f32 v31, v31
    v_exp_f32 v32, v32
    s_waitcnt lgkmcnt(2)
    v_mfma_f32_32x32x16_bf16 v[84:99], v[120:123], v[20:23], v[84:99]
    v_exp_f32 v33, v33
    v_exp_f32 v34, v34
    s_cmp_lg_u32 s63, 0
    s_mov_b32 s41, 0x1b400
    s_cmov_b32 s41, 0x38000
    s_add_u32 s41, s41, s61
    buffer_load_dwordx4 v[196:199], v7, s[28:31], s41 offen sc1
    v_exp_f32 v35, v35
    v_cvt_pk_bf16_f32 v28, v28, v29
    v_cvt_pk_bf16_f32 v29, v30, v31
    v_cvt_pk_bf16_f32 v30, v32, v33
    v_cvt_pk_bf16_f32 v31, v34, v35
    v_exp_f32 v36, v36
    v_mfma_f32_32x32x16_bf16 v[52:67], v[116:119], v[12:15], v[52:67]
    v_exp_f32 v37, v37
    v_exp_f32 v38, v38
    s_cmp_lg_u32 s63, 0
    s_mov_b32 s41, 0x2000
    s_cmov_b32 s41, 0x2ac00
    s_add_u32 s41, s41, s61
    buffer_load_dwordx4 v[200:203], v7, s[28:31], s41 offen sc1
    v_exp_f32 v39, v39
    v_exp_f32 v40, v40
    s_waitcnt lgkmcnt(0)
    v_mfma_f32_32x32x16_bf16 v[84:99], v[124:127], v[28:31], v[84:99]
    v_exp_f32 v41, v41
    v_exp_f32 v42, v42
    v_exp_f32 v43, v43
    s_cmp_lg_u32 s63, 0
    s_mov_b32 s41, 0xf800
    s_cmov_b32 s41, 0x38400
    s_add_u32 s41, s41, s61
    buffer_load_dwordx4 v[204:207], v7, s[28:31], s41 offen sc1
    v_cvt_pk_bf16_f32 v36, v36, v37
    v_cvt_pk_bf16_f32 v37, v38, v39
    v_mfma_f32_32x32x16_bf16 v[68:83], v[116:119], v[16:19], v[68:83]
    v_cvt_pk_bf16_f32 v38, v40, v41
    v_cvt_pk_bf16_f32 v39, v42, v43
    v_exp_f32 v44, v44
    v_exp_f32 v45, v45
    s_waitcnt vmcnt(6)
    s_barrier
    s_setprio 3
    v_add_u32 v4, s51, v4
    v_exp_f32 v46, v46
    ds_read_b128 v[116:119], v4
    v_exp_f32 v47, v47
    v_exp_f32 v48, v48
    v_mfma_f32_32x32x16_bf16 v[100:115], v[120:123], v[36:39], v[100:115]
    v_exp_f32 v49, v49
    v_exp_f32 v50, v50
    ds_read_b64_tr_b16 v[120:121], v6 offset:1792
    ds_read_b64_tr_b16 v[122:123], v6 offset:2240
    v_exp_f32 v51, v51
    v_add_u32 v5, s51, v5
    v_cvt_pk_bf16_f32 v44, v44, v45
    ds_read2_b64 v[128:131], v5 offset0:0 offset1:224
    v_cvt_pk_bf16_f32 v45, v46, v47
    v_cvt_pk_bf16_f32 v46, v48, v49
    v_cvt_pk_bf16_f32 v47, v50, v51
    v_exp_f32 v52, v52
    s_setprio 2
    v_exp_f32 v53, v53
    v_exp_f32 v54, v54
    v_mfma_f32_32x32x16_bf16 v[100:115], v[124:127], v[44:47], v[100:115]
    v_exp_f32 v55, v55
    v_exp_f32 v56, v56
    ds_read_b64_tr_b16 v[124:125], v6 offset:2688
    ds_read_b64_tr_b16 v[126:127], v6 offset:3136
    v_exp_f32 v57, v57
    v_exp_f32 v58, v58
    v_exp_f32 v59, v59
    s_waitcnt lgkmcnt(2)
    v_mfma_f32_32x32x4_2b_bf16 v[20:51], v[128:129], v[10:11], 0
    v_cvt_pk_bf16_f32 v52, v52, v53
    v_cvt_pk_bf16_f32 v53, v54, v55
    v_cvt_pk_bf16_f32 v54, v56, v57
    s_mul_i32 s55, s54, 24576
    s_add_u32 s55, s55, s59
    s_mov_b32 m0, s53
    s_add_u32 s54, s54, 1
    s_and_b32 s54, s54, 15
    s_add_u32 s53, s53, 24576
    s_cmp_ge_u32 s53, s57
    s_cselect_b32 s53, s56, s53
    buffer_load_dwordx4 v7, s[28:31], s55 offen offset:0 sc1 lds
    v_cvt_pk_bf16_f32 v55, v58, v59
    v_exp_f32 v60, v60
    v_exp_f32 v61, v61
    v_exp_f32 v62, v62
    v_exp_f32 v63, v63
    v_exp_f32 v64, v64
    v_mfma_f32_32x32x16_bf16 v[84:99], v[120:123], v[52:55], v[84:99]
    v_exp_f32 v65, v65
    v_exp_f32 v66, v66
    v_exp_f32 v67, v67
    v_cvt_pk_bf16_f32 v60, v60, v61
    buffer_load_dwordx4 v7, s[28:31], s55 offen offset:1024 sc1 lds
    v_cvt_pk_bf16_f32 v61, v62, v63
    v_cvt_pk_bf16_f32 v62, v64, v65
    v_cvt_pk_bf16_f32 v63, v66, v67
    v_exp_f32 v68, v68
    v_mfma_f32_32x32x16_bf16 v[20:35], v[116:119], v[12:15], v[20:35]
    v_exp_f32 v69, v69
    v_exp_f32 v70, v70
    v_exp_f32 v71, v71
    v_exp_f32 v72, v72
    s_waitcnt lgkmcnt(0)
    v_mfma_f32_32x32x16_bf16 v[84:99], v[124:127], v[60:63], v[84:99]
    v_exp_f32 v73, v73
    v_exp_f32 v74, v74
    s_setprio 1
    buffer_load_dwordx4 v7, s[28:31], s55 offen offset:2048 sc1 lds
    v_exp_f32 v75, v75
    v_cvt_pk_bf16_f32 v68, v68, v69
    v_cvt_pk_bf16_f32 v69, v70, v71
    v_mfma_f32_32x32x16_bf16 v[36:51], v[116:119], v[16:19], v[36:51]
    v_cvt_pk_bf16_f32 v70, v72, v73
    v_cvt_pk_bf16_f32 v71, v74, v75
    ds_read_b128 v[116:119], v4 offset:1024
    v_exp_f32 v76, v76
    v_exp_f32 v77, v77
    s_cmp_lg_u32 s63, 0
    s_mov_b32 s41, 0x1d000
    s_cmov_b32 s41, 0x2c800
    s_add_u32 s41, s41, s61
    buffer_load_dwordx4 v[208:211], v7, s[28:31], s41 offen sc1
    v_exp_f32 v78, v78
    v_exp_f32 v79, v79
    v_exp_f32 v80, v80
    v_mfma_f32_32x32x16_bf16 v[100:115], v[120:123], v[68:71], v[100:115]
    v_exp_f32 v81, v81
    v_add_u32 v6, s51, v6
    v_exp_f32 v82, v82
    ds_read_b64_tr_b16 v[120:121], v6 offset:0
    ds_read_b64_tr_b16 v[122:123], v6 offset:448
    v_exp_f32 v83, v83
    v_cvt_pk_bf16_f32 v76, v76, v77
    v_cvt_pk_bf16_f32 v77, v78, v79
    s_cmp_lg_u32 s63, 0
    s_mov_b32 s41, 0x2400
    s_cmov_b32 s41, 0x3a000
    s_add_u32 s41, s41, s61
    buffer_load_dwordx4 v[212:215], v7, s[28:31], s41 offen sc1
    v_cvt_pk_bf16_f32 v78, v80, v81
    v_cvt_pk_bf16_f32 v79, v82, v83
    s_add_u32 s52, s52, 1
    s_cmp_eq_u32 s52, 3
    s_movk_i32 s51, 24576
    s_cselect_b32 s51, 4294918144, s51
    s_cselect_b32 s52, 0, s52
    v_exp_f32 v20, v20
    v_exp_f32 v21, v21
    v_exp_f32 v22, v22
    s_waitcnt lgkmcnt(3)
    v_mfma_f32_32x32x16_bf16 v[100:115], v[124:127], v[76:79], v[100:115]
    v_exp_f32 v23, v23
    v_exp_f32 v24, v24
    ds_read_b64_tr_b16 v[124:125], v6 offset:896
    ds_read_b64_tr_b16 v[126:127], v6 offset:1344
    v_exp_f32 v25, v25
    v_exp_f32 v26, v26
    v_exp_f32 v27, v27
    v_mfma_f32_32x32x4_2b_bf16 v[52:83], v[130:131], v[10:11], 0
    v_cvt_pk_bf16_f32 v20, v20, v21
    v_cvt_pk_bf16_f32 v21, v22, v23
    s_cmp_lg_u32 s63, 0
    s_mov_b32 s41, 0xfc00
    s_cmov_b32 s41, 0x2cc00
    s_add_u32 s41, s41, s61
    buffer_load_dwordx4 v[216:219], v7, s[28:31], s41 offen sc1
    v_cvt_pk_bf16_f32 v22, v24, v25
    s_setprio 0
    v_cvt_pk_bf16_f32 v23, v26, v27
    v_exp_f32 v28, v28
    v_exp_f32 v29, v29
    v_exp_f32 v30, v30
    v_exp_f32 v31, v31
    v_exp_f32 v32, v32
    s_waitcnt lgkmcnt(2)
    v_mfma_f32_32x32x16_bf16 v[84:99], v[120:123], v[20:23], v[84:99]
    v_exp_f32 v33, v33
    v_exp_f32 v34, v34
    s_cmp_lg_u32 s63, 0
    s_mov_b32 s41, 0x1d400
    s_cmov_b32 s41, 0x3a400
    s_add_u32 s41, s41, s61
    buffer_load_dwordx4 v[220:223], v7, s[28:31], s41 offen sc1
    v_exp_f32 v35, v35
    v_cvt_pk_bf16_f32 v28, v28, v29
    v_cvt_pk_bf16_f32 v29, v30, v31
    v_cvt_pk_bf16_f32 v30, v32, v33
    v_cvt_pk_bf16_f32 v31, v34, v35
    v_exp_f32 v36, v36
    v_mfma_f32_32x32x16_bf16 v[52:67], v[116:119], v[12:15], v[52:67]
    v_exp_f32 v37, v37
    v_exp_f32 v38, v38
    s_cmp_lg_u32 s63, 0
    s_mov_b32 s41, 0x4000
    s_cmov_b32 s41, 0x2e800
    s_add_u32 s41, s41, s61
    buffer_load_dwordx4 v[224:227], v7, s[28:31], s41 offen sc1
    v_exp_f32 v39, v39
    v_exp_f32 v40, v40
    s_waitcnt lgkmcnt(0)
    v_mfma_f32_32x32x16_bf16 v[84:99], v[124:127], v[28:31], v[84:99]
    v_exp_f32 v41, v41
    v_exp_f32 v42, v42
    v_exp_f32 v43, v43
    s_cmp_lg_u32 s63, 0
    s_mov_b32 s41, 0x11800
    s_cmov_b32 s41, 0x3c000
    s_add_u32 s41, s41, s61
    buffer_load_dwordx4 v[228:231], v7, s[28:31], s41 offen sc1
    v_cvt_pk_bf16_f32 v36, v36, v37
    v_cvt_pk_bf16_f32 v37, v38, v39
    v_mfma_f32_32x32x16_bf16 v[68:83], v[116:119], v[16:19], v[68:83]
    v_cvt_pk_bf16_f32 v38, v40, v41
    v_cvt_pk_bf16_f32 v39, v42, v43
    v_exp_f32 v44, v44
    v_exp_f32 v45, v45
    s_waitcnt vmcnt(6)
    s_barrier
    s_setprio 3
    v_add_u32 v4, s51, v4
    v_exp_f32 v46, v46
    ds_read_b128 v[116:119], v4
    v_exp_f32 v47, v47
    v_exp_f32 v48, v48
    v_mfma_f32_32x32x16_bf16 v[100:115], v[120:123], v[36:39], v[100:115]
    v_exp_f32 v49, v49
    v_exp_f32 v50, v50
    ds_read_b64_tr_b16 v[120:121], v6 offset:1792
    ds_read_b64_tr_b16 v[122:123], v6 offset:2240
    v_exp_f32 v51, v51
    v_add_u32 v5, s51, v5
    v_cvt_pk_bf16_f32 v44, v44, v45
    ds_read2_b64 v[128:131], v5 offset0:0 offset1:224
    v_cvt_pk_bf16_f32 v45, v46, v47
    v_cvt_pk_bf16_f32 v46, v48, v49
    v_cvt_pk_bf16_f32 v47, v50, v51
    v_exp_f32 v52, v52
    s_setprio 2
    v_exp_f32 v53, v53
    v_exp_f32 v54, v54
    v_mfma_f32_32x32x16_bf16 v[100:115], v[124:127], v[44:47], v[100:115]
    v_exp_f32 v55, v55
    v_exp_f32 v56, v56
    ds_read_b64_tr_b16 v[124:125], v6 offset:2688
    ds_read_b64_tr_b16 v[126:127], v6 offset:3136
    v_exp_f32 v57, v57
    v_exp_f32 v58, v58
    v_exp_f32 v59, v59
    s_waitcnt lgkmcnt(2)
    v_mfma_f32_32x32x4_2b_bf16 v[20:51], v[128:129], v[10:11], 0
    v_cvt_pk_bf16_f32 v52, v52, v53
    v_cvt_pk_bf16_f32 v53, v54, v55
    v_cvt_pk_bf16_f32 v54, v56, v57
    s_mul_i32 s55, s54, 24576
    s_add_u32 s55, s55, s59
    s_mov_b32 m0, s53
    s_add_u32 s54, s54, 1
    s_and_b32 s54, s54, 15
    s_add_u32 s53, s53, 24576
    s_cmp_ge_u32 s53, s57
    s_cselect_b32 s53, s56, s53
    buffer_load_dwordx4 v7, s[28:31], s55 offen offset:0 sc1 lds
    v_cvt_pk_bf16_f32 v55, v58, v59
    v_exp_f32 v60, v60
    v_exp_f32 v61, v61
    v_exp_f32 v62, v62
    v_exp_f32 v63, v63
    v_exp_f32 v64, v64
    v_mfma_f32_32x32x16_bf16 v[84:99], v[120:123], v[52:55], v[84:99]
    v_exp_f32 v65, v65
    v_exp_f32 v66, v66
    v_exp_f32 v67, v67
    v_cvt_pk_bf16_f32 v60, v60, v61
    buffer_load_dwordx4 v7, s[28:31], s55 offen offset:1024 sc1 lds
    v_cvt_pk_bf16_f32 v61, v62, v63
    v_cvt_pk_bf16_f32 v62, v64, v65
    v_cvt_pk_bf16_f32 v63, v66, v67
    v_exp_f32 v68, v68
    v_mfma_f32_32x32x16_bf16 v[20:35], v[116:119], v[12:15], v[20:35]
    v_exp_f32 v69, v69
    v_exp_f32 v70, v70
    v_exp_f32 v71, v71
    v_exp_f32 v72, v72
    s_waitcnt lgkmcnt(0)
    v_mfma_f32_32x32x16_bf16 v[84:99], v[124:127], v[60:63], v[84:99]
    v_exp_f32 v73, v73
    v_exp_f32 v74, v74
    s_setprio 1
    buffer_load_dwordx4 v7, s[28:31], s55 offen offset:2048 sc1 lds
    v_exp_f32 v75, v75
    v_cvt_pk_bf16_f32 v68, v68, v69
    v_cvt_pk_bf16_f32 v69, v70, v71
    v_mfma_f32_32x32x16_bf16 v[36:51], v[116:119], v[16:19], v[36:51]
    v_cvt_pk_bf16_f32 v70, v72, v73
    v_cvt_pk_bf16_f32 v71, v74, v75
    ds_read_b128 v[116:119], v4 offset:1024
    v_exp_f32 v76, v76
    v_exp_f32 v77, v77
    s_cmp_lg_u32 s63, 0
    s_mov_b32 s41, 0x1f000
    s_cmov_b32 s41, 0x2ec00
    s_add_u32 s41, s41, s61
    buffer_load_dwordx4 v[232:235], v7, s[28:31], s41 offen sc1
    v_exp_f32 v78, v78
    v_exp_f32 v79, v79
    v_exp_f32 v80, v80
    v_mfma_f32_32x32x16_bf16 v[100:115], v[120:123], v[68:71], v[100:115]
    v_exp_f32 v81, v81
    v_add_u32 v6, s51, v6
    v_exp_f32 v82, v82
    ds_read_b64_tr_b16 v[120:121], v6 offset:0
    ds_read_b64_tr_b16 v[122:123], v6 offset:448
    v_exp_f32 v83, v83
    v_cvt_pk_bf16_f32 v76, v76, v77
    v_cvt_pk_bf16_f32 v77, v78, v79
    s_cmp_lg_u32 s63, 0
    s_mov_b32 s41, 0x4400
    s_cmov_b32 s41, 0x3c400
    s_add_u32 s41, s41, s61
    buffer_load_dwordx4 v[236:239], v7, s[28:31], s41 offen sc1
    v_cvt_pk_bf16_f32 v78, v80, v81
    v_cvt_pk_bf16_f32 v79, v82, v83
    s_cmp_eq_u32 s67, 0
    s_cbranch_scc1 Lu3
    s_mul_i32 s37, s2, 128
    s_add_u32 s37, s37, 229376
    v_mov_b32 v2, s35
    v_mov_b32 v3, 0
    s_mov_b64 s[44:45], exec
    s_mov_b64 exec, 1
    buffer_store_dword v2, v3, s[28:31], s37 offen sc1
    s_mov_b64 exec, s[44:45]
Lu3:
    s_add_u32 s52, s52, 1
    s_cmp_eq_u32 s52, 3
    s_movk_i32 s51, 24576
    s_cselect_b32 s51, 4294918144, s51
    s_cselect_b32 s52, 0, s52
    v_exp_f32 v20, v20
    v_exp_f32 v21, v21
    v_exp_f32 v22, v22
    s_waitcnt lgkmcnt(3)
    v_mfma_f32_32x32x16_bf16 v[100:115], v[124:127], v[76:79], v[100:115]
    v_exp_f32 v23, v23
    v_exp_f32 v24, v24
    ds_read_b64_tr_b16 v[124:125], v6 offset:896
    ds_read_b64_tr_b16 v[126:127], v6 offset:1344
    v_exp_f32 v25, v25
    v_exp_f32 v26, v26
    v_exp_f32 v27, v27
    v_mfma_f32_32x32x4_2b_bf16 v[52:83], v[130:131], v[10:11], 0
    v_cvt_pk_bf16_f32 v20, v20, v21
    v_cvt_pk_bf16_f32 v21, v22, v23
    s_cmp_lg_u32 s63, 0
    s_mov_b32 s41, 0x11c00
    s_cmov_b32 s41, 0x30800
    s_add_u32 s41, s41, s61
    buffer_load_dwordx4 v[240:243], v7, s[28:31], s41 offen sc1
    v_cvt_pk_bf16_f32 v22, v24, v25
    s_setprio 0
    v_cvt_pk_bf16_f32 v23, v26, v27
    v_exp_f32 v28, v28
    v_exp_f32 v29, v29
    v_exp_f32 v30, v30
    v_exp_f32 v31, v31
    v_exp_f32 v32, v32
    s_waitcnt lgkmcnt(2)
    v_mfma_f32_32x32x16_bf16 v[84:99], v[120:123], v[20:23], v[84:99]
    v_exp_f32 v33, v33
    v_exp_f32 v34, v34
    s_cmp_lg_u32 s63, 0
    s_mov_b32 s41, 0x1f400
    s_cmov_b32 s41, 0x3e000
    s_add_u32 s41, s41, s61
    buffer_load_dwordx4 v[244:247], v7, s[28:31], s41 offen sc1
    v_exp_f32 v35, v35
    v_cvt_pk_bf16_f32 v28, v28, v29
    v_cvt_pk_bf16_f32 v29, v30, v31
    v_cvt_pk_bf16_f32 v30, v32, v33
    v_cvt_pk_bf16_f32 v31, v34, v35
    v_exp_f32 v36, v36
    v_mfma_f32_32x32x16_bf16 v[52:67], v[116:119], v[12:15], v[52:67]
    v_exp_f32 v37, v37
    v_exp_f32 v38, v38
    s_cmp_lg_u32 s63, 0
    s_mov_b32 s41, 0x6000
    s_cmov_b32 s41, 0x30c00
    s_add_u32 s41, s41, s61
    buffer_load_dwordx4 v[248:251], v7, s[28:31], s41 offen sc1
    v_exp_f32 v39, v39
    v_exp_f32 v40, v40
    s_waitcnt lgkmcnt(0)
    v_mfma_f32_32x32x16_bf16 v[84:99], v[124:127], v[28:31], v[84:99]
    v_exp_f32 v41, v41
    v_exp_f32 v42, v42
    v_exp_f32 v43, v43
    s_cmp_lg_u32 s63, 0
    s_mov_b32 s41, 0x13800
    s_cmov_b32 s41, 0x3e400
    s_add_u32 s41, s41, s61
    buffer_load_dwordx4 v[252:255], v7, s[28:31], s41 offen sc1
    v_cvt_pk_bf16_f32 v36, v36, v37
    v_cvt_pk_bf16_f32 v37, v38, v39
    v_mfma_f32_32x32x16_bf16 v[68:83], v[116:119], v[16:19], v[68:83]
    v_cvt_pk_bf16_f32 v38, v40, v41
    v_cvt_pk_bf16_f32 v39, v42, v43
    v_exp_f32 v44, v44
    v_exp_f32 v45, v45
    s_waitcnt vmcnt(6)
    s_barrier
    s_setprio 3
    v_add_u32 v4, s51, v4
    v_exp_f32 v46, v46
    ds_read_b128 v[116:119], v4
    v_exp_f32 v47, v47
    v_exp_f32 v48, v48
    v_mfma_f32_32x32x16_bf16 v[100:115], v[120:123], v[36:39], v[100:115]
    v_exp_f32 v49, v49
    v_exp_f32 v50, v50
    ds_read_b64_tr_b16 v[120:121], v6 offset:1792
    ds_read_b64_tr_b16 v[122:123], v6 offset:2240
    v_exp_f32 v51, v51
    v_add_u32 v5, s51, v5
    v_cvt_pk_bf16_f32 v44, v44, v45
    ds_read2_b64 v[128:131], v5 offset0:0 offset1:224
    v_cvt_pk_bf16_f32 v45, v46, v47
    v_cvt_pk_bf16_f32 v46, v48, v49
    v_cvt_pk_bf16_f32 v47, v50, v51
    v_exp_f32 v52, v52
    s_setprio 2
    v_exp_f32 v53, v53
    v_exp_f32 v54, v54
    v_mfma_f32_32x32x16_bf16 v[100:115], v[124:127], v[44:47], v[100:115]
    v_exp_f32 v55, v55
    v_exp_f32 v56, v56
    ds_read_b64_tr_b16 v[124:125], v6 offset:2688
    ds_read_b64_tr_b16 v[126:127], v6 offset:3136
    v_exp_f32 v57, v57
    v_exp_f32 v58, v58
    v_exp_f32 v59, v59
    s_waitcnt lgkmcnt(2)
    v_mfma_f32_32x32x4_2b_bf16 v[20:51], v[128:129], v[10:11], 0
    v_cvt_pk_bf16_f32 v52, v52, v53
    v_cvt_pk_bf16_f32 v53, v54, v55
    v_cvt_pk_bf16_f32 v54, v56, v57
    v_cvt_pk_bf16_f32 v55, v58, v59
    v_exp_f32 v60, v60
    v_exp_f32 v61, v61
    v_exp_f32 v62, v62
    v_exp_f32 v63, v63
    v_exp_f32 v64, v64
    v_mfma_f32_32x32x16_bf16 v[84:99], v[120:123], v[52:55], v[84:99]
    v_exp_f32 v65, v65
    v_exp_f32 v66, v66
    v_exp_f32 v67, v67
    v_cvt_pk_bf16_f32 v60, v60, v61
    v_cvt_pk_bf16_f32 v61, v62, v63
    v_cvt_pk_bf16_f32 v62, v64, v65
    v_cvt_pk_bf16_f32 v63, v66, v67
    v_exp_f32 v68, v68
    v_mfma_f32_32x32x16_bf16 v[20:35], v[116:119], v[12:15], v[20:35]
    v_exp_f32 v69, v69
    v_exp_f32 v70, v70
    v_exp_f32 v71, v71
    v_exp_f32 v72, v72
    s_waitcnt lgkmcnt(0)
    v_mfma_f32_32x32x16_bf16 v[84:99], v[124:127], v[60:63], v[84:99]
    v_exp_f32 v73, v73
    v_exp_f32 v74, v74
    s_setprio 1
    v_exp_f32 v75, v75
    v_cvt_pk_bf16_f32 v68, v68, v69
    v_cvt_pk_bf16_f32 v69, v70, v71
    v_mfma_f32_32x32x16_bf16 v[36:51], v[116:119], v[16:19], v[36:51]
    v_cvt_pk_bf16_f32 v70, v72, v73
    v_cvt_pk_bf16_f32 v71, v74, v75
    ds_read_b128 v[116:119], v4 offset:1024
    v_exp_f32 v76, v76
    v_exp_f32 v77, v77
    v_exp_f32 v78, v78
    v_exp_f32 v79, v79
    v_exp_f32 v80, v80
    v_mfma_f32_32x32x16_bf16 v[100:115], v[120:123], v[68:71], v[100:115]
    v_exp_f32 v81, v81
    v_add_u32 v6, s51, v6
    v_exp_f32 v82, v82
    ds_read_b64_tr_b16 v[120:121], v6 offset:0
    ds_read_b64_tr_b16 v[122:123], v6 offset:448
    v_exp_f32 v83, v83
    v_cvt_pk_bf16_f32 v76, v76, v77
    v_cvt_pk_bf16_f32 v77, v78, v79
    v_cvt_pk_bf16_f32 v78, v80, v81
    v_cvt_pk_bf16_f32 v79, v82, v83
    s_add_u32 s52, s52, 1
    s_cmp_eq_u32 s52, 3
    s_movk_i32 s51, 24576
    s_cselect_b32 s51, 4294918144, s51
    s_cselect_b32 s52, 0, s52
    v_exp_f32 v20, v20
    v_exp_f32 v21, v21
    v_exp_f32 v22, v22
    s_waitcnt lgkmcnt(3)
    v_mfma_f32_32x32x16_bf16 v[100:115], v[124:127], v[76:79], v[100:115]
    v_exp_f32 v23, v23
    v_exp_f32 v24, v24
    ds_read_b64_tr_b16 v[124:125], v6 offset:896
    ds_read_b64_tr_b16 v[126:127], v6 offset:1344
    v_exp_f32 v25, v25
    v_exp_f32 v26, v26
    v_exp_f32 v27, v27
    v_mfma_f32_32x32x4_2b_bf16 v[52:83], v[130:131], v[10:11], 0
    v_cvt_pk_bf16_f32 v20, v20, v21
    v_cvt_pk_bf16_f32 v21, v22, v23
    v_cvt_pk_bf16_f32 v22, v24, v25
    s_setprio 0
    v_cvt_pk_bf16_f32 v23, v26, v27
    v_exp_f32 v28, v28
    v_exp_f32 v29, v29
    v_exp_f32 v30, v30
    v_exp_f32 v31, v31
    v_exp_f32 v32, v32
    s_waitcnt lgkmcnt(2)
    v_mfma_f32_32x32x16_bf16 v[84:99], v[120:123], v[20:23], v[84:99]
    v_exp_f32 v33, v33
    v_exp_f32 v34, v34
    v_exp_f32 v35, v35
    v_cvt_pk_bf16_f32 v28, v28, v29
    v_cvt_pk_bf16_f32 v29, v30, v31
    v_cvt_pk_bf16_f32 v30, v32, v33
    v_cvt_pk_bf16_f32 v31, v34, v35
    v_exp_f32 v36, v36
    v_mfma_f32_32x32x16_bf16 v[52:67], v[116:119], v[12:15], v[52:67]
    v_exp_f32 v37, v37
    v_exp_f32 v38, v38
    v_exp_f32 v39, v39
    v_exp_f32 v40, v40
    s_waitcnt lgkmcnt(0)
    v_mfma_f32_32x32x16_bf16 v[84:99], v[124:127], v[28:31], v[84:99]
    v_exp_f32 v41, v41
    v_exp_f32 v42, v42
    v_exp_f32 v43, v43
    v_cvt_pk_bf16_f32 v36, v36, v37
    v_cvt_pk_bf16_f32 v37, v38, v39
    v_mfma_f32_32x32x16_bf16 v[68:83], v[116:119], v[16:19], v[68:83]
    v_cvt_pk_bf16_f32 v38, v40, v41
    v_cvt_pk_bf16_f32 v39, v42, v43
    v_exp_f32 v44, v44
    v_exp_f32 v45, v45
    s_waitcnt vmcnt(0)
    s_barrier
    s_setprio 3
    v_add_u32 v4, s51, v4
    v_exp_f32 v46, v46
    ds_read_b128 v[116:119], v4
    v_exp_f32 v47, v47
    v_exp_f32 v48, v48
    v_mfma_f32_32x32x16_bf16 v[100:115], v[120:123], v[36:39], v[100:115]
    v_exp_f32 v49, v49
    v_exp_f32 v50, v50
    ds_read_b64_tr_b16 v[120:121], v6 offset:1792
    ds_read_b64_tr_b16 v[122:123], v6 offset:2240
    v_exp_f32 v51, v51
    v_add_u32 v5, s51, v5
    v_cvt_pk_bf16_f32 v44, v44, v45
    ds_read2_b64 v[128:131], v5 offset0:0 offset1:224
    v_cvt_pk_bf16_f32 v45, v46, v47
    v_cvt_pk_bf16_f32 v46, v48, v49
    v_cvt_pk_bf16_f32 v47, v50, v51
    v_exp_f32 v52, v52
    s_setprio 2
    v_exp_f32 v53, v53
    v_exp_f32 v54, v54
    v_mfma_f32_32x32x16_bf16 v[100:115], v[124:127], v[44:47], v[100:115]
    v_exp_f32 v55, v55
    v_exp_f32 v56, v56
    ds_read_b64_tr_b16 v[124:125], v6 offset:2688
    ds_read_b64_tr_b16 v[126:127], v6 offset:3136
    v_exp_f32 v57, v57
    v_exp_f32 v58, v58
    v_exp_f32 v59, v59
    s_waitcnt lgkmcnt(2)
    v_mfma_f32_32x32x4_2b_bf16 v[20:51], v[128:129], v[10:11], 0
    v_cvt_pk_bf16_f32 v52, v52, v53
    v_cvt_pk_bf16_f32 v53, v54, v55
    v_cvt_pk_bf16_f32 v54, v56, v57
    v_cvt_pk_bf16_f32 v55, v58, v59
    v_exp_f32 v60, v60
    v_exp_f32 v61, v61
    v_exp_f32 v62, v62
    v_exp_f32 v63, v63
    v_exp_f32 v64, v64
    v_mfma_f32_32x32x16_bf16 v[84:99], v[120:123], v[52:55], v[84:99]
    v_exp_f32 v65, v65
    v_exp_f32 v66, v66
    v_exp_f32 v67, v67
    v_cvt_pk_bf16_f32 v60, v60, v61
    v_cvt_pk_bf16_f32 v61, v62, v63
    v_cvt_pk_bf16_f32 v62, v64, v65
    v_cvt_pk_bf16_f32 v63, v66, v67
    v_exp_f32 v68, v68
    v_mfma_f32_32x32x16_bf16 v[20:35], v[116:119], v[12:15], v[20:35]
    v_exp_f32 v69, v69
    v_exp_f32 v70, v70
    v_exp_f32 v71, v71
    v_exp_f32 v72, v72
    s_waitcnt lgkmcnt(0)
    v_mfma_f32_32x32x16_bf16 v[84:99], v[124:127], v[60:63], v[84:99]
    v_exp_f32 v73, v73
    v_exp_f32 v74, v74
    s_setprio 1
    v_exp_f32 v75, v75
    v_cvt_pk_bf16_f32 v68, v68, v69
    v_cvt_pk_bf16_f32 v69, v70, v71
    v_mfma_f32_32x32x16_bf16 v[36:51], v[116:119], v[16:19], v[36:51]
    v_cvt_pk_bf16_f32 v70, v72, v73
    v_cvt_pk_bf16_f32 v71, v74, v75
    ds_read_b128 v[116:119], v4 offset:1024
    v_exp_f32 v76, v76
    v_exp_f32 v77, v77
    v_exp_f32 v78, v78
    v_exp_f32 v79, v79
    v_exp_f32 v80, v80
    v_mfma_f32_32x32x16_bf16 v[100:115], v[120:123], v[68:71], v[100:115]
    v_exp_f32 v81, v81
    v_add_u32 v6, s51, v6
    v_exp_f32 v82, v82
    ds_read_b64_tr_b16 v[120:121], v6 offset:0
    ds_read_b64_tr_b16 v[122:123], v6 offset:448
    v_exp_f32 v83, v83
    v_cvt_pk_bf16_f32 v76, v76, v77
    v_cvt_pk_bf16_f32 v77, v78, v79
    v_cvt_pk_bf16_f32 v78, v80, v81
    v_cvt_pk_bf16_f32 v79, v82, v83
    s_nop 0
    s_waitcnt lgkmcnt(0)
    v_mfma_f32_32x32x16_bf16 v[100:115], v[124:127], v[76:79], v[100:115]
    s_setprio 0
    s_mul_i32 s37, s32, 3072
    s_add_u32 s37, s37, 53248
    v_lshl_add_u32 v132, v1, 4, s37
    s_xor_b32 s38, s32, 2
    s_mul_i32 s38, s38, 3072
    s_add_u32 s38, s38, 53248
    v_lshl_add_u32 v133, v1, 4, s38
    s_nop 6
    s_cmp_lg_u32 s58, 0
    s_cbranch_scc1 Lox1a
    ds_write_b128 v132, v[100:103] offset:0
    ds_write_b128 v132, v[104:107] offset:1024
    ds_write_b128 v132, v[108:111] offset:2048
    s_branch Lox2a
Lox1a:
    ds_write_b128 v132, v[84:87] offset:0
    ds_write_b128 v132, v[88:91] offset:1024
    ds_write_b128 v132, v[92:95] offset:2048
    v_mov_b32 v84, v100
    v_mov_b32 v85, v101
    v_mov_b32 v86, v102
    v_mov_b32 v87, v103
    v_mov_b32 v88, v104
    v_mov_b32 v89, v105
    v_mov_b32 v90, v106
    v_mov_b32 v91, v107
    v_mov_b32 v92, v108
    v_mov_b32 v93, v109
    v_mov_b32 v94, v110
    v_mov_b32 v95, v111
Lox2a:
    s_waitcnt lgkmcnt(0)
    s_barrier
    ds_read_b128 v[20:23], v133 offset:0
    ds_read_b128 v[24:27], v133 offset:1024
    ds_read_b128 v[28:31], v133 offset:2048
    s_and_b32 s37, s32, 1
    s_lshl_b32 s37, s37, 1
    s_add_u32 s37, s37, s58
    s_lshl_b32 s38, s33, 2
    s_add_u32 s37, s37, s38
    s_mul_i32 s37, s37, 40960
    s_add_u32 s37, s37, 0xa00000
    s_lshr_b32 s38, s32, 2
    s_lshl_b32 s39, s34, 1
    s_add_u32 s38, s38, s39
    s_lshl_b32 s39, s38, 10
    s_add_u32 s39, s39, s37
    s_lshl_b32 s38, s38, 8
    s_add_u32 s38, s38, s37
    s_add_u32 s38, s38, 32768
    s_mov_b32 s64, s39
    s_mov_b32 s65, s38
    s_waitcnt lgkmcnt(0)
    v_add_f32 v84, v84, v20
    v_add_f32 v85, v85, v21
    v_add_f32 v86, v86, v22
    v_add_f32 v87, v87, v23
    v_add_f32 v88, v88, v24
    v_add_f32 v89, v89, v25
    v_add_f32 v90, v90, v26
    v_add_f32 v91, v91, v27
    v_add_f32 v92, v92, v28
    v_add_f32 v93, v93, v29
    v_add_f32 v94, v94, v30
    v_add_f32 v95, v95, v31
    v_mov_b32 v32, v92
    v_mov_b32 v33, v92
    s_nop 1
    v_permlane32_swap_b32 v32, v33
    v_rcp_f32 v32, v33
    s_nop 0
    v_mul_f32 v84, v84, v32
    v_mul_f32 v85, v85, v32
    v_mul_f32 v86, v86, v32
    v_mul_f32 v87, v87, v32
    v_mul_f32 v88, v88, v32
    v_mul_f32 v89, v89, v32
    v_mul_f32 v90, v90, v32
    v_mul_f32 v91, v91, v32
    v_mul_f32 v92, v92, v32
    v_mul_f32 v93, v93, v32
    v_mul_f32 v94, v94, v32
    v_mul_f32 v95, v95, v32
    v_cvt_pk_bf16_f32 v20, v84, v85
    v_cvt_pk_bf16_f32 v21, v86, v87
    v_cvt_pk_bf16_f32 v22, v88, v89
    v_cvt_pk_bf16_f32 v23, v90, v91
    v_cvt_pk_bf16_f32 v24, v92, v93
    v_cvt_pk_bf16_f32 v25, v94, v95
    v_lshlrev_b32 v132, 4, v1
    v_lshlrev_b32 v133, 3, v1
    buffer_store_dwordx4 v[20:23], v132, s[28:31], s39 offen sc1
    s_mov_b32 exec_hi, 0
    buffer_store_dwordx2 v[24:25], v133, s[28:31], s38 offen sc1
    s_mov_b32 exec_hi, -1
    v_add_f32 v84, v84, v85
    v_add_f32 v84, v84, v86
    v_add_f32 v84, v84, v87
    v_add_f32 v84, v84, v88
    v_add_f32 v84, v84, v89
    v_add_f32 v84, v84, v90
    v_add_f32 v84, v84, v91
    v_add_f32 v84, v84, v92
    v_add_f32 v84, v84, v93
    v_add_f32 v84, v84, v94
    v_add_f32 v84, v84, v95
    v_mov_b32 v132, 0x5f800000
    v_cmp_nle_f32 vcc, v33, v132
    v_mov_b32 v132, 0x1f800000
    v_cmp_nge_f32 s[40:41], v33, v132
    s_or_b64 vcc, vcc, s[40:41]
    v_mov_b32 v132, 0x207
    v_cmp_class_f32 s[40:41], v84, v132
    s_or_b64 vcc, vcc, s[40:41]
    s_cbranch_vccz Lokay
    v_mov_b32 v132, 1
    v_mov_b32 v133, 3584
    ds_write_b32 v133, v132
Lokay:
    s_waitcnt vmcnt(0) lgkmcnt(0)
    s_barrier
    v_mov_b32 v133, 3584
    ds_read_b32 v132, v133
    s_waitcnt lgkmcnt(0)
    v_readfirstlane_b32 s37, v132
    s_cmp_lg_u32 s37, 0
    s_cbranch_scc1 Lslow
Lo_done:
    s_cmp_lg_u32 s32, 0
    s_cbranch_scc1 Lf2
    s_mul_i32 s37, s36, 128
    s_add_u32 s37, s37, 131072
    v_mov_b32 v132, s35
    v_mov_b32 v133, 0
    s_mov_b64 s[44:45], exec
    s_mov_b64 exec, 1
    buffer_store_dword v132, v133, s[28:31], s37 offen sc1
    s_mov_b64 exec, s[44:45]
Lf2:
    s_mov_b32 s33, s47
    s_mov_b32 s34, s43
    s_lshl_b32 s36, s33, 4
    s_add_u32 s36, s36, s34
    s_and_b32 s37, s34, 7
    s_mul_i32 s37, s37, 320
    s_sub_u32 s38, s37, 5120
    s_add_u32 s39, s37, 2240
    v_mov_b32 v2, 2560
    v_mov_b32 v3, s38
    v_cmp_le_u32 vcc, 320, v0
    v_mov_b32 v4, s39
    s_nop 0
    v_cndmask_b32 v2, v2, v3, vcc
    v_cmp_le_u32 vcc, 340, v0
    s_nop 1
    v_cndmask_b32 v2, v2, v4, vcc
    v_lshl_add_u32 v128, v0, 4, v2
    v_cmp_gt_u32 vcc, 360, v0
    s_and_saveexec_b64 s[44:45], vcc
    s_cbranch_execz Lt1
    s_mov_b32 s37, 0x60000
    buffer_load_dwordx4 v[16:19], v128, s[28:31], s37 offen sc1
    s_add_u32 s37, s37, 10240
    buffer_load_dwordx4 v[20:23], v128, s[28:31], s37 offen sc1
    s_add_u32 s37, s37, 10240
    buffer_load_dwordx4 v[24:27], v128, s[28:31], s37 offen sc1
    s_add_u32 s37, s37, 10240
    buffer_load_dwordx4 v[28:31], v128, s[28:31], s37 offen sc1
    s_add_u32 s37, s37, 10240
    buffer_load_dwordx4 v[32:35], v128, s[28:31], s37 offen sc1
Lt1:
    s_mov_b64 exec, s[44:45]
    v_lshlrev_b32 v135, 4, v1
    s_cmp_lg_u32 s32, 7
    s_cbranch_scc1 Lq4
    v_and_b32 v132, 15, v1
    s_lshl_b32 s37, s33, 11
    v_lshlrev_b32 v132, 7, v132
    s_add_u32 s37, s37, 0x20000
    v_add_u32 v132, s37, v132
    s_mov_b32 s46, 30000
Lp2_5:
    buffer_load_dword v133, v132, s[28:31], 0 offen sc1
    s_waitcnt vmcnt(0)
    v_cmp_ne_u32 vcc, s35, v133
    s_cbranch_vccz Lpe2_6
    s_sub_u32 s46, s46, 1
    s_cmp_gt_i32 s46, 0
    s_cbranch_scc1 Lp2_5
Lpe2_6:
Lq4:
    s_lshl_b32 s37, s33, 7
    s_lshr_b32 s38, s34, 3
    s_lshl_b32 s38, s38, 6
    s_add_u32 s37, s37, s38
    s_and_b32 s38, s32, 3
    s_lshl_b32 s38, s38, 4
    s_add_u32 s37, s37, s38
    s_mul_i32 s37, s37, 1280
    s_and_b32 s38, s34, 7
    s_mul_i32 s38, s38, 160
    s_add_u32 s37, s37, s38
    s_lshr_b32 s38, s32, 2
    s_mul_i32 s38, s38, 96
    s_add_u32 s37, s37, s38
    v_and_b32 v2, 15, v1
    v_mul_u32_u24 v2, 1280, v2
    v_lshrrev_b32 v3, 4, v1
    v_lshl_add_u32 v2, v3, 3, v2
    v_add_u32 v128, s37, v2
    s_cmp_ge_u32 s32, 4
    s_cbranch_scc1 Lx3
    global_load_dwordx2 v[14:15], v128, s[4:5] offset:64
Lx3:
    global_load_dwordx2 v[10:11], v128, s[4:5] offset:0
    global_load_dwordx2 v[12:13], v128, s[4:5] offset:32
    s_lshl_b32 s37, s33, 1
    s_lshr_b32 s38, s34, 3
    s_add_u32 s37, s37, s38
    s_mul_i32 s37, s37, 81920
    s_add_u32 s37, s37, 0xa00000
    s_mul_i32 s38, s32, 10240
    s_add_u32 s60, s37, s38
    s_add_u32 m0, s38, 20480
    v_cmp_gt_u32 vcc, 360, v0
    s_and_saveexec_b64 s[44:45], vcc
    s_cbranch_execz Lt2
    s_waitcnt vmcnt(2)
    v_add_f32 v16, v16, v20
    v_add_f32 v24, v24, v28
    v_add_f32 v16, v16, v32
    v_add_f32 v16, v16, v24
    v_add_f32 v17, v17, v21
    v_add_f32 v25, v25, v29
    v_add_f32 v17, v17, v33
    v_add_f32 v17, v17, v25
    v_add_f32 v18, v18, v22
    v_add_f32 v26, v26, v30
    v_add_f32 v18, v18, v34
    v_add_f32 v18, v18, v26
    v_add_f32 v19, v19, v23
    v_add_f32 v27, v27, v31
    v_add_f32 v19, v19, v35
    v_add_f32 v19, v19, v27
    v_subrev_u32 v5, 160, v0
    v_cmp_gt_u32 vcc, 160, v5
    v_mov_b32 v4, 1.0
    s_nop 0
    v_cndmask_b32 v4, 0, v4, vcc
    v_cvt_pk_bf16_f32 v2, v16, v17
    v_lshlrev_b32 v16, 16, v2
    v_and_b32 v17, 0xffff0000, v2
    v_add_f32 v16, v16, v4
    v_add_f32 v17, v17, v4
    v_cvt_pk_bf16_f32 v20, v16, v17
    v_lshlrev_b32 v16, 16, v20
    v_and_b32 v17, 0xffff0000, v20
    v_cvt_pk_bf16_f32 v2, v18, v19
    v_lshlrev_b32 v18, 16, v2
    v_and_b32 v19, 0xffff0000, v2
    v_add_f32 v18, v18, v4
    v_add_f32 v19, v19, v4
    v_cvt_pk_bf16_f32 v21, v18, v19
    v_lshlrev_b32 v18, 16, v21
    v_and_b32 v19, 0xffff0000, v21
    v_cndmask_b32 v2, v0, v5, vcc
    v_mov_b32 v3, 1280
    v_cndmask_b32 v3, v3, 0, vcc
    v_lshrrev_b32 v4, 2, v2
    v_lshl_add_u32 v3, v4, 5, v3
    v_and_b32 v4, 1, v2
    v_lshl_add_u32 v3, v4, 4, v3
    v_bfe_u32 v4, v2, 1, 1
    v_lshl_add_u32 v3, v4, 3, v3
    s_mov_b64 s[40:41], exec
    v_cmp_gt_u32 vcc, 320, v0
    s_and_b64 exec, exec, vcc
    s_cbranch_execz Lt3
    ds_write_b64 v3, v[20:21]
Lt3:
    s_andn2_b64 exec, s[40:41], vcc
    s_cbranch_execz Lt2
    v_lshlrev_b32 v2, 4, v0
    v_add_u32 v2, -2560, v2
    ds_write_b128 v2, v[16:19]
Lt2:
    s_mov_b64 exec, s[44:45]
    s_waitcnt lgkmcnt(0)
    s_barrier
    buffer_load_dwordx4 v135, s[28:31], s60 offen offset:0 sc1 lds
    buffer_load_dwordx4 v135, s[28:31], s60 offen offset:1024 sc1 lds
    buffer_load_dwordx4 v135, s[28:31], s60 offen offset:2048 sc1 lds
    buffer_load_dwordx4 v135, s[28:31], s60 offen offset:3072 sc1 lds
    s_add_u32 s60, s60, 4096
    s_add_u32 m0, m0, 4096
    s_nop 0
    buffer_load_dwordx4 v135, s[28:31], s60 offen offset:0 sc1 lds
    buffer_load_dwordx4 v135, s[28:31], s60 offen offset:1024 sc1 lds
    buffer_load_dwordx4 v135, s[28:31], s60 offen offset:2048 sc1 lds
    buffer_load_dwordx4 v135, s[28:31], s60 offen offset:3072 sc1 lds
    s_add_u32 s60, s60, 4096
    s_add_u32 m0, m0, 4096
    s_nop 0
    buffer_load_dwordx4 v135, s[28:31], s60 offen offset:0 sc1 lds
    buffer_load_dwordx4 v135, s[28:31], s60 offen offset:1024 sc1 lds
    v_lshrrev_b32 v2, 5, v1
    v_lshlrev_b32 v2, 10, v2
    v_bfe_u32 v3, v1, 4, 1
    v_and_b32 v4, 15, v1
    v_lshl_add_u32 v5, v3, 8, v2
    v_lshl_add_u32 v5, v4, 3, v5
    v_lshl_add_u32 v2, v3, 9, v2
    v_lshl_add_u32 v2, v4, 4, v2
    s_and_b32 s37, s32, 3
    s_mul_i32 s38, s37, 2048
    s_add_u32 s38, s38, 20480
    s_add_u32 s39, s37, 0
    s_bfe_u32 s40, s39, 0x10001
    s_mul_i32 s40, s40, 40960
    s_add_u32 s40, s40, s38
    s_and_b32 s39, s39, 1
    s_lshl_b32 s41, s39, 8
    s_add_u32 s41, s41, s40
    v_add_u32 v104, s41, v2
    s_lshl_b32 s41, s39, 7
    s_add_u32 s41, s41, s40
    s_add_u32 s41, s41, 32768
    v_add_u32 v108, s41, v5
    s_add_u32 s39, s37, 1
    s_bfe_u32 s40, s39, 0x10001
    s_mul_i32 s40, s40, 40960
    s_add_u32 s40, s40, s38
    s_and_b32 s39, s39, 1
    s_lshl_b32 s41, s39, 8
    s_add_u32 s41, s41, s40
    v_add_u32 v105, s41, v2
    s_lshl_b32 s41, s39, 7
    s_add_u32 s41, s41, s40
    s_add_u32 s41, s41, 32768
    v_add_u32 v109, s41, v5
    s_add_u32 s39, s37, 2
    s_bfe_u32 s40, s39, 0x10001
    s_mul_i32 s40, s40, 40960
    s_add_u32 s40, s40, s38
    s_and_b32 s39, s39, 1
    s_lshl_b32 s41, s39, 8
    s_add_u32 s41, s41, s40
    v_add_u32 v106, s41, v2
    s_lshl_b32 s41, s39, 7
    s_add_u32 s41, s41, s40
    s_add_u32 s41, s41, 32768
    v_add_u32 v110, s41, v5
    s_add_u32 s39, s37, 3
    s_bfe_u32 s40, s39, 0x10001
    s_mul_i32 s40, s40, 40960
    s_add_u32 s40, s40, s38
    s_and_b32 s39, s39, 1
    s_lshl_b32 s41, s39, 8
    s_add_u32 s41, s41, s40
    v_add_u32 v107, s41, v2
    s_lshl_b32 s41, s39, 7
    s_add_u32 s41, s41, s40
    s_add_u32 s41, s41, 32768
    v_add_u32 v111, s41, v5
    s_and_b32 s37, s32, 3
    s_lshr_b32 s39, s32, 2
    s_mul_i32 s39, s39, 36864
    s_add_u32 s38, s37, 0
    s_and_b32 s38, s38, 3
    s_mul_i32 s38, s38, 3072
    s_add_u32 s38, s38, s39
    s_add_u32 s38, s38, 102400
    v_lshl_add_u32 v112, v1, 4, s38
    s_add_u32 s38, s37, 1
    s_and_b32 s38, s38, 3
    s_mul_i32 s38, s38, 3072
    s_add_u32 s38, s38, s39
    s_add_u32 s38, s38, 104448
    v_lshl_add_u32 v113, v1, 4, s38
    s_add_u32 s38, s37, 2
    s_and_b32 s38, s38, 3
    s_mul_i32 s38, s38, 3072
    s_add_u32 s38, s38, s39
    s_add_u32 s38, s38, 103424
    v_lshl_add_u32 v114, v1, 4, s38
    s_add_u32 s38, s37, 3
    s_and_b32 s38, s38, 3
    s_mul_i32 s38, s38, 3072
    s_add_u32 s38, s38, s39
    s_add_u32 s38, s38, 102400
    v_lshl_add_u32 v115, v1, 4, s38
    s_lshr_b32 s41, s32, 2
    s_mul_i32 s37, s41, 192
    v_lshrrev_b32 v2, 4, v1
    v_lshl_add_u32 v130, v2, 4, s37
    ds_read_b128 v[116:119], v130 offset:2560
    ds_read_b128 v[120:123], v130 offset:2624
    ds_read_b128 v[124:127], v130 offset:2688
    s_and_b32 s40, s34, 7
    s_mul_i32 s37, s40, 160
    s_mul_i32 s38, s41, 96
    s_add_u32 s37, s37, s38
    v_and_b32 v3, 1, v2
    v_lshl_add_u32 v3, v3, 4, s37
    v_lshrrev_b32 v2, 1, v2
    v_lshl_add_u32 v3, v2, 3, v3
    ds_read_b64 v[96:97], v3 offset:0
    ds_read_b64 v[98:99], v3 offset:32
    ds_read_b64 v[100:101], v3 offset:64
    s_lshl_b32 s37, s33, 2
    s_lshr_b32 s38, s34, 3
    s_lshl_b32 s38, s38, 1
    s_add_u32 s37, s37, s38
    s_bfe_u32 s38, s32, 0x10001
    s_add_u32 s39, s37, s38
    s_mul_i32 s37, s39, 40
    s_mul_i32 s38, s40, 5
    s_add_u32 s37, s37, s38
    s_mul_i32 s38, s41, 3
    s_add_u32 s37, s37, s38
    s_lshl_b32 s37, s37, 10
    s_and_b32 s38, s32, 1
    s_lshl_b32 s64, s38, 8
    s_add_u32 s64, s64, s37
    s_add_u32 s64, s64, 0xd00000
    s_lshl_b32 s39, s39, 12
    s_lshl_b32 s40, s40, 9
    s_add_u32 s39, s39, s40
    s_lshl_b32 s38, s38, 7
    s_add_u32 s39, s39, s38
    s_lshl_b32 s41, s41, 8
    s_add_u32 s39, s39, s41
    s_add_u32 s65, s39, 0x80000
    v_and_b32 v129, 15, v1
    v_lshlrev_b32 v129, 4, v129
    v_bfe_u32 v3, v1, 4, 1
    v_lshl_add_u32 v129, v3, 9, v129
    v_lshrrev_b32 v3, 5, v1
    v_lshl_add_u32 v129, v3, 10, v129
    v_lshlrev_b32 v128, 3, v1
    v_mov_b32 v102, 0
    v_mov_b32 v103, 0
    s_waitcnt vmcnt(0) lgkmcnt(0)
    s_barrier
    s_cmp_ge_u32 s32, 4
    s_cbranch_scc1 Lp3b
    ds_read_b128 v[64:67], v105 offset:0
    ds_read_b128 v[68:71], v105 offset:8192
    ds_read_b128 v[72:75], v105 offset:16384
    ds_read_b128 v[76:79], v105 offset:24576
    ds_read2_b64 v[80:83], v109 offset0:0 offset1:64
    ds_read_b128 v[84:87], v106 offset:0
    s_waitcnt lgkmcnt(5)
    v_mfma_f32_16x16x32_bf16 v[20:23], v[136:139], v[64:67], 0
    v_mfma_f32_16x16x32_bf16 v[36:39], v[140:143], v[64:67], 0
    v_mfma_f32_16x16x32_bf16 v[52:55], v[144:147], v[64:67], 0
    ds_read_b128 v[88:91], v106 offset:8192
    s_waitcnt lgkmcnt(5)
    v_mfma_f32_16x16x32_bf16 v[20:23], v[148:151], v[68:71], v[20:23]
    v_mfma_f32_16x16x32_bf16 v[36:39], v[152:155], v[68:71], v[36:39]
    v_mfma_f32_16x16x32_bf16 v[52:55], v[156:159], v[68:71], v[52:55]
    ds_read_b128 v[92:95], v106 offset:16384
    s_waitcnt lgkmcnt(5)
    v_mfma_f32_16x16x32_bf16 v[20:23], v[160:163], v[72:75], v[20:23]
    v_mfma_f32_16x16x32_bf16 v[36:39], v[164:167], v[72:75], v[36:39]
    v_mfma_f32_16x16x32_bf16 v[52:55], v[168:171], v[72:75], v[52:55]
    ds_read_b128 v[64:67], v106 offset:24576
    s_waitcnt lgkmcnt(5)
    v_mfma_f32_16x16x32_bf16 v[20:23], v[172:175], v[76:79], v[20:23]
    v_mfma_f32_16x16x32_bf16 v[36:39], v[176:179], v[76:79], v[36:39]
    v_mfma_f32_16x16x32_bf16 v[52:55], v[180:183], v[76:79], v[52:55]
    ds_read2_b64 v[68:71], v110 offset0:0 offset1:64
    s_waitcnt lgkmcnt(5)
    v_mfma_f32_16x16x32_bf16 v[20:23], v[184:187], v[80:83], v[20:23]
    v_mfma_f32_16x16x32_bf16 v[36:39], v[188:191], v[80:83], v[36:39]
    v_mfma_f32_16x16x32_bf16 v[52:55], v[192:195], v[80:83], v[52:55]
    ds_read_b128 v[72:75], v107 offset:0
    s_waitcnt lgkmcnt(5)
    v_mfma_f32_16x16x32_bf16 v[24:27], v[136:139], v[84:87], 0
    v_mfma_f32_16x16x32_bf16 v[40:43], v[140:143], v[84:87], 0
    v_mfma_f32_16x16x32_bf16 v[56:59], v[144:147], v[84:87], 0
    ds_read_b128 v[76:79], v107 offset:8192
    s_waitcnt lgkmcnt(5)
    v_mfma_f32_16x16x32_bf16 v[24:27], v[148:151], v[88:91], v[24:27]
    v_mfma_f32_16x16x32_bf16 v[40:43], v[152:155], v[88:91], v[40:43]
    v_mfma_f32_16x16x32_bf16 v[56:59], v[156:159], v[88:91], v[56:59]
    ds_read_b128 v[80:83], v107 offset:16384
    s_waitcnt lgkmcnt(5)
    v_mfma_f32_16x16x32_bf16 v[24:27], v[160:163], v[92:95], v[24:27]
    v_mfma_f32_16x16x32_bf16 v[40:43], v[164:167], v[92:95], v[40:43]
    v_mfma_f32_16x16x32_bf16 v[56:59], v[168:171], v[92:95], v[56:59]
    ds_read_b128 v[84:87], v107 offset:24576
    ds_write_b128 v113, v[20:23] offset:0
    s_waitcnt lgkmcnt(6)
    v_mfma_f32_16x16x32_bf16 v[24:27], v[172:175], v[64:67], v[24:27]
    v_mfma_f32_16x16x32_bf16 v[40:43], v[176:179], v[64:67], v[40:43]
    v_mfma_f32_16x16x32_bf16 v[56:59], v[180:183], v[64:67], v[56:59]
    ds_read2_b64 v[88:91], v111 offset0:0 offset1:64
    ds_write_b128 v113, v[36:39] offset:12288
    s_waitcnt lgkmcnt(7)
    v_mfma_f32_16x16x32_bf16 v[24:27], v[184:187], v[68:71], v[24:27]
    v_mfma_f32_16x16x32_bf16 v[40:43], v[188:191], v[68:71], v[40:43]
    v_mfma_f32_16x16x32_bf16 v[56:59], v[192:195], v[68:71], v[56:59]
    ds_read_b128 v[92:95], v104 offset:0
    ds_write_b128 v113, v[52:55] offset:24576
    s_waitcnt lgkmcnt(8)
    v_mfma_f32_16x16x32_bf16 v[28:31], v[136:139], v[72:75], 0
    v_mfma_f32_16x16x32_bf16 v[44:47], v[140:143], v[72:75], 0
    v_mfma_f32_16x16x32_bf16 v[60:63], v[144:147], v[72:75], 0
    ds_read_b128 v[64:67], v104 offset:8192
    s_waitcnt lgkmcnt(8)
    v_mfma_f32_16x16x32_bf16 v[28:31], v[148:151], v[76:79], v[28:31]
    v_mfma_f32_16x16x32_bf16 v[44:47], v[152:155], v[76:79], v[44:47]
    v_mfma_f32_16x16x32_bf16 v[60:63], v[156:159], v[76:79], v[60:63]
    ds_read_b128 v[68:71], v104 offset:16384
    s_waitcnt lgkmcnt(8)
    v_mfma_f32_16x16x32_bf16 v[28:31], v[160:163], v[80:83], v[28:31]
    v_mfma_f32_16x16x32_bf16 v[44:47], v[164:167], v[80:83], v[44:47]
    v_mfma_f32_16x16x32_bf16 v[60:63], v[168:171], v[80:83], v[60:63]
    ds_read_b128 v[72:75], v104 offset:24576
    ds_write_b128 v114, v[24:27] offset:0
    s_waitcnt lgkmcnt(9)
    v_mfma_f32_16x16x32_bf16 v[28:31], v[172:175], v[84:87], v[28:31]
    v_mfma_f32_16x16x32_bf16 v[44:47], v[176:179], v[84:87], v[44:47]
    v_mfma_f32_16x16x32_bf16 v[60:63], v[180:183], v[84:87], v[60:63]
    ds_read2_b64 v[76:79], v108 offset0:0 offset1:64
    ds_write_b128 v114, v[40:43] offset:12288
    s_waitcnt lgkmcnt(9)
    v_mfma_f32_16x16x32_bf16 v[28:31], v[184:187], v[88:91], v[28:31]
    v_mfma_f32_16x16x32_bf16 v[44:47], v[188:191], v[88:91], v[44:47]
    v_mfma_f32_16x16x32_bf16 v[60:63], v[192:195], v[88:91], v[60:63]
    ds_write_b128 v114, v[56:59] offset:24576
    s_waitcnt lgkmcnt(8)
    v_mfma_f32_16x16x32_bf16 v[16:19], v[136:139], v[92:95], 0
    v_mfma_f32_16x16x32_bf16 v[32:35], v[140:143], v[92:95], 0
    v_mfma_f32_16x16x32_bf16 v[48:51], v[144:147], v[92:95], 0
    s_waitcnt lgkmcnt(6)
    v_mfma_f32_16x16x32_bf16 v[16:19], v[148:151], v[64:67], v[16:19]
    v_mfma_f32_16x16x32_bf16 v[32:35], v[152:155], v[64:67], v[32:35]
    v_mfma_f32_16x16x32_bf16 v[48:51], v[156:159], v[64:67], v[48:51]
    s_waitcnt lgkmcnt(5)
    v_mfma_f32_16x16x32_bf16 v[16:19], v[160:163], v[68:71], v[16:19]
    v_mfma_f32_16x16x32_bf16 v[32:35], v[164:167], v[68:71], v[32:35]
    v_mfma_f32_16x16x32_bf16 v[48:51], v[168:171], v[68:71], v[48:51]
    ds_write_b128 v115, v[28:31] offset:0
    s_waitcnt lgkmcnt(5)
    v_mfma_f32_16x16x32_bf16 v[16:19], v[172:175], v[72:75], v[16:19]
    v_mfma_f32_16x16x32_bf16 v[32:35], v[176:179], v[72:75], v[32:35]
    v_mfma_f32_16x16x32_bf16 v[48:51], v[180:183], v[72:75], v[48:51]
    ds_write_b128 v115, v[44:47] offset:12288
    s_waitcnt lgkmcnt(4)
    v_mfma_f32_16x16x32_bf16 v[16:19], v[184:187], v[76:79], v[16:19]
    v_mfma_f32_16x16x32_bf16 v[32:35], v[188:191], v[76:79], v[32:35]
    v_mfma_f32_16x16x32_bf16 v[48:51], v[192:195], v[76:79], v[48:51]
    ds_write_b128 v115, v[60:63] offset:24576
    s_waitcnt lgkmcnt(0)
    s_barrier
    ds_read_b128 v[64:67], v112 offset:0
    ds_read_b128 v[68:71], v112 offset:1024
    ds_read_b128 v[72:75], v112 offset:2048
    ds_read_b128 v[76:79], v112 offset:12288
    ds_read_b128 v[80:83], v112 offset:13312
    ds_read_b128 v[84:87], v112 offset:14336
    ds_read_b128 v[88:91], v112 offset:24576
    ds_read_b128 v[92:95], v112 offset:25600
    ds_read_b128 v[20:23], v112 offset:26624
    s_waitcnt lgkmcnt(6)
    v_add_f32 v64, v64, v68
    v_add_f32 v16, v16, v72
    v_add_f32 v16, v16, v64
    v_add_f32 v65, v65, v69
    v_add_f32 v17, v17, v73
    v_add_f32 v17, v17, v65
    v_add_f32 v66, v66, v70
    v_add_f32 v18, v18, v74
    v_add_f32 v18, v18, v66
    v_add_f32 v67, v67, v71
    v_add_f32 v19, v19, v75
    v_add_f32 v19, v19, v67
    v_lshlrev_b32 v2, 16, v10
    v_and_b32 v3, 0xffff0000, v10
    v_fmac_f32 v2, v116, v16
    v_fmac_f32 v3, v117, v17
    v_cvt_pk_bf16_f32 v10, v2, v3
    v_lshlrev_b32 v16, 16, v10
    v_and_b32 v17, 0xffff0000, v10
    v_lshlrev_b32 v4, 16, v96
    v_and_b32 v5, 0xffff0000, v96
    v_mul_f32 v2, v16, v4
    v_mul_f32 v3, v17, v5
    v_cvt_pk_bf16_f32 v116, v2, v3
    v_lshlrev_b32 v2, 16, v11
    v_and_b32 v3, 0xffff0000, v11
    v_fmac_f32 v2, v118, v18
    v_fmac_f32 v3, v119, v19
    v_cvt_pk_bf16_f32 v11, v2, v3
    v_lshlrev_b32 v18, 16, v11
    v_and_b32 v19, 0xffff0000, v11
    v_lshlrev_b32 v4, 16, v97
    v_and_b32 v5, 0xffff0000, v97
    v_mul_f32 v2, v18, v4
    v_mul_f32 v3, v19, v5
    v_cvt_pk_bf16_f32 v117, v2, v3
    s_waitcnt lgkmcnt(3)
    v_add_f32 v76, v76, v80
    v_add_f32 v32, v32, v84
    v_add_f32 v32, v32, v76
    v_add_f32 v77, v77, v81
    v_add_f32 v33, v33, v85
    v_add_f32 v33, v33, v77
    v_add_f32 v78, v78, v82
    v_add_f32 v34, v34, v86
    v_add_f32 v34, v34, v78
    v_add_f32 v79, v79, v83
    v_add_f32 v35, v35, v87
    v_add_f32 v35, v35, v79
    v_lshlrev_b32 v2, 16, v12
    v_and_b32 v3, 0xffff0000, v12
    v_fmac_f32 v2, v120, v32
    v_fmac_f32 v3, v121, v33
    v_cvt_pk_bf16_f32 v12, v2, v3
    v_lshlrev_b32 v32, 16, v12
    v_and_b32 v33, 0xffff0000, v12
    v_lshlrev_b32 v4, 16, v98
    v_and_b32 v5, 0xffff0000, v98
    v_mul_f32 v2, v32, v4
    v_mul_f32 v3, v33, v5
    v_cvt_pk_bf16_f32 v118, v2, v3
    v_lshlrev_b32 v2, 16, v13
    v_and_b32 v3, 0xffff0000, v13
    v_fmac_f32 v2, v122, v34
    v_fmac_f32 v3, v123, v35
    v_cvt_pk_bf16_f32 v13, v2, v3
    v_lshlrev_b32 v34, 16, v13
    v_and_b32 v35, 0xffff0000, v13
    v_lshlrev_b32 v4, 16, v99
    v_and_b32 v5, 0xffff0000, v99
    v_mul_f32 v2, v34, v4
    v_mul_f32 v3, v35, v5
    v_cvt_pk_bf16_f32 v119, v2, v3
    s_nop 1
    v_permlane32_swap_b32 v116, v118
    v_permlane32_swap_b32 v117, v119
    buffer_store_dwordx4 v[116:119], v129, s[28:31], s64 offen sc1
    s_waitcnt lgkmcnt(0)
    v_add_f32 v88, v88, v92
    v_add_f32 v48, v48, v20
    v_add_f32 v48, v48, v88
    v_add_f32 v89, v89, v93
    v_add_f32 v49, v49, v21
    v_add_f32 v49, v49, v89
    v_add_f32 v90, v90, v94
    v_add_f32 v50, v50, v22
    v_add_f32 v50, v50, v90
    v_add_f32 v91, v91, v95
    v_add_f32 v51, v51, v23
    v_add_f32 v51, v51, v91
    v_lshlrev_b32 v2, 16, v14
    v_and_b32 v3, 0xffff0000, v14
    v_fmac_f32 v2, v124, v48
    v_fmac_f32 v3, v125, v49
    v_cvt_pk_bf16_f32 v14, v2, v3
    v_lshlrev_b32 v48, 16, v14
    v_and_b32 v49, 0xffff0000, v14
    v_lshlrev_b32 v4, 16, v100
    v_and_b32 v5, 0xffff0000, v100
    v_mul_f32 v2, v48, v4
    v_mul_f32 v3, v49, v5
    v_cvt_pk_bf16_f32 v120, v2, v3
    v_lshlrev_b32 v2, 16, v15
    v_and_b32 v3, 0xffff0000, v15
    v_fmac_f32 v2, v126, v50
    v_fmac_f32 v3, v127, v51
    v_cvt_pk_bf16_f32 v15, v2, v3
    v_lshlrev_b32 v50, 16, v15
    v_and_b32 v51, 0xffff0000, v15
    v_lshlrev_b32 v4, 16, v101
    v_and_b32 v5, 0xffff0000, v101
    v_mul_f32 v2, v50, v4
    v_mul_f32 v3, v51, v5
    v_cvt_pk_bf16_f32 v121, v2, v3
    s_nop 1
    v_permlane32_swap_b32 v120, v122
    v_permlane32_swap_b32 v121, v123
    s_mov_b32 exec_hi, 0
    buffer_store_dwordx4 v[120:123], v129, s[28:31], s64 offen offset:2048 sc1
    s_mov_b32 exec_hi, -1
    v_add_f32 v102, v102, v16
    v_fmac_f32 v103, v16, v16
    v_add_f32 v102, v102, v17
    v_fmac_f32 v103, v17, v17
    v_add_f32 v102, v102, v18
    v_fmac_f32 v103, v18, v18
    v_add_f32 v102, v102, v19
    v_fmac_f32 v103, v19, v19
    v_add_f32 v102, v102, v32
    v_fmac_f32 v103, v32, v32
    v_add_f32 v102, v102, v33
    v_fmac_f32 v103, v33, v33
    v_add_f32 v102, v102, v34
    v_fmac_f32 v103, v34, v34
    v_add_f32 v102, v102, v35
    v_fmac_f32 v103, v35, v35
    v_add_f32 v102, v102, v48
    v_fmac_f32 v103, v48, v48
    v_add_f32 v102, v102, v49
    v_fmac_f32 v103, v49, v49
    v_add_f32 v102, v102, v50
    v_fmac_f32 v103, v50, v50
    v_add_f32 v102, v102, v51
    v_fmac_f32 v103, v51, v51
    v_mov_b32 v2, v102
    v_mov_b32 v3, v103
    s_nop 1
    v_permlane32_swap_b32 v102, v2
    v_permlane32_swap_b32 v103, v3
    v_add_f32 v102, v102, v2
    v_add_f32 v103, v103, v3
    v_mov_b32 v2, v102
    v_mov_b32 v3, v103
    s_nop 1
    v_permlane16_swap_b32 v102, v2
    v_permlane16_swap_b32 v103, v3
    v_add_f32 v102, v102, v2
    v_add_f32 v103, v103, v3
    s_mov_b64 exec, 0xffff
    buffer_store_dwordx2 v[102:103], v128, s[28:31], s65 offen sc1
    s_mov_b64 exec, -1
    s_branch Lp3e
Lp3b:
    ds_read_b128 v[64:67], v105 offset:0
    ds_read_b128 v[68:71], v105 offset:8192
    ds_read_b128 v[72:75], v105 offset:16384
    ds_read_b128 v[76:79], v105 offset:24576
    ds_read2_b64 v[80:83], v109 offset0:0 offset1:64
    ds_read_b128 v[84:87], v106 offset:0
    s_waitcnt lgkmcnt(5)
    v_mfma_f32_16x16x32_bf16 v[20:23], v[136:139], v[64:67], 0
    v_mfma_f32_16x16x32_bf16 v[36:39], v[140:143], v[64:67], 0
    ds_read_b128 v[88:91], v106 offset:8192
    s_waitcnt lgkmcnt(5)
    v_mfma_f32_16x16x32_bf16 v[20:23], v[144:147], v[68:71], v[20:23]
    v_mfma_f32_16x16x32_bf16 v[36:39], v[148:151], v[68:71], v[36:39]
    ds_read_b128 v[92:95], v106 offset:16384
    s_waitcnt lgkmcnt(5)
    v_mfma_f32_16x16x32_bf16 v[20:23], v[152:155], v[72:75], v[20:23]
    v_mfma_f32_16x16x32_bf16 v[36:39], v[156:159], v[72:75], v[36:39]
    ds_read_b128 v[64:67], v106 offset:24576
    s_waitcnt lgkmcnt(5)
    v_mfma_f32_16x16x32_bf16 v[20:23], v[160:163], v[76:79], v[20:23]
    v_mfma_f32_16x16x32_bf16 v[36:39], v[164:167], v[76:79], v[36:39]
    ds_read2_b64 v[68:71], v110 offset0:0 offset1:64
    s_waitcnt lgkmcnt(5)
    v_mfma_f32_16x16x32_bf16 v[20:23], v[168:171], v[80:83], v[20:23]
    v_mfma_f32_16x16x32_bf16 v[36:39], v[172:175], v[80:83], v[36:39]
    ds_read_b128 v[72:75], v107 offset:0
    s_waitcnt lgkmcnt(5)
    v_mfma_f32_16x16x32_bf16 v[24:27], v[136:139], v[84:87], 0
    v_mfma_f32_16x16x32_bf16 v[40:43], v[140:143], v[84:87], 0
    ds_read_b128 v[76:79], v107 offset:8192
    s_waitcnt lgkmcnt(5)
    v_mfma_f32_16x16x32_bf16 v[24:27], v[144:147], v[88:91], v[24:27]
    v_mfma_f32_16x16x32_bf16 v[40:43], v[148:151], v[88:91], v[40:43]
    ds_read_b128 v[80:83], v107 offset:16384
    s_waitcnt lgkmcnt(5)
    v_mfma_f32_16x16x32_bf16 v[24:27], v[152:155], v[92:95], v[24:27]
    v_mfma_f32_16x16x32_bf16 v[40:43], v[156:159], v[92:95], v[40:43]
    ds_read_b128 v[84:87], v107 offset:24576
    ds_write_b128 v113, v[20:23] offset:0
    s_waitcnt lgkmcnt(6)
    v_mfma_f32_16x16x32_bf16 v[24:27], v[160:163], v[64:67], v[24:27]
    v_mfma_f32_16x16x32_bf16 v[40:43], v[164:167], v[64:67], v[40:43]
    ds_read2_b64 v[88:91], v111 offset0:0 offset1:64
    ds_write_b128 v113, v[36:39] offset:12288
    s_waitcnt lgkmcnt(7)
    v_mfma_f32_16x16x32_bf16 v[24:27], v[168:171], v[68:71], v[24:27]
    v_mfma_f32_16x16x32_bf16 v[40:43], v[172:175], v[68:71], v[40:43]
    ds_read_b128 v[92:95], v104 offset:0
    s_waitcnt lgkmcnt(7)
    v_mfma_f32_16x16x32_bf16 v[28:31], v[136:139], v[72:75], 0
    v_mfma_f32_16x16x32_bf16 v[44:47], v[140:143], v[72:75], 0
    ds_read_b128 v[64:67], v104 offset:8192
    s_waitcnt lgkmcnt(7)
    v_mfma_f32_16x16x32_bf16 v[28:31], v[144:147], v[76:79], v[28:31]
    v_mfma_f32_16x16x32_bf16 v[44:47], v[148:151], v[76:79], v[44:47]
    ds_read_b128 v[68:71], v104 offset:16384
    s_waitcnt lgkmcnt(7)
    v_mfma_f32_16x16x32_bf16 v[28:31], v[152:155], v[80:83], v[28:31]
    v_mfma_f32_16x16x32_bf16 v[44:47], v[156:159], v[80:83], v[44:47]
    ds_read_b128 v[72:75], v104 offset:24576
    ds_write_b128 v114, v[24:27] offset:0
    s_waitcnt lgkmcnt(8)
    v_mfma_f32_16x16x32_bf16 v[28:31], v[160:163], v[84:87], v[28:31]
    v_mfma_f32_16x16x32_bf16 v[44:47], v[164:167], v[84:87], v[44:47]
    ds_read2_b64 v[76:79], v108 offset0:0 offset1:64
    ds_write_b128 v114, v[40:43] offset:12288
    s_waitcnt lgkmcnt(8)
    v_mfma_f32_16x16x32_bf16 v[28:31], v[168:171], v[88:91], v[28:31]
    v_mfma_f32_16x16x32_bf16 v[44:47], v[172:175], v[88:91], v[44:47]
    s_waitcnt lgkmcnt(6)
    v_mfma_f32_16x16x32_bf16 v[16:19], v[136:139], v[92:95], 0
    v_mfma_f32_16x16x32_bf16 v[32:35], v[140:143], v[92:95], 0
    s_waitcnt lgkmcnt(5)
    v_mfma_f32_16x16x32_bf16 v[16:19], v[144:147], v[64:67], v[16:19]
    v_mfma_f32_16x16x32_bf16 v[32:35], v[148:151], v[64:67], v[32:35]
    s_waitcnt lgkmcnt(4)
    v_mfma_f32_16x16x32_bf16 v[16:19], v[152:155], v[68:71], v[16:19]
    v_mfma_f32_16x16x32_bf16 v[32:35], v[156:159], v[68:71], v[32:35]
    ds_write_b128 v115, v[28:31] offset:0
    s_waitcnt lgkmcnt(4)
    v_mfma_f32_16x16x32_bf16 v[16:19], v[160:163], v[72:75], v[16:19]
    v_mfma_f32_16x16x32_bf16 v[32:35], v[164:167], v[72:75], v[32:35]
    ds_write_b128 v115, v[44:47] offset:12288
    s_waitcnt lgkmcnt(3)
    v_mfma_f32_16x16x32_bf16 v[16:19], v[168:171], v[76:79], v[16:19]
    v_mfma_f32_16x16x32_bf16 v[32:35], v[172:175], v[76:79], v[32:35]
    s_waitcnt lgkmcnt(0)
    s_barrier
    ds_read_b128 v[64:67], v112 offset:0
    ds_read_b128 v[68:71], v112 offset:1024
    ds_read_b128 v[72:75], v112 offset:2048
    ds_read_b128 v[76:79], v112 offset:12288
    ds_read_b128 v[80:83], v112 offset:13312
    ds_read_b128 v[84:87], v112 offset:14336
    s_waitcnt lgkmcnt(3)
    v_add_f32 v64, v64, v68
    v_add_f32 v16, v16, v72
    v_add_f32 v16, v16, v64
    v_add_f32 v65, v65, v69
    v_add_f32 v17, v17, v73
    v_add_f32 v17, v17, v65
    v_add_f32 v66, v66, v70
    v_add_f32 v18, v18, v74
    v_add_f32 v18, v18, v66
    v_add_f32 v67, v67, v71
    v_add_f32 v19, v19, v75
    v_add_f32 v19, v19, v67
    v_lshlrev_b32 v2, 16, v10
    v_and_b32 v3, 0xffff0000, v10
    v_fmac_f32 v2, v116, v16
    v_fmac_f32 v3, v117, v17
    v_cvt_pk_bf16_f32 v10, v2, v3
    v_lshlrev_b32 v16, 16, v10
    v_and_b32 v17, 0xffff0000, v10
    v_lshlrev_b32 v4, 16, v96
    v_and_b32 v5, 0xffff0000, v96
    v_mul_f32 v2, v16, v4
    v_mul_f32 v3, v17, v5
    v_cvt_pk_bf16_f32 v116, v2, v3
    v_lshlrev_b32 v2, 16, v11
    v_and_b32 v3, 0xffff0000, v11
    v_fmac_f32 v2, v118, v18
    v_fmac_f32 v3, v119, v19
    v_cvt_pk_bf16_f32 v11, v2, v3
    v_lshlrev_b32 v18, 16, v11
    v_and_b32 v19, 0xffff0000, v11
    v_lshlrev_b32 v4, 16, v97
    v_and_b32 v5, 0xffff0000, v97
    v_mul_f32 v2, v18, v4
    v_mul_f32 v3, v19, v5
    v_cvt_pk_bf16_f32 v117, v2, v3
    s_waitcnt lgkmcnt(0)
    v_add_f32 v76, v76, v80
    v_add_f32 v32, v32, v84
    v_add_f32 v32, v32, v76
    v_add_f32 v77, v77, v81
    v_add_f32 v33, v33, v85
    v_add_f32 v33, v33, v77
    v_add_f32 v78, v78, v82
    v_add_f32 v34, v34, v86
    v_add_f32 v34, v34, v78
    v_add_f32 v79, v79, v83
    v_add_f32 v35, v35, v87
    v_add_f32 v35, v35, v79
    v_lshlrev_b32 v2, 16, v12
    v_and_b32 v3, 0xffff0000, v12
    v_fmac_f32 v2, v120, v32
    v_fmac_f32 v3, v121, v33
    v_cvt_pk_bf16_f32 v12, v2, v3
    v_lshlrev_b32 v32, 16, v12
    v_and_b32 v33, 0xffff0000, v12
    v_lshlrev_b32 v4, 16, v98
    v_and_b32 v5, 0xffff0000, v98
    v_mul_f32 v2, v32, v4
    v_mul_f32 v3, v33, v5
    v_cvt_pk_bf16_f32 v118, v2, v3
    v_lshlrev_b32 v2, 16, v13
    v_and_b32 v3, 0xffff0000, v13
    v_fmac_f32 v2, v122, v34
    v_fmac_f32 v3, v123, v35
    v_cvt_pk_bf16_f32 v13, v2, v3
    v_lshlrev_b32 v34, 16, v13
    v_and_b32 v35, 0xffff0000, v13
    v_lshlrev_b32 v4, 16, v99
    v_and_b32 v5, 0xffff0000, v99
    v_mul_f32 v2, v34, v4
    v_mul_f32 v3, v35, v5
    v_cvt_pk_bf16_f32 v119, v2, v3
    s_nop 1
    v_permlane32_swap_b32 v116, v118
    v_permlane32_swap_b32 v117, v119
    buffer_store_dwordx4 v[116:119], v129, s[28:31], s64 offen sc1
    v_add_f32 v102, v102, v16
    v_fmac_f32 v103, v16, v16
    v_add_f32 v102, v102, v17
    v_fmac_f32 v103, v17, v17
    v_add_f32 v102, v102, v18
    v_fmac_f32 v103, v18, v18
    v_add_f32 v102, v102, v19
    v_fmac_f32 v103, v19, v19
    v_add_f32 v102, v102, v32
    v_fmac_f32 v103, v32, v32
    v_add_f32 v102, v102, v33
    v_fmac_f32 v103, v33, v33
    v_add_f32 v102, v102, v34
    v_fmac_f32 v103, v34, v34
    v_add_f32 v102, v102, v35
    v_fmac_f32 v103, v35, v35
    v_mov_b32 v2, v102
    v_mov_b32 v3, v103
    s_nop 1
    v_permlane32_swap_b32 v102, v2
    v_permlane32_swap_b32 v103, v3
    v_add_f32 v102, v102, v2
    v_add_f32 v103, v103, v3
    v_mov_b32 v2, v102
    v_mov_b32 v3, v103
    s_nop 1
    v_permlane16_swap_b32 v102, v2
    v_permlane16_swap_b32 v103, v3
    v_add_f32 v102, v102, v2
    v_add_f32 v103, v103, v3
    s_mov_b64 exec, 0xffff
    buffer_store_dwordx2 v[102:103], v128, s[28:31], s65 offen sc1
    s_mov_b64 exec, -1
Lp3e:
    s_waitcnt vmcnt(0)
    s_barrier
    s_cmp_lg_u32 s32, 0
    s_cbranch_scc1 Lf3
    s_mul_i32 s37, s36, 128
    s_add_u32 s37, s37, 163840
    v_mov_b32 v2, s35
    v_mov_b32 v3, 0
    s_mov_b64 s[44:45], exec
    s_mov_b64 exec, 1
    buffer_store_dword v2, v3, s[28:31], s37 offen sc1
    s_mov_b64 exec, s[44:45]
Lf3:
    s_mul_i32 s37, s34, 40
    s_mul_i32 s38, s32, 5
    s_add_u32 s37, s37, s38
    s_lshl_b32 s37, s37, 10
    s_add_u32 s37, s37, 0x1b00000
    s_lshl_b32 s38, s38, 10
    s_add_u32 m0, s38, 20480
    s_nop 0
    buffer_load_dwordx4 v135, s[28:31], s37 offen offset:0 sc1 lds
    buffer_load_dwordx4 v135, s[28:31], s37 offen offset:1024 sc1 lds
    buffer_load_dwordx4 v135, s[28:31], s37 offen offset:2048 sc1 lds
    buffer_load_dwordx4 v135, s[28:31], s37 offen offset:3072 sc1 lds
    s_add_u32 s37, s37, 4096
    s_add_u32 m0, m0, 4096
    s_nop 0
    buffer_load_dwordx4 v135, s[28:31], s37 offen sc1 lds
    s_mul_i32 s37, s34, 40
    s_mul_i32 s38, s32, 5
    s_add_u32 s37, s37, s38
    s_lshl_b32 s37, s37, 10
    s_add_u32 s37, s37, 0x1ba0000
    s_lshl_b32 s38, s38, 10
    s_add_u32 m0, s38, 61440
    s_nop 0
    buffer_load_dwordx4 v135, s[28:31], s37 offen offset:0 sc1 lds
    buffer_load_dwordx4 v135, s[28:31], s37 offen offset:1024 sc1 lds
    buffer_load_dwordx4 v135, s[28:31], s37 offen offset:2048 sc1 lds
    buffer_load_dwordx4 v135, s[28:31], s37 offen offset:3072 sc1 lds
    s_add_u32 s37, s37, 4096
    s_add_u32 m0, m0, 4096
    s_nop 0
    buffer_load_dwordx4 v135, s[28:31], s37 offen sc1 lds
    s_mul_i32 s37, s34, 40
    s_mul_i32 s38, s32, 5
    s_add_u32 s37, s37, s38
    s_lshl_b32 s37, s37, 10
    s_add_u32 s37, s37, 0x1c40000
    s_lshl_b32 s38, s38, 10
    s_add_u32 m0, s38, 102400
    s_nop 0
    buffer_load_dwordx4 v135, s[28:31], s37 offen offset:0 sc1 lds
    buffer_load_dwordx4 v135, s[28:31], s37 offen offset:1024 sc1 lds
    buffer_load_dwordx4 v135, s[28:31], s37 offen offset:2048 sc1 lds
    buffer_load_dwordx4 v135, s[28:31], s37 offen offset:3072 sc1 lds
    s_add_u32 s37, s37, 4096
    s_add_u32 m0, m0, 4096
    s_nop 0
    buffer_load_dwordx4 v135, s[28:31], s37 offen sc1 lds
    s_and_b32 s37, s32, 3
    s_lshl_b32 s38, s33, 2
    s_add_u32 s62, s37, s38
    v_and_b32 v9, 31, v1
    v_lshlrev_b32 v9, 3, v9
    v_lshrrev_b32 v3, 5, v1
    v_lshl_add_u32 v9, v3, 11, v9
    s_lshr_b32 s38, s32, 2
    s_mul_i32 s39, s38, 20480
    s_add_u32 s39, s39, 20480
    v_add_u32 v6, s39, v135
    s_lshl_b32 s37, s37, 12
    s_add_u32 s37, s37, 4096
    v_add_u32 v7, s37, v135
    s_mul_i32 s60, s62, 108
    s_add_u32 s60, s60, s34
    s_lshl_b32 s60, s60, 10
    s_add_u32 s60, s60, 0x1000000
    s_lshl_b32 s63, s34, 10
    s_add_u32 s63, s63, 0x2000000
    s_mul_i32 s65, s62, 40
    s_mul_i32 s39, s38, 20
    s_add_u32 s65, s65, s39
    s_lshl_b32 s65, s65, 10
    s_add_u32 s65, s65, 0xd00000
    s_lshl_b32 s37, s33, 2
    s_lshr_b32 s39, s34, 3
    s_lshl_b32 s39, s39, 1
    s_add_u32 s37, s37, s39
    s_add_u32 s37, s37, s38
    s_mul_i32 s64, s37, 108
    s_and_b32 s38, s32, 3
    s_lshl_b32 s38, s38, 2
    s_add_u32 s64, s64, s38
    s_lshl_b32 s64, s64, 10
    s_add_u32 s64, s64, 0x1000000
    s_and_b32 s38, s34, 7
    s_mul_i32 s38, s38, 20480
    s_mul_i32 s39, s33, 163840
    s_add_u32 s38, s38, s39
    s_add_u32 s66, s38, 0xd00000
    v_lshlrev_b32 v128, 7, v0
    s_cmp_lg_u32 s32, 0
    s_cbranch_scc1 Lq5
    v_and_b32 v132, 15, v1
    s_lshl_b32 s37, s33, 11
    v_lshlrev_b32 v132, 7, v132
    s_add_u32 s37, s37, 0x28000
    v_add_u32 v132, s37, v132
    v_subrev_u32 v133, 16, v1
    v_lshrrev_b32 v2, 1, v133
    v_lshl_add_u32 v2, v2, 4, s34
    v_min_u32 v2, 107, v2
    v_lshlrev_b32 v2, 1, v2
    v_and_b32 v3, 1, v1
    v_add_u32 v2, v2, v3
    v_lshlrev_b32 v2, 7, v2
    v_add_u32 v2, 0x38000, v2
    v_cmp_gt_u32 vcc, 14, v133
    s_nop 1
    v_cndmask_b32 v132, v132, v2, vcc
    s_mov_b32 s46, 30000
Lp3_7:
    buffer_load_dword v133, v132, s[28:31], 0 offen sc1
    s_waitcnt vmcnt(0)
    v_cmp_ne_u32 vcc, s35, v133
    s_cbranch_vccz Lpe3_8
    s_sub_u32 s46, s46, 1
    s_cmp_gt_i32 s46, 0
    s_cbranch_scc1 Lp3_7
Lpe3_8:
Lq5:
    s_waitcnt vmcnt(5)
    s_barrier
    buffer_load_dwordx4 v[16:19], v135, s[28:31], s65 offen offset:0 sc1
    buffer_load_dwordx4 v[20:23], v135, s[28:31], s65 offen offset:1024 sc1
    buffer_load_dwordx4 v[24:27], v135, s[28:31], s65 offen offset:2048 sc1
    buffer_load_dwordx4 v[28:31], v135, s[28:31], s65 offen offset:3072 sc1
    s_add_u32 s65, s65, 4096
    buffer_load_dwordx4 v[32:35], v135, s[28:31], s65 offen offset:0 sc1
    buffer_load_dwordx4 v[36:39], v135, s[28:31], s65 offen offset:1024 sc1
    buffer_load_dwordx4 v[40:43], v135, s[28:31], s65 offen offset:2048 sc1
    buffer_load_dwordx4 v[44:47], v135, s[28:31], s65 offen offset:3072 sc1
    s_cmp_ge_u32 s32, 4
    s_cbranch_scc1 Lp4b
    ds_read_b128 v[136:139], v6 offset:0
    ds_read_b128 v[140:143], v6 offset:40960
    ds_read_b128 v[144:147], v6 offset:1024
    ds_read_b128 v[164:167], v6 offset:41984
    ds_read_b128 v[128:131], v6 offset:2048
    ds_read_b128 v[172:175], v6 offset:43008
    s_waitcnt vmcnt(7)
    s_waitcnt lgkmcnt(5)
    v_mfma_f32_32x32x16_bf16 v[96:111], v[136:139], v[16:19], 0
    s_add_u32 s65, s65, 4096
    buffer_load_dwordx4 v[48:51], v135, s[28:31], s65 offen offset:0 sc1
    s_waitcnt lgkmcnt(4)
    v_mfma_f32_32x32x16_bf16 v[112:127], v[140:143], v[16:19], 0
    buffer_load_dwordx4 v[52:55], v135, s[28:31], s65 offen offset:1024 sc1
    ds_read_b128 v[136:139], v6 offset:3072
    ds_read_b128 v[140:143], v6 offset:44032
    s_waitcnt vmcnt(8)
    s_waitcnt lgkmcnt(5)
    v_mfma_f32_32x32x16_bf16 v[96:111], v[144:147], v[20:23], v[96:111]
    buffer_load_dwordx4 v[56:59], v135, s[28:31], s65 offen offset:2048 sc1
    s_waitcnt lgkmcnt(4)
    v_mfma_f32_32x32x16_bf16 v[112:127], v[164:167], v[20:23], v[112:127]
    buffer_load_dwordx4 v[60:63], v135, s[28:31], s65 offen offset:3072 sc1
    ds_read_b128 v[144:147], v6 offset:4096
    ds_read_b128 v[164:167], v6 offset:45056
    s_waitcnt vmcnt(9)
    s_waitcnt lgkmcnt(5)
    v_mfma_f32_32x32x16_bf16 v[96:111], v[128:131], v[24:27], v[96:111]
    s_add_u32 s65, s65, 4096
    buffer_load_dwordx4 v[64:67], v135, s[28:31], s65 offen offset:0 sc1
    s_waitcnt lgkmcnt(4)
    v_mfma_f32_32x32x16_bf16 v[112:127], v[172:175], v[24:27], v[112:127]
    buffer_load_dwordx4 v[68:71], v135, s[28:31], s65 offen offset:1024 sc1
    ds_read_b128 v[128:131], v6 offset:5120
    ds_read_b128 v[172:175], v6 offset:46080
    s_waitcnt vmcnt(10)
    s_waitcnt lgkmcnt(5)
    v_mfma_f32_32x32x16_bf16 v[96:111], v[136:139], v[28:31], v[96:111]
    buffer_load_dwordx4 v[72:75], v135, s[28:31], s65 offen offset:2048 sc1
    s_waitcnt lgkmcnt(4)
    v_mfma_f32_32x32x16_bf16 v[112:127], v[140:143], v[28:31], v[112:127]
    buffer_load_dwordx4 v[76:79], v135, s[28:31], s65 offen offset:3072 sc1
    ds_read_b128 v[136:139], v6 offset:6144
    ds_read_b128 v[140:143], v6 offset:47104
    s_waitcnt vmcnt(11)
    s_waitcnt lgkmcnt(5)
    v_mfma_f32_32x32x16_bf16 v[96:111], v[144:147], v[32:35], v[96:111]
    s_add_u32 s65, s65, 4096
    buffer_load_dwordx4 v[80:83], v135, s[28:31], s65 offen offset:0 sc1
    s_waitcnt lgkmcnt(4)
    v_mfma_f32_32x32x16_bf16 v[112:127], v[164:167], v[32:35], v[112:127]
    buffer_load_dwordx4 v[84:87], v135, s[28:31], s65 offen offset:1024 sc1
    ds_read_b128 v[144:147], v6 offset:7168
    ds_read_b128 v[164:167], v6 offset:48128
    s_waitcnt vmcnt(12)
    s_waitcnt lgkmcnt(5)
    v_mfma_f32_32x32x16_bf16 v[96:111], v[128:131], v[36:39], v[96:111]
    buffer_load_dwordx4 v[88:91], v135, s[28:31], s65 offen offset:2048 sc1
    s_waitcnt lgkmcnt(4)
    v_mfma_f32_32x32x16_bf16 v[112:127], v[172:175], v[36:39], v[112:127]
    buffer_load_dwordx4 v[92:95], v135, s[28:31], s65 offen offset:3072 sc1
    ds_read_b128 v[128:131], v6 offset:8192
    ds_read_b128 v[172:175], v6 offset:49152
    s_waitcnt vmcnt(13)
    s_waitcnt lgkmcnt(5)
    v_mfma_f32_32x32x16_bf16 v[96:111], v[136:139], v[40:43], v[96:111]
    s_waitcnt lgkmcnt(4)
    v_mfma_f32_32x32x16_bf16 v[112:127], v[140:143], v[40:43], v[112:127]
    ds_read_b128 v[136:139], v6 offset:9216
    ds_read_b128 v[140:143], v6 offset:50176
    s_waitcnt vmcnt(12)
    s_waitcnt lgkmcnt(5)
    v_mfma_f32_32x32x16_bf16 v[96:111], v[144:147], v[44:47], v[96:111]
    s_waitcnt lgkmcnt(4)
    v_mfma_f32_32x32x16_bf16 v[112:127], v[164:167], v[44:47], v[112:127]
    ds_read_b128 v[144:147], v6 offset:10240
    ds_read_b128 v[164:167], v6 offset:51200
    s_waitcnt vmcnt(11)
    s_waitcnt lgkmcnt(5)
    v_mfma_f32_32x32x16_bf16 v[96:111], v[128:131], v[48:51], v[96:111]
    s_waitcnt lgkmcnt(4)
    v_mfma_f32_32x32x16_bf16 v[112:127], v[172:175], v[48:51], v[112:127]
    ds_read_b128 v[128:131], v6 offset:11264
    ds_read_b128 v[172:175], v6 offset:52224
    s_waitcnt vmcnt(10)
    s_waitcnt lgkmcnt(5)
    v_mfma_f32_32x32x16_bf16 v[96:111], v[136:139], v[52:55], v[96:111]
    s_waitcnt lgkmcnt(4)
    v_mfma_f32_32x32x16_bf16 v[112:127], v[140:143], v[52:55], v[112:127]
    ds_read_b128 v[136:139], v6 offset:12288
    ds_read_b128 v[140:143], v6 offset:53248
    s_waitcnt vmcnt(9)
    s_waitcnt lgkmcnt(5)
    v_mfma_f32_32x32x16_bf16 v[96:111], v[144:147], v[56:59], v[96:111]
    s_waitcnt lgkmcnt(4)
    v_mfma_f32_32x32x16_bf16 v[112:127], v[164:167], v[56:59], v[112:127]
    ds_read_b128 v[144:147], v6 offset:13312
    ds_read_b128 v[164:167], v6 offset:54272
    s_waitcnt vmcnt(8)
    s_waitcnt lgkmcnt(5)
    v_mfma_f32_32x32x16_bf16 v[96:111], v[128:131], v[60:63], v[96:111]
    s_waitcnt lgkmcnt(4)
    v_mfma_f32_32x32x16_bf16 v[112:127], v[172:175], v[60:63], v[112:127]
    ds_read_b128 v[128:131], v6 offset:14336
    ds_read_b128 v[172:175], v6 offset:55296
    s_waitcnt vmcnt(7)
    s_waitcnt lgkmcnt(5)
    v_mfma_f32_32x32x16_bf16 v[96:111], v[136:139], v[64:67], v[96:111]
    s_waitcnt lgkmcnt(4)
    v_mfma_f32_32x32x16_bf16 v[112:127], v[140:143], v[64:67], v[112:127]
    s_add_u32 s41, s63, 0
    buffer_load_dwordx4 v[168:171], v135, s[28:31], s41 offen sc1
    ds_read_b128 v[136:139], v6 offset:15360
    ds_read_b128 v[140:143], v6 offset:56320
    s_waitcnt vmcnt(7)
    s_waitcnt lgkmcnt(5)
    v_mfma_f32_32x32x16_bf16 v[96:111], v[144:147], v[68:71], v[96:111]
    s_waitcnt lgkmcnt(4)
    v_mfma_f32_32x32x16_bf16 v[112:127], v[164:167], v[68:71], v[112:127]
    ds_read_b128 v[144:147], v6 offset:16384
    ds_read_b128 v[164:167], v6 offset:57344
    s_waitcnt vmcnt(6)
    s_waitcnt lgkmcnt(5)
    v_mfma_f32_32x32x16_bf16 v[96:111], v[128:131], v[72:75], v[96:111]
    s_waitcnt lgkmcnt(4)
    v_mfma_f32_32x32x16_bf16 v[112:127], v[172:175], v[72:75], v[112:127]
    ds_read_b128 v[128:131], v6 offset:17408
    ds_read_b128 v[172:175], v6 offset:58368
    s_waitcnt vmcnt(5)
    s_waitcnt lgkmcnt(5)
    v_mfma_f32_32x32x16_bf16 v[96:111], v[136:139], v[76:79], v[96:111]
    s_waitcnt lgkmcnt(4)
    v_mfma_f32_32x32x16_bf16 v[112:127], v[140:143], v[76:79], v[112:127]
    ds_read_b128 v[136:139], v6 offset:18432
    ds_read_b128 v[140:143], v6 offset:59392
    s_waitcnt vmcnt(4)
    s_waitcnt lgkmcnt(5)
    v_mfma_f32_32x32x16_bf16 v[96:111], v[144:147], v[80:83], v[96:111]
    s_waitcnt lgkmcnt(4)
    v_mfma_f32_32x32x16_bf16 v[112:127], v[164:167], v[80:83], v[112:127]
    ds_read_b128 v[144:147], v6 offset:19456
    ds_read_b128 v[164:167], v6 offset:60416
    s_waitcnt vmcnt(3)
    s_waitcnt lgkmcnt(5)
    v_mfma_f32_32x32x16_bf16 v[96:111], v[128:131], v[84:87], v[96:111]
    s_waitcnt lgkmcnt(4)
    v_mfma_f32_32x32x16_bf16 v[112:127], v[172:175], v[84:87], v[112:127]
    s_waitcnt vmcnt(2)
    s_waitcnt lgkmcnt(3)
    v_mfma_f32_32x32x16_bf16 v[96:111], v[136:139], v[88:91], v[96:111]
    s_waitcnt lgkmcnt(2)
    v_mfma_f32_32x32x16_bf16 v[112:127], v[140:143], v[88:91], v[112:127]
    s_waitcnt vmcnt(1)
    s_waitcnt lgkmcnt(1)
    v_mfma_f32_32x32x16_bf16 v[96:111], v[144:147], v[92:95], v[96:111]
    s_waitcnt lgkmcnt(0)
    v_mfma_f32_32x32x16_bf16 v[112:127], v[164:167], v[92:95], v[112:127]
    s_lshl_b32 s37, s62, 12
    s_add_u32 s37, s37, 0x80000
    buffer_load_dwordx2 v[148:149], v9, s[28:31], s37 offen offset:0 sc1
    buffer_load_dwordx2 v[150:151], v9, s[28:31], s37 offen offset:256 sc1
    buffer_load_dwordx2 v[152:153], v9, s[28:31], s37 offen offset:512 sc1
    buffer_load_dwordx2 v[154:155], v9, s[28:31], s37 offen offset:768 sc1
    buffer_load_dwordx2 v[156:157], v9, s[28:31], s37 offen offset:1024 sc1
    buffer_load_dwordx2 v[158:159], v9, s[28:31], s37 offen offset:1280 sc1
    buffer_load_dwordx2 v[160:161], v9, s[28:31], s37 offen offset:1536 sc1
    buffer_load_dwordx2 v[162:163], v9, s[28:31], s37 offen offset:1792 sc1
    v_add_u32 v9, 139264, v7
    s_nop 0
    ds_write_b128 v7, v[112:115] offset:0
    ds_write_b128 v7, v[116:119] offset:1024
    ds_write_b128 v7, v[120:123] offset:2048
    ds_write_b128 v7, v[124:127] offset:3072
    v_add_u32 v6, 40960, v6
    s_waitcnt lgkmcnt(0)
    s_barrier
    s_setprio 1
    v_add_u32 v6, 0xa000, v6
    ds_read_b128 v[136:139], v6 offset:0
    ds_read_b128 v[140:143], v6 offset:1024
    ds_read_b128 v[144:147], v6 offset:2048
    s_waitcnt lgkmcnt(2)
    v_mfma_f32_32x32x16_bf16 v[112:127], v[136:139], v[16:19], 0
    s_mul_i32 s37, s34, 40
    s_mul_i32 s38, s32, 5
    s_add_u32 s37, s37, s38
    s_lshl_b32 s37, s37, 10
    s_add_u32 s37, s37, 0x1ce0000
    s_lshl_b32 s38, s38, 10
    s_add_u32 m0, s38, 20480
    s_nop 0
    buffer_load_dwordx4 v135, s[28:31], s37 offen offset:0 sc1 lds
    buffer_load_dwordx4 v135, s[28:31], s37 offen offset:1024 sc1 lds
    buffer_load_dwordx4 v135, s[28:31], s37 offen offset:2048 sc1 lds
    buffer_load_dwordx4 v135, s[28:31], s37 offen offset:3072 sc1 lds
    s_add_u32 s37, s37, 4096
    s_add_u32 m0, m0, 4096
    s_nop 0
    buffer_load_dwordx4 v135, s[28:31], s37 offen sc1 lds
    ds_read_b128 v[136:139], v6 offset:3072
    s_waitcnt lgkmcnt(2)
    v_mfma_f32_32x32x16_bf16 v[112:127], v[140:143], v[20:23], v[112:127]
    ds_read_b128 v[140:143], v6 offset:4096
    s_waitcnt lgkmcnt(2)
    v_mfma_f32_32x32x16_bf16 v[112:127], v[144:147], v[24:27], v[112:127]
    ds_read_b128 v[144:147], v6 offset:5120
    s_waitcnt lgkmcnt(2)
    v_mfma_f32_32x32x16_bf16 v[112:127], v[136:139], v[28:31], v[112:127]
    s_waitcnt vmcnt(5)
    v_add_f32 v148, v148, v156
    v_add_f32 v149, v149, v157
    v_add_f32 v150, v150, v158
    v_add_f32 v151, v151, v159
    v_add_f32 v152, v152, v160
    v_add_f32 v153, v153, v161
    v_add_f32 v154, v154, v162
    v_add_f32 v155, v155, v163
    v_add_f32 v148, v148, v152
    v_add_f32 v149, v149, v153
    v_add_f32 v150, v150, v154
    v_add_f32 v151, v151, v155
    v_add_f32 v148, v148, v150
    v_add_f32 v149, v149, v151
    v_mov_b32 v150, v148
    v_mov_b32 v151, v149
    s_nop 1
    v_permlane32_swap_b32 v148, v150
    v_permlane32_swap_b32 v149, v151
    v_add_f32 v148, v148, v150
    v_add_f32 v149, v149, v151
    v_mul_f32 v148, 0xbacccccd, v148
    v_mul_f32 v149, 0x3acccccd, v149
    v_fma_f32 v149, -v148, v148, v149
    v_max_f32 v149, 0, v149
    v_add_f32 v149, 0x3727c5ac, v149
    v_rsq_f32 v8, v149
    v_mov_b32 v5, v149
    v_mul_f32 v149, v149, v8
    v_mul_f32 v4, v8, v8
    v_mul_f32 v4, v4, v8
    v_mul_f32 v4, 0xbdd2d3e8, v4
    v_mul_f32 v8, 0xc0135761, v8
    v_cvt_pk_bf16_f32 v150, v148, v148
    v_and_b32 v150, 0xffff0000, v150
    v_sub_f32 v152, v148, v150
    v_cvt_pk_bf16_f32 v151, v149, v149
    v_and_b32 v151, 0xffff0000, v151
    v_sub_f32 v153, v149, v151
    v_cvt_pk_bf16_f32 v164, v150, v150
    v_cvt_pk_bf16_f32 v165, v152, v151
    v_cvt_pk_bf16_f32 v166, v151, v153
    v_mov_b32 v167, 0
    ds_read_b128 v[136:139], v6 offset:6144
    s_waitcnt lgkmcnt(2)
    v_mfma_f32_32x32x16_bf16 v[112:127], v[140:143], v[32:35], v[112:127]
    v_mfma_f32_32x32x16_bf16 v[96:111], v[168:171], v[164:167], v[96:111]
    s_add_u32 s41, s63, 32768
    buffer_load_dwordx4 v[168:171], v135, s[28:31], s41 offen sc1
    ds_read_b128 v[140:143], v6 offset:7168
    s_waitcnt lgkmcnt(2)
    v_mfma_f32_32x32x16_bf16 v[112:127], v[144:147], v[36:39], v[112:127]
    ds_read_b128 v[148:151], v9 offset:0
    ds_read_b128 v[152:155], v9 offset:1024
    ds_read_b128 v[156:159], v9 offset:2048
    ds_read_b128 v[160:163], v9 offset:3072
    s_nop 2
    ds_read_b128 v[144:147], v6 offset:8192
    s_waitcnt lgkmcnt(6)
    v_mfma_f32_32x32x16_bf16 v[112:127], v[136:139], v[40:43], v[112:127]
    s_waitcnt lgkmcnt(4)
    v_add_f32 v96, v96, v148
    v_add_f32 v97, v97, v149
    v_add_f32 v98, v98, v150
    v_add_f32 v99, v99, v151
    s_waitcnt lgkmcnt(2)
    v_add_f32 v104, v104, v156
    v_add_f32 v105, v105, v157
    v_add_f32 v106, v106, v158
    ds_read_b128 v[136:139], v6 offset:9216
    v_mfma_f32_32x32x16_bf16 v[112:127], v[140:143], v[44:47], v[112:127]
    v_add_f32 v107, v107, v159
    v_add_f32 v100, v100, v152
    v_add_f32 v101, v101, v153
    v_add_f32 v102, v102, v154
    v_add_f32 v103, v103, v155
    s_waitcnt lgkmcnt(2)
    v_add_f32 v108, v108, v160
    v_add_f32 v109, v109, v161
    ds_read_b128 v[140:143], v6 offset:10240
    s_waitcnt lgkmcnt(2)
    v_mfma_f32_32x32x16_bf16 v[112:127], v[144:147], v[48:51], v[112:127]
    v_add_f32 v110, v110, v162
    v_add_f32 v111, v111, v163
    v_mul_f32 v128, v96, v96
    v_mul_f32 v130, v97, v97
    v_fma_f32 v128, v128, v4, v8
    v_fma_f32 v130, v130, v4, v8
    v_mul_f32 v128, v128, v96
    ds_read_b128 v[144:147], v6 offset:11264
    s_waitcnt lgkmcnt(2)
    v_mfma_f32_32x32x16_bf16 v[112:127], v[136:139], v[52:55], v[112:127]
    v_mul_f32 v130, v130, v97
    v_exp_f32 v128, v128
    v_exp_f32 v130, v130
    v_mul_f32 v96, v96, v104
    v_mul_f32 v97, v97, v105
    v_fma_f32 v128, v128, v5, v5
    v_fma_f32 v130, v130, v5, v5
    ds_read_b128 v[136:139], v6 offset:12288
    s_waitcnt lgkmcnt(2)
    v_mfma_f32_32x32x16_bf16 v[112:127], v[140:143], v[56:59], v[112:127]
    v_rcp_f32 v128, v128
    v_rcp_f32 v130, v130
    s_nop 0
    v_mul_f32 v96, v96, v128
    v_mul_f32 v97, v97, v130
    v_cvt_pk_bf16_f32 v172, v96, v97
    v_mul_f32 v128, v98, v98
    ds_read_b128 v[140:143], v6 offset:13312
    s_waitcnt lgkmcnt(2)
    v_mfma_f32_32x32x16_bf16 v[112:127], v[144:147], v[60:63], v[112:127]
    v_mul_f32 v130, v99, v99
    v_fma_f32 v128, v128, v4, v8
    v_fma_f32 v130, v130, v4, v8
    v_mul_f32 v128, v128, v98
    v_mul_f32 v130, v130, v99
    v_exp_f32 v128, v128
    v_exp_f32 v130, v130
    ds_read_b128 v[144:147], v6 offset:14336
    s_waitcnt lgkmcnt(2)
    v_mfma_f32_32x32x16_bf16 v[112:127], v[136:139], v[64:67], v[112:127]
    v_mul_f32 v98, v98, v106
    v_mul_f32 v99, v99, v107
    v_fma_f32 v128, v128, v5, v5
    v_fma_f32 v130, v130, v5, v5
    v_rcp_f32 v128, v128
    v_rcp_f32 v130, v130
    s_nop 0
    ds_read_b128 v[136:139], v6 offset:15360
    s_waitcnt lgkmcnt(2)
    v_mfma_f32_32x32x16_bf16 v[112:127], v[140:143], v[68:71], v[112:127]
    v_mul_f32 v98, v98, v128
    v_mul_f32 v99, v99, v130
    v_cvt_pk_bf16_f32 v173, v98, v99
    v_mul_f32 v128, v100, v100
    v_mul_f32 v130, v101, v101
    v_fma_f32 v128, v128, v4, v8
    v_fma_f32 v130, v130, v4, v8
    ds_read_b128 v[140:143], v6 offset:16384
    s_waitcnt lgkmcnt(2)
    v_mfma_f32_32x32x16_bf16 v[112:127], v[144:147], v[72:75], v[112:127]
    v_mul_f32 v128, v128, v100
    v_mul_f32 v130, v130, v101
    v_exp_f32 v128, v128
    v_exp_f32 v130, v130
    v_mul_f32 v100, v100, v108
    v_mul_f32 v101, v101, v109
    v_fma_f32 v128, v128, v5, v5
    ds_read_b128 v[144:147], v6 offset:17408
    s_waitcnt lgkmcnt(2)
    v_mfma_f32_32x32x16_bf16 v[112:127], v[136:139], v[76:79], v[112:127]
    v_fma_f32 v130, v130, v5, v5
    v_rcp_f32 v128, v128
    v_rcp_f32 v130, v130
    s_nop 0
    v_mul_f32 v100, v100, v128
    v_mul_f32 v101, v101, v130
    v_cvt_pk_bf16_f32 v174, v100, v101
    ds_read_b128 v[136:139], v6 offset:18432
    s_waitcnt lgkmcnt(2)
    v_mfma_f32_32x32x16_bf16 v[112:127], v[140:143], v[80:83], v[112:127]
    v_mul_f32 v128, v102, v102
    v_mul_f32 v130, v103, v103
    v_fma_f32 v128, v128, v4, v8
    v_fma_f32 v130, v130, v4, v8
    v_mul_f32 v128, v128, v102
    v_mul_f32 v130, v130, v103
    v_exp_f32 v128, v128
    ds_read_b128 v[140:143], v6 offset:19456
    s_waitcnt lgkmcnt(2)
    v_mfma_f32_32x32x16_bf16 v[112:127], v[144:147], v[84:87], v[112:127]
    v_exp_f32 v130, v130
    v_mul_f32 v102, v102, v110
    v_mul_f32 v103, v103, v111
    v_fma_f32 v128, v128, v5, v5
    v_fma_f32 v130, v130, v5, v5
    v_rcp_f32 v128, v128
    v_rcp_f32 v130, v130
    s_waitcnt lgkmcnt(1)
    v_mfma_f32_32x32x16_bf16 v[112:127], v[136:139], v[88:91], v[112:127]
    s_nop 0
    v_mul_f32 v102, v102, v128
    v_mul_f32 v103, v103, v130
    v_cvt_pk_bf16_f32 v175, v102, v103
    s_add_u32 s41, s60, 0
    buffer_store_dwordx4 v[172:175], v135, s[28:31], s41 offen sc1
    s_waitcnt lgkmcnt(0)
    v_mfma_f32_32x32x16_bf16 v[112:127], v[140:143], v[92:95], v[112:127]
    s_waitcnt vmcnt(2)
    s_waitcnt lgkmcnt(0)
    s_barrier
    s_setprio 1
    v_add_u32 v6, 0xfffec000, v6
    ds_read_b128 v[136:139], v6 offset:0
    ds_read_b128 v[140:143], v6 offset:1024
    ds_read_b128 v[144:147], v6 offset:2048
    s_waitcnt lgkmcnt(2)
    v_mfma_f32_32x32x16_bf16 v[96:111], v[136:139], v[16:19], 0
    s_waitcnt vmcnt(1)
    v_mfma_f32_32x32x16_bf16 v[112:127], v[168:171], v[164:167], v[112:127]
    ds_read_b128 v[136:139], v6 offset:3072
    s_waitcnt lgkmcnt(2)
    v_mfma_f32_32x32x16_bf16 v[96:111], v[140:143], v[20:23], v[96:111]
    ds_read_b128 v[148:151], v7 offset:0
    ds_read_b128 v[152:155], v7 offset:1024
    ds_read_b128 v[156:159], v7 offset:2048
    ds_read_b128 v[160:163], v7 offset:3072
    s_nop 2
    ds_read_b128 v[140:143], v6 offset:4096
    s_waitcnt lgkmcnt(6)
    v_mfma_f32_32x32x16_bf16 v[96:111], v[144:147], v[24:27], v[96:111]
    s_waitcnt lgkmcnt(4)
    v_add_f32 v112, v112, v148
    v_add_f32 v113, v113, v149
    v_add_f32 v114, v114, v150
    v_add_f32 v115, v115, v151
    s_waitcnt lgkmcnt(2)
    v_add_f32 v120, v120, v156
    v_add_f32 v121, v121, v157
    ds_read_b128 v[144:147], v6 offset:5120
    v_mfma_f32_32x32x16_bf16 v[96:111], v[136:139], v[28:31], v[96:111]
    v_add_f32 v122, v122, v158
    v_add_f32 v123, v123, v159
    v_add_f32 v116, v116, v152
    v_add_f32 v117, v117, v153
    v_add_f32 v118, v118, v154
    v_add_f32 v119, v119, v155
    ds_read_b128 v[136:139], v6 offset:6144
    s_waitcnt lgkmcnt(2)
    v_mfma_f32_32x32x16_bf16 v[96:111], v[140:143], v[32:35], v[96:111]
    v_add_f32 v124, v124, v160
    v_add_f32 v125, v125, v161
    v_add_f32 v126, v126, v162
    v_add_f32 v127, v127, v163
    v_mul_f32 v128, v112, v112
    v_mul_f32 v130, v113, v113
    ds_read_b128 v[140:143], v6 offset:7168
    s_waitcnt lgkmcnt(2)
    v_mfma_f32_32x32x16_bf16 v[96:111], v[144:147], v[36:39], v[96:111]
    v_fma_f32 v128, v128, v4, v8
    v_fma_f32 v130, v130, v4, v8
    v_mul_f32 v128, v128, v112
    v_mul_f32 v130, v130, v113
    v_exp_f32 v128, v128
    v_exp_f32 v130, v130
    ds_read_b128 v[144:147], v6 offset:8192
    s_waitcnt lgkmcnt(2)
    v_mfma_f32_32x32x16_bf16 v[96:111], v[136:139], v[40:43], v[96:111]
    v_mul_f32 v112, v112, v120
    v_mul_f32 v113, v113, v121
    v_fma_f32 v128, v128, v5, v5
    v_fma_f32 v130, v130, v5, v5
    v_rcp_f32 v128, v128
    v_rcp_f32 v130, v130
    ds_read_b128 v[136:139], v6 offset:9216
    s_waitcnt lgkmcnt(2)
    v_mfma_f32_32x32x16_bf16 v[96:111], v[140:143], v[44:47], v[96:111]
    s_nop 0
    v_mul_f32 v112, v112, v128
    v_mul_f32 v113, v113, v130
    v_cvt_pk_bf16_f32 v172, v112, v113
    v_mul_f32 v128, v114, v114
    v_mul_f32 v130, v115, v115
    ds_read_b128 v[140:143], v6 offset:10240
    s_waitcnt lgkmcnt(2)
    v_mfma_f32_32x32x16_bf16 v[96:111], v[144:147], v[48:51], v[96:111]
    v_fma_f32 v128, v128, v4, v8
    v_fma_f32 v130, v130, v4, v8
    v_mul_f32 v128, v128, v114
    v_mul_f32 v130, v130, v115
    v_exp_f32 v128, v128
    v_exp_f32 v130, v130
    ds_read_b128 v[144:147], v6 offset:11264
    s_waitcnt lgkmcnt(2)
    v_mfma_f32_32x32x16_bf16 v[96:111], v[136:139], v[52:55], v[96:111]
    v_mul_f32 v114, v114, v122
    v_mul_f32 v115, v115, v123
    v_fma_f32 v128, v128, v5, v5
    v_fma_f32 v130, v130, v5, v5
    v_rcp_f32 v128, v128
    v_rcp_f32 v130, v130
    ds_read_b128 v[136:139], v6 offset:12288
    s_waitcnt lgkmcnt(2)
    v_mfma_f32_32x32x16_bf16 v[96:111], v[140:143], v[56:59], v[96:111]
    s_nop 0
    v_mul_f32 v114, v114, v128
    v_mul_f32 v115, v115, v130
    v_cvt_pk_bf16_f32 v173, v114, v115
    v_mul_f32 v128, v116, v116
    v_mul_f32 v130, v117, v117
    ds_read_b128 v[140:143], v6 offset:13312
    s_waitcnt lgkmcnt(2)
    v_mfma_f32_32x32x16_bf16 v[96:111], v[144:147], v[60:63], v[96:111]
    v_fma_f32 v128, v128, v4, v8
    v_fma_f32 v130, v130, v4, v8
    v_mul_f32 v128, v128, v116
    v_mul_f32 v130, v130, v117
    v_exp_f32 v128, v128
    v_exp_f32 v130, v130
    ds_read_b128 v[144:147], v6 offset:14336
    s_waitcnt lgkmcnt(2)
    v_mfma_f32_32x32x16_bf16 v[96:111], v[136:139], v[64:67], v[96:111]
    v_mul_f32 v116, v116, v124
    v_mul_f32 v117, v117, v125
    v_fma_f32 v128, v128, v5, v5
    v_fma_f32 v130, v130, v5, v5
    v_rcp_f32 v128, v128
    v_rcp_f32 v130, v130
    ds_read_b128 v[136:139], v6 offset:15360
    s_waitcnt lgkmcnt(2)
    v_mfma_f32_32x32x16_bf16 v[96:111], v[140:143], v[68:71], v[96:111]
    s_nop 0
    v_mul_f32 v116, v116, v128
    v_mul_f32 v117, v117, v130
    v_cvt_pk_bf16_f32 v174, v116, v117
    v_mul_f32 v128, v118, v118
    v_mul_f32 v130, v119, v119
    ds_read_b128 v[140:143], v6 offset:16384
    s_waitcnt lgkmcnt(2)
    v_mfma_f32_32x32x16_bf16 v[96:111], v[144:147], v[72:75], v[96:111]
    v_fma_f32 v128, v128, v4, v8
    v_fma_f32 v130, v130, v4, v8
    v_mul_f32 v128, v128, v118
    v_mul_f32 v130, v130, v119
    v_exp_f32 v128, v128
    v_exp_f32 v130, v130
    ds_read_b128 v[144:147], v6 offset:17408
    s_waitcnt lgkmcnt(2)
    v_mfma_f32_32x32x16_bf16 v[96:111], v[136:139], v[76:79], v[96:111]
    v_mul_f32 v118, v118, v126
    v_mul_f32 v119, v119, v127
    v_fma_f32 v128, v128, v5, v5
    v_fma_f32 v130, v130, v5, v5
    v_rcp_f32 v128, v128
    v_rcp_f32 v130, v130
    ds_read_b128 v[136:139], v6 offset:18432
    s_waitcnt lgkmcnt(2)
    v_mfma_f32_32x32x16_bf16 v[96:111], v[140:143], v[80:83], v[96:111]
    s_nop 0
    v_mul_f32 v118, v118, v128
    v_mul_f32 v119, v119, v130
    v_cvt_pk_bf16_f32 v175, v118, v119
    s_add_u32 s41, s60, 32768
    buffer_store_dwordx4 v[172:175], v135, s[28:31], s41 offen sc1
    ds_read_b128 v[140:143], v6 offset:19456
    s_waitcnt lgkmcnt(2)
    v_mfma_f32_32x32x16_bf16 v[96:111], v[144:147], v[84:87], v[96:111]
    s_waitcnt lgkmcnt(1)
    v_mfma_f32_32x32x16_bf16 v[96:111], v[136:139], v[88:91], v[96:111]
    s_waitcnt lgkmcnt(0)
    v_mfma_f32_32x32x16_bf16 v[96:111], v[140:143], v[92:95], v[96:111]
    s_nop 11
    ds_write_b128 v7, v[96:99] offset:0
    ds_write_b128 v7, v[100:103] offset:1024
    ds_write_b128 v7, v[104:107] offset:2048
    ds_write_b128 v7, v[108:111] offset:3072
    s_waitcnt vmcnt(1)
    s_waitcnt lgkmcnt(0)
    s_barrier
    s_setprio 0
    s_cmp_lg_u32 s32, 0
    s_cbranch_scc1 Lf4_9
    s_add_u32 s38, s35, 2
    s_lshl_b32 s37, s36, 7
    s_add_u32 s37, s37, 0x30000
    v_mov_b32 v2, s38
    v_mov_b32 v3, 0
    s_mov_b64 exec, 1
    buffer_store_dword v2, v3, s[28:31], s37 offen sc1
    s_mov_b64 exec, -1
Lf4_9:
    v_add_u32 v6, 0x14000, v6
    ds_read_b128 v[136:139], v6 offset:0
    ds_read_b128 v[140:143], v6 offset:1024
    ds_read_b128 v[144:147], v6 offset:2048
    s_waitcnt lgkmcnt(2)
    v_mfma_f32_32x32x16_bf16 v[96:111], v[136:139], v[16:19], 0
    s_mul_i32 s39, s34, 40
    s_and_b32 s38, s32, 3
    s_mul_i32 s38, s38, 10
    s_add_u32 s39, s39, s38
    s_lshl_b32 s39, s39, 10
    s_add_u32 s39, s39, 0x1e20000
    s_lshl_b32 s38, s38, 10
    s_add_u32 m0, s38, 20480
    s_nop 0
    buffer_load_dwordx4 v135, s[28:31], s39 offen offset:0 sc1 lds
    buffer_load_dwordx4 v135, s[28:31], s39 offen offset:1024 sc1 lds
    ds_read_b128 v[136:139], v6 offset:3072
    s_waitcnt lgkmcnt(2)
    v_mfma_f32_32x32x16_bf16 v[96:111], v[140:143], v[20:23], v[96:111]
    buffer_load_dwordx4 v135, s[28:31], s39 offen offset:2048 sc1 lds
    buffer_load_dwordx4 v135, s[28:31], s39 offen offset:3072 sc1 lds
    ds_read_b128 v[140:143], v6 offset:4096
    s_waitcnt lgkmcnt(2)
    v_mfma_f32_32x32x16_bf16 v[96:111], v[144:147], v[24:27], v[96:111]
    s_add_u32 s39, s39, 4096
    s_add_u32 m0, m0, 4096
    s_nop 0
    buffer_load_dwordx4 v135, s[28:31], s39 offen offset:0 sc1 lds
    buffer_load_dwordx4 v135, s[28:31], s39 offen offset:1024 sc1 lds
    ds_read_b128 v[144:147], v6 offset:5120
    s_waitcnt lgkmcnt(2)
    v_mfma_f32_32x32x16_bf16 v[96:111], v[136:139], v[28:31], v[96:111]
    buffer_load_dwordx4 v135, s[28:31], s39 offen offset:2048 sc1 lds
    buffer_load_dwordx4 v135, s[28:31], s39 offen offset:3072 sc1 lds
    ds_read_b128 v[136:139], v6 offset:6144
    s_waitcnt lgkmcnt(2)
    v_mfma_f32_32x32x16_bf16 v[96:111], v[140:143], v[32:35], v[96:111]
    s_add_u32 s39, s39, 4096
    s_add_u32 m0, m0, 4096
    s_nop 0
    buffer_load_dwordx4 v135, s[28:31], s39 offen offset:0 sc1 lds
    buffer_load_dwordx4 v135, s[28:31], s39 offen offset:1024 sc1 lds
    s_add_u32 s41, s63, 65536
    buffer_load_dwordx4 v[168:171], v135, s[28:31], s41 offen sc1
    ds_read_b128 v[140:143], v6 offset:7168
    s_waitcnt lgkmcnt(2)
    v_mfma_f32_32x32x16_bf16 v[96:111], v[144:147], v[36:39], v[96:111]
    ds_read_b128 v[144:147], v6 offset:8192
    s_waitcnt lgkmcnt(2)
    v_mfma_f32_32x32x16_bf16 v[96:111], v[136:139], v[40:43], v[96:111]
    ds_read_b128 v[136:139], v6 offset:9216
    s_waitcnt lgkmcnt(2)
    v_mfma_f32_32x32x16_bf16 v[96:111], v[140:143], v[44:47], v[96:111]
    ds_read_b128 v[140:143], v6 offset:10240
    s_waitcnt lgkmcnt(2)
    v_mfma_f32_32x32x16_bf16 v[96:111], v[144:147], v[48:51], v[96:111]
    ds_read_b128 v[144:147], v6 offset:11264
    s_waitcnt lgkmcnt(2)
    v_mfma_f32_32x32x16_bf16 v[96:111], v[136:139], v[52:55], v[96:111]
    ds_read_b128 v[136:139], v6 offset:12288
    s_waitcnt lgkmcnt(2)
    v_mfma_f32_32x32x16_bf16 v[96:111], v[140:143], v[56:59], v[96:111]
    ds_read_b128 v[140:143], v6 offset:13312
    s_waitcnt lgkmcnt(2)
    v_mfma_f32_32x32x16_bf16 v[96:111], v[144:147], v[60:63], v[96:111]
    ds_read_b128 v[144:147], v6 offset:14336
    s_waitcnt lgkmcnt(2)
    v_mfma_f32_32x32x16_bf16 v[96:111], v[136:139], v[64:67], v[96:111]
    s_add_u32 s41, s61, 0x0
    buffer_load_dwordx4 v[176:179], v135, s[28:31], s41 offen sc1
    ds_read_b128 v[136:139], v6 offset:15360
    s_waitcnt lgkmcnt(2)
    v_mfma_f32_32x32x16_bf16 v[96:111], v[140:143], v[68:71], v[96:111]
    s_add_u32 s41, s61, 0xd800
    buffer_load_dwordx4 v[180:183], v135, s[28:31], s41 offen sc1
    ds_read_b128 v[140:143], v6 offset:16384
    s_waitcnt lgkmcnt(2)
    v_mfma_f32_32x32x16_bf16 v[96:111], v[144:147], v[72:75], v[96:111]
    s_add_u32 s41, s61, 0x1b000
    buffer_load_dwordx4 v[184:187], v135, s[28:31], s41 offen sc1
    ds_read_b128 v[144:147], v6 offset:17408
    s_waitcnt lgkmcnt(2)
    v_mfma_f32_32x32x16_bf16 v[96:111], v[136:139], v[76:79], v[96:111]
    s_add_u32 s41, s61, 0x400
    buffer_load_dwordx4 v[188:191], v135, s[28:31], s41 offen sc1
    ds_read_b128 v[136:139], v6 offset:18432
    s_waitcnt lgkmcnt(2)
    v_mfma_f32_32x32x16_bf16 v[96:111], v[140:143], v[80:83], v[96:111]
    s_add_u32 s41, s61, 0xdc00
    buffer_load_dwordx4 v[192:195], v135, s[28:31], s41 offen sc1
    ds_read_b128 v[140:143], v6 offset:19456
    s_waitcnt lgkmcnt(2)
    v_mfma_f32_32x32x16_bf16 v[96:111], v[144:147], v[84:87], v[96:111]
    s_waitcnt lgkmcnt(1)
    v_mfma_f32_32x32x16_bf16 v[96:111], v[136:139], v[88:91], v[96:111]
    s_waitcnt lgkmcnt(0)
    v_mfma_f32_32x32x16_bf16 v[96:111], v[140:143], v[92:95], v[96:111]
    s_waitcnt vmcnt(6)
    s_waitcnt lgkmcnt(0)
    s_barrier
    s_setprio 1
    s_cmp_lg_u32 s32, 0
    s_cbranch_scc1 Lf4_10
    s_add_u32 s38, s35, 3
    s_lshl_b32 s37, s36, 7
    s_add_u32 s37, s37, 0x30000
    v_mov_b32 v2, s38
    v_mov_b32 v3, 0
    s_mov_b64 exec, 1
    buffer_store_dword v2, v3, s[28:31], s37 offen sc1
    s_mov_b64 exec, -1
Lf4_10:
    v_add_u32 v6, 0xfffec000, v6
    ds_read_b128 v[136:139], v6 offset:0
    ds_read_b128 v[140:143], v6 offset:1024
    ds_read_b128 v[144:147], v6 offset:2048
    s_waitcnt lgkmcnt(2)
    v_mfma_f32_32x32x16_bf16 v[112:127], v[136:139], v[16:19], 0
    s_waitcnt vmcnt(5)
    v_mfma_f32_32x32x16_bf16 v[96:111], v[168:171], v[164:167], v[96:111]
    ds_read_b128 v[136:139], v6 offset:3072
    s_waitcnt lgkmcnt(2)
    v_mfma_f32_32x32x16_bf16 v[112:127], v[140:143], v[20:23], v[112:127]
    ds_read_b128 v[148:151], v7 offset:0
    ds_read_b128 v[152:155], v7 offset:1024
    ds_read_b128 v[156:159], v7 offset:2048
    ds_read_b128 v[160:163], v7 offset:3072
    s_nop 2
    ds_read_b128 v[140:143], v6 offset:4096
    s_waitcnt lgkmcnt(6)
    v_mfma_f32_32x32x16_bf16 v[112:127], v[144:147], v[24:27], v[112:127]
    s_waitcnt lgkmcnt(4)
    v_add_f32 v96, v96, v148
    v_add_f32 v97, v97, v149
    v_add_f32 v98, v98, v150
    v_add_f32 v99, v99, v151
    s_waitcnt lgkmcnt(2)
    v_add_f32 v104, v104, v156
    v_add_f32 v105, v105, v157
    s_cmp_lg_u32 s32, 3
    s_cbranch_scc1 Lai_11
    v_and_b32 v132, 15, v1
    s_lshl_b32 s37, s33, 11
    s_add_u32 s37, s37, 0x30000
    v_lshl_add_u32 v132, v132, 7, s37
    buffer_load_dword v133, v132, s[28:31], 0 offen sc1
Lai_11:
    ds_read_b128 v[144:147], v6 offset:5120
    v_mfma_f32_32x32x16_bf16 v[112:127], v[136:139], v[28:31], v[112:127]
    v_add_f32 v106, v106, v158
    v_add_f32 v107, v107, v159
    v_add_f32 v100, v100, v152
    v_add_f32 v101, v101, v153
    v_add_f32 v102, v102, v154
    v_add_f32 v103, v103, v155
    ds_read_b128 v[136:139], v6 offset:6144
    s_waitcnt lgkmcnt(2)
    v_mfma_f32_32x32x16_bf16 v[112:127], v[140:143], v[32:35], v[112:127]
    v_add_f32 v108, v108, v160
    v_add_f32 v109, v109, v161
    v_add_f32 v110, v110, v162
    v_add_f32 v111, v111, v163
    v_mul_f32 v128, v96, v96
    v_mul_f32 v130, v97, v97
    ds_read_b128 v[140:143], v6 offset:7168
    s_waitcnt lgkmcnt(2)
    v_mfma_f32_32x32x16_bf16 v[112:127], v[144:147], v[36:39], v[112:127]
    v_fma_f32 v128, v128, v4, v8
    v_fma_f32 v130, v130, v4, v8
    v_mul_f32 v128, v128, v96
    v_mul_f32 v130, v130, v97
    v_exp_f32 v128, v128
    v_exp_f32 v130, v130
    ds_read_b128 v[144:147], v6 offset:8192
    s_waitcnt lgkmcnt(2)
    v_mfma_f32_32x32x16_bf16 v[112:127], v[136:139], v[40:43], v[112:127]
    v_mul_f32 v96, v96, v104
    v_mul_f32 v97, v97, v105
    v_fma_f32 v128, v128, v5, v5
    v_fma_f32 v130, v130, v5, v5
    v_rcp_f32 v128, v128
    v_rcp_f32 v130, v130
    ds_read_b128 v[136:139], v6 offset:9216
    s_waitcnt lgkmcnt(2)
    v_mfma_f32_32x32x16_bf16 v[112:127], v[140:143], v[44:47], v[112:127]
    s_nop 0
    v_mul_f32 v96, v96, v128
    v_mul_f32 v97, v97, v130
    v_cvt_pk_bf16_f32 v172, v96, v97
    v_mul_f32 v128, v98, v98
    v_mul_f32 v130, v99, v99
    ds_read_b128 v[140:143], v6 offset:10240
    s_waitcnt lgkmcnt(2)
    v_mfma_f32_32x32x16_bf16 v[112:127], v[144:147], v[48:51], v[112:127]
    v_fma_f32 v128, v128, v4, v8
    v_fma_f32 v130, v130, v4, v8
    v_mul_f32 v128, v128, v98
    v_mul_f32 v130, v130, v99
    v_exp_f32 v128, v128
    v_exp_f32 v130, v130
    ds_read_b128 v[144:147], v6 offset:11264
    s_waitcnt lgkmcnt(2)
    v_mfma_f32_32x32x16_bf16 v[112:127], v[136:139], v[52:55], v[112:127]
    v_mul_f32 v98, v98, v106
    v_mul_f32 v99, v99, v107
    v_fma_f32 v128, v128, v5, v5
    v_fma_f32 v130, v130, v5, v5
    v_rcp_f32 v128, v128
    v_rcp_f32 v130, v130
    ds_read_b128 v[136:139], v6 offset:12288
    s_waitcnt lgkmcnt(2)
    v_mfma_f32_32x32x16_bf16 v[112:127], v[140:143], v[56:59], v[112:127]
    s_nop 0
    v_mul_f32 v98, v98, v128
    v_mul_f32 v99, v99, v130
    v_cvt_pk_bf16_f32 v173, v98, v99
    v_mul_f32 v128, v100, v100
    v_mul_f32 v130, v101, v101
    ds_read_b128 v[140:143], v6 offset:13312
    s_waitcnt lgkmcnt(2)
    v_mfma_f32_32x32x16_bf16 v[112:127], v[144:147], v[60:63], v[112:127]
    v_fma_f32 v128, v128, v4, v8
    v_fma_f32 v130, v130, v4, v8
    v_mul_f32 v128, v128, v100
    v_mul_f32 v130, v130, v101
    v_exp_f32 v128, v128
    v_exp_f32 v130, v130
    ds_read_b128 v[144:147], v6 offset:14336
    s_waitcnt lgkmcnt(2)
    v_mfma_f32_32x32x16_bf16 v[112:127], v[136:139], v[64:67], v[112:127]
    v_mul_f32 v100, v100, v108
    v_mul_f32 v101, v101, v109
    v_fma_f32 v128, v128, v5, v5
    v_fma_f32 v130, v130, v5, v5
    v_rcp_f32 v128, v128
    v_rcp_f32 v130, v130
    ds_read_b128 v[136:139], v6 offset:15360
    s_waitcnt lgkmcnt(2)
    v_mfma_f32_32x32x16_bf16 v[112:127], v[140:143], v[68:71], v[112:127]
    s_nop 0
    v_mul_f32 v100, v100, v128
    v_mul_f32 v101, v101, v130
    v_cvt_pk_bf16_f32 v174, v100, v101
    v_mul_f32 v128, v102, v102
    v_mul_f32 v130, v103, v103
    ds_read_b128 v[140:143], v6 offset:16384
    s_waitcnt lgkmcnt(2)
    v_mfma_f32_32x32x16_bf16 v[112:127], v[144:147], v[72:75], v[112:127]
    v_fma_f32 v128, v128, v4, v8
    v_fma_f32 v130, v130, v4, v8
    v_mul_f32 v128, v128, v102
    v_mul_f32 v130, v130, v103
    v_exp_f32 v128, v128
    v_exp_f32 v130, v130
    ds_read_b128 v[144:147], v6 offset:17408
    s_waitcnt lgkmcnt(2)
    v_mfma_f32_32x32x16_bf16 v[112:127], v[136:139], v[76:79], v[112:127]
    v_mul_f32 v102, v102, v110
    v_mul_f32 v103, v103, v111
    v_fma_f32 v128, v128, v5, v5
    v_fma_f32 v130, v130, v5, v5
    v_rcp_f32 v128, v128
    v_rcp_f32 v130, v130
    ds_read_b128 v[136:139], v6 offset:18432
    s_waitcnt lgkmcnt(2)
    v_mfma_f32_32x32x16_bf16 v[112:127], v[140:143], v[80:83], v[112:127]
    s_nop 0
    v_mul_f32 v102, v102, v128
    v_mul_f32 v103, v103, v130
    v_cvt_pk_bf16_f32 v175, v102, v103
    s_add_u32 s41, s60, 65536
    buffer_store_dwordx4 v[172:175], v135, s[28:31], s41 offen sc1
    ds_read_b128 v[140:143], v6 offset:19456
    s_waitcnt lgkmcnt(2)
    v_mfma_f32_32x32x16_bf16 v[112:127], v[144:147], v[84:87], v[112:127]
    s_waitcnt lgkmcnt(1)
    v_mfma_f32_32x32x16_bf16 v[112:127], v[136:139], v[88:91], v[112:127]
    s_waitcnt lgkmcnt(0)
    v_mfma_f32_32x32x16_bf16 v[112:127], v[140:143], v[92:95], v[112:127]
    s_nop 11
    ds_write_b128 v7, v[112:115] offset:0
    ds_write_b128 v7, v[116:119] offset:1024
    ds_write_b128 v7, v[120:123] offset:2048
    ds_write_b128 v7, v[124:127] offset:3072
    s_cmp_ge_u32 s34, 12
    s_cbranch_scc1 Lp4x0
    s_cmp_lg_u32 s32, 3
    s_cbranch_scc1 Lac_12
    s_waitcnt vmcnt(1)
    v_subrev_u32 v133, s35, v133
    v_subrev_u32 v133, 2, v133
    v_cmp_lt_u32 vcc, 5, v133
    s_cbranch_vccz Lac_12
    s_mov_b32 s46, 30000
Lpa_13:
    buffer_load_dword v133, v132, s[28:31], 0 offen sc1
    s_waitcnt vmcnt(0)
    v_subrev_u32 v133, s35, v133
    v_subrev_u32 v133, 2, v133
    v_cmp_lt_u32 vcc, 5, v133
    s_cbranch_vccz Lpea_14
    s_sub_u32 s46, s46, 1
    s_cmp_gt_i32 s46, 0
    s_cbranch_scc1 Lpa_13
Lpea_14:
Lac_12:
    s_waitcnt lgkmcnt(0)
    s_barrier
    s_setprio 0
    s_cmp_lg_u32 s32, 0
    s_cbranch_scc1 Lf4_15
    s_add_u32 s38, s35, 4
    s_lshl_b32 s37, s36, 7
    s_add_u32 s37, s37, 0x30000
    v_mov_b32 v2, s38
    v_mov_b32 v3, 0
    s_mov_b64 exec, 1
    buffer_store_dword v2, v3, s[28:31], s37 offen sc1
    s_mov_b64 exec, -1
Lf4_15:
    v_add_u32 v6, 0x14000, v6
    s_and_b32 s37, s32, 3
    s_mul_i32 s41, s37, 2048
    s_add_u32 s41, s41, 94208
    v_add_u32 v128, s41, v135
    s_mul_i32 s41, s37, 5120
    s_add_u32 s41, s41, 143360
    v_add_u32 v129, s41, v135
    ds_read_b128 v[136:139], v6 offset:0
    ds_read_b128 v[140:143], v6 offset:1024
    ds_read_b128 v[144:147], v6 offset:2048
    s_waitcnt lgkmcnt(2)
    v_mfma_f32_32x32x16_bf16 v[96:111], v[136:139], v[16:19], 0
    s_add_u32 s39, s64, 0x0
    s_lshl_b32 s38, s32, 12
    s_add_u32 m0, s38, 20480
    s_nop 0
    buffer_load_dwordx4 v135, s[28:31], s39 offen offset:0 sc1 lds
    ds_read_b128 v[136:139], v6 offset:3072
    s_waitcnt lgkmcnt(2)
    v_mfma_f32_32x32x16_bf16 v[96:111], v[140:143], v[20:23], v[96:111]
    buffer_load_dwordx4 v135, s[28:31], s39 offen offset:1024 sc1 lds
    ds_read_b128 v[140:143], v6 offset:4096
    s_waitcnt lgkmcnt(2)
    v_mfma_f32_32x32x16_bf16 v[96:111], v[144:147], v[24:27], v[96:111]
    buffer_load_dwordx4 v135, s[28:31], s39 offen offset:2048 sc1 lds
    ds_read_b128 v[16:19], v128 offset:0
    ds_read_b128 v[144:147], v6 offset:5120
    s_waitcnt lgkmcnt(3)
    v_mfma_f32_32x32x16_bf16 v[96:111], v[136:139], v[28:31], v[96:111]
    buffer_load_dwordx4 v135, s[28:31], s39 offen offset:3072 sc1 lds
    ds_read_b128 v[20:23], v128 offset:1024
    ds_read_b128 v[136:139], v6 offset:6144
    s_waitcnt lgkmcnt(4)
    v_mfma_f32_32x32x16_bf16 v[96:111], v[140:143], v[32:35], v[96:111]
    s_add_u32 s39, s64, 0x1b000
    s_lshl_b32 s38, s32, 12
    s_add_u32 m0, s38, 36864
    s_nop 0
    buffer_load_dwordx4 v135, s[28:31], s39 offen offset:0 sc1 lds
    ds_read_b128 v[24:27], v129 offset:0
    s_add_u32 s41, s63, 98304
    buffer_load_dwordx4 v[168:171], v135, s[28:31], s41 offen sc1
    ds_read_b128 v[140:143], v6 offset:7168
    s_waitcnt lgkmcnt(4)
    v_mfma_f32_32x32x16_bf16 v[96:111], v[144:147], v[36:39], v[96:111]
    buffer_load_dwordx4 v135, s[28:31], s39 offen offset:1024 sc1 lds
    ds_read_b128 v[28:31], v129 offset:1024
    ds_read_b128 v[144:147], v6 offset:8192
    s_waitcnt lgkmcnt(4)
    v_mfma_f32_32x32x16_bf16 v[96:111], v[136:139], v[40:43], v[96:111]
    buffer_load_dwordx4 v135, s[28:31], s39 offen offset:2048 sc1 lds
    ds_read_b128 v[32:35], v129 offset:2048
    ds_read_b128 v[136:139], v6 offset:9216
    s_waitcnt lgkmcnt(4)
    v_mfma_f32_32x32x16_bf16 v[96:111], v[140:143], v[44:47], v[96:111]
    buffer_load_dwordx4 v135, s[28:31], s39 offen offset:3072 sc1 lds
    ds_read_b128 v[36:39], v129 offset:3072
    ds_read_b128 v[140:143], v6 offset:10240
    s_waitcnt lgkmcnt(4)
    v_mfma_f32_32x32x16_bf16 v[96:111], v[144:147], v[48:51], v[96:111]
    ds_read_b128 v[40:43], v129 offset:4096
    ds_read_b128 v[144:147], v6 offset:11264
    s_waitcnt lgkmcnt(4)
    v_mfma_f32_32x32x16_bf16 v[96:111], v[136:139], v[52:55], v[96:111]
    s_add_u32 s41, s61, 0x8400
    buffer_load_dwordx4 v[44:47], v135, s[28:31], s41 offen sc1
    ds_read_b128 v[136:139], v6 offset:12288
    s_waitcnt lgkmcnt(3)
    v_mfma_f32_32x32x16_bf16 v[96:111], v[140:143], v[56:59], v[96:111]
    s_add_u32 s41, s61, 0x15c00
    buffer_load_dwordx4 v[48:51], v135, s[28:31], s41 offen sc1
    ds_read_b128 v[140:143], v6 offset:13312
    s_waitcnt lgkmcnt(2)
    v_mfma_f32_32x32x16_bf16 v[96:111], v[144:147], v[60:63], v[96:111]
    s_add_u32 s41, s61, 0x23400
    buffer_load_dwordx4 v[52:55], v135, s[28:31], s41 offen sc1
    ds_read_b128 v[144:147], v6 offset:14336
    s_waitcnt lgkmcnt(2)
    v_mfma_f32_32x32x16_bf16 v[96:111], v[136:139], v[64:67], v[96:111]
    s_add_u32 s41, s61, 0xa000
    buffer_load_dwordx4 v[56:59], v135, s[28:31], s41 offen sc1
    ds_read_b128 v[136:139], v6 offset:15360
    s_waitcnt lgkmcnt(2)
    v_mfma_f32_32x32x16_bf16 v[96:111], v[140:143], v[68:71], v[96:111]
    s_add_u32 s41, s61, 0x17800
    buffer_load_dwordx4 v[60:63], v135, s[28:31], s41 offen sc1
    ds_read_b128 v[140:143], v6 offset:16384
    s_waitcnt lgkmcnt(2)
    v_mfma_f32_32x32x16_bf16 v[96:111], v[144:147], v[72:75], v[96:111]
    s_add_u32 s41, s61, 0x25000
    buffer_load_dwordx4 v[64:67], v135, s[28:31], s41 offen sc1
    ds_read_b128 v[144:147], v6 offset:17408
    s_waitcnt lgkmcnt(2)
    v_mfma_f32_32x32x16_bf16 v[96:111], v[136:139], v[76:79], v[96:111]
    s_add_u32 s41, s61, 0xa400
    buffer_load_dwordx4 v[68:71], v135, s[28:31], s41 offen sc1
    ds_read_b128 v[136:139], v6 offset:18432
    s_waitcnt lgkmcnt(2)
    v_mfma_f32_32x32x16_bf16 v[96:111], v[140:143], v[80:83], v[96:111]
    s_add_u32 s41, s61, 0x17c00
    buffer_load_dwordx4 v[72:75], v135, s[28:31], s41 offen sc1
    ds_read_b128 v[140:143], v6 offset:19456
    s_waitcnt lgkmcnt(2)
    v_mfma_f32_32x32x16_bf16 v[96:111], v[144:147], v[84:87], v[96:111]
    s_add_u32 s41, s61, 0x25400
    buffer_load_dwordx4 v[76:79], v135, s[28:31], s41 offen sc1
    s_waitcnt lgkmcnt(1)
    v_mfma_f32_32x32x16_bf16 v[96:111], v[136:139], v[88:91], v[96:111]
    s_add_u32 s41, s61, 0xc000
    buffer_load_dwordx4 v[80:83], v135, s[28:31], s41 offen sc1
    s_waitcnt lgkmcnt(0)
    v_mfma_f32_32x32x16_bf16 v[96:111], v[140:143], v[92:95], v[96:111]
    s_add_u32 s41, s61, 0x19800
    buffer_load_dwordx4 v[84:87], v135, s[28:31], s41 offen sc1
    s_waitcnt vmcnt(14)
    s_waitcnt lgkmcnt(0)
    s_barrier
    s_setprio 0
    s_cmp_lg_u32 s32, 0
    s_cbranch_scc1 Lf4_16
    s_add_u32 s38, s35, 5
    s_lshl_b32 s37, s36, 7
    s_add_u32 s37, s37, 0x30000
    v_mov_b32 v2, s38
    v_mov_b32 v3, 0
    s_mov_b64 exec, 1
    buffer_store_dword v2, v3, s[28:31], s37 offen sc1
    s_mov_b64 exec, -1
Lf4_16:
    s_waitcnt vmcnt(11)
    v_mfma_f32_32x32x16_bf16 v[96:111], v[168:171], v[164:167], v[96:111]
    ds_read_b128 v[148:151], v7 offset:0
    ds_read_b128 v[152:155], v7 offset:1024
    ds_read_b128 v[156:159], v7 offset:2048
    ds_read_b128 v[160:163], v7 offset:3072
    s_nop 7
    s_waitcnt lgkmcnt(3)
    v_add_f32 v96, v96, v148
    v_add_f32 v97, v97, v149
    v_add_f32 v98, v98, v150
    v_add_f32 v99, v99, v151
    s_waitcnt lgkmcnt(1)
    v_add_f32 v104, v104, v156
    v_add_f32 v105, v105, v157
    v_add_f32 v106, v106, v158
    v_add_f32 v107, v107, v159
    v_add_f32 v100, v100, v152
    v_add_f32 v101, v101, v153
    v_add_f32 v102, v102, v154
    v_add_f32 v103, v103, v155
    s_waitcnt lgkmcnt(0)
    v_add_f32 v108, v108, v160
    v_add_f32 v109, v109, v161
    v_add_f32 v110, v110, v162
    v_add_f32 v111, v111, v163
    v_mul_f32 v128, v96, v96
    v_mul_f32 v130, v97, v97
    v_fma_f32 v128, v128, v4, v8
    v_fma_f32 v130, v130, v4, v8
    v_mul_f32 v128, v128, v96
    v_mul_f32 v130, v130, v97
    v_exp_f32 v128, v128
    v_exp_f32 v130, v130
    v_mul_f32 v96, v96, v104
    v_mul_f32 v97, v97, v105
    v_fma_f32 v128, v128, v5, v5
    v_fma_f32 v130, v130, v5, v5
    v_rcp_f32 v128, v128
    v_rcp_f32 v130, v130
    s_nop 0
    v_mul_f32 v96, v96, v128
    v_mul_f32 v97, v97, v130
    v_cvt_pk_bf16_f32 v172, v96, v97
    v_mul_f32 v128, v98, v98
    v_mul_f32 v130, v99, v99
    v_fma_f32 v128, v128, v4, v8
    v_fma_f32 v130, v130, v4, v8
    v_mul_f32 v128, v128, v98
    v_mul_f32 v130, v130, v99
    v_exp_f32 v128, v128
    v_exp_f32 v130, v130
    v_mul_f32 v98, v98, v106
    v_mul_f32 v99, v99, v107
    v_fma_f32 v128, v128, v5, v5
    v_fma_f32 v130, v130, v5, v5
    v_rcp_f32 v128, v128
    v_rcp_f32 v130, v130
    s_nop 0
    v_mul_f32 v98, v98, v128
    v_mul_f32 v99, v99, v130
    v_cvt_pk_bf16_f32 v173, v98, v99
    v_mul_f32 v128, v100, v100
    v_mul_f32 v130, v101, v101
    v_fma_f32 v128, v128, v4, v8
    v_fma_f32 v130, v130, v4, v8
    v_mul_f32 v128, v128, v100
    v_mul_f32 v130, v130, v101
    v_exp_f32 v128, v128
    v_exp_f32 v130, v130
    v_mul_f32 v100, v100, v108
    v_mul_f32 v101, v101, v109
    v_fma_f32 v128, v128, v5, v5
    v_fma_f32 v130, v130, v5, v5
    v_rcp_f32 v128, v128
    v_rcp_f32 v130, v130
    s_nop 0
    v_mul_f32 v100, v100, v128
    v_mul_f32 v101, v101, v130
    v_cvt_pk_bf16_f32 v174, v100, v101
    v_mul_f32 v128, v102, v102
    v_mul_f32 v130, v103, v103
    v_fma_f32 v128, v128, v4, v8
    v_fma_f32 v130, v130, v4, v8
    v_mul_f32 v128, v128, v102
    v_mul_f32 v130, v130, v103
    v_exp_f32 v128, v128
    v_exp_f32 v130, v130
    v_mul_f32 v102, v102, v110
    v_mul_f32 v103, v103, v111
    v_fma_f32 v128, v128, v5, v5
    v_fma_f32 v130, v130, v5, v5
    v_rcp_f32 v128, v128
    v_rcp_f32 v130, v130
    s_nop 0
    v_mul_f32 v102, v102, v128
    v_mul_f32 v103, v103, v130
    v_cvt_pk_bf16_f32 v175, v102, v103
    s_add_u32 s41, s60, 98304
    buffer_store_dwordx4 v[172:175], v135, s[28:31], s41 offen sc1
    s_branch Lp4e
Lp4x0:
    s_waitcnt vmcnt(0) lgkmcnt(0)
    s_barrier
    s_setprio 0
    s_cmp_lg_u32 s32, 0
    s_cbranch_scc1 Lf4_17
    s_add_u32 s38, s35, 5
    s_lshl_b32 s37, s36, 7
    s_add_u32 s37, s37, 0x30000
    v_mov_b32 v2, s38
    v_mov_b32 v3, 0
    s_mov_b64 exec, 1
    buffer_store_dword v2, v3, s[28:31], s37 offen sc1
    s_mov_b64 exec, -1
Lf4_17:
    s_and_b32 s37, s32, 3
    s_mul_i32 s41, s37, 2048
    s_add_u32 s41, s41, 94208
    v_add_u32 v128, s41, v135
    s_mul_i32 s41, s37, 5120
    s_add_u32 s41, s41, 143360
    v_add_u32 v129, s41, v135
    ds_read_b128 v[16:19], v128 offset:0
    ds_read_b128 v[20:23], v128 offset:1024
    ds_read_b128 v[24:27], v129 offset:0
    ds_read_b128 v[28:31], v129 offset:1024
    ds_read_b128 v[32:35], v129 offset:2048
    ds_read_b128 v[36:39], v129 offset:3072
    ds_read_b128 v[40:43], v129 offset:4096
    s_waitcnt lgkmcnt(0)
    s_barrier
    s_add_u32 s39, s64, 0x0
    s_lshl_b32 s38, s32, 12
    s_add_u32 m0, s38, 20480
    s_nop 0
    buffer_load_dwordx4 v135, s[28:31], s39 offen offset:0 sc1 lds
    buffer_load_dwordx4 v135, s[28:31], s39 offen offset:1024 sc1 lds
    buffer_load_dwordx4 v135, s[28:31], s39 offen offset:2048 sc1 lds
    buffer_load_dwordx4 v135, s[28:31], s39 offen offset:3072 sc1 lds
    s_add_u32 s39, s64, 0x4000
    s_lshl_b32 s38, s32, 12
    s_add_u32 m0, s38, 61440
    s_nop 0
    buffer_load_dwordx4 v135, s[28:31], s39 offen offset:0 sc1 lds
    buffer_load_dwordx4 v135, s[28:31], s39 offen offset:1024 sc1 lds
    buffer_load_dwordx4 v135, s[28:31], s39 offen offset:2048 sc1 lds
    buffer_load_dwordx4 v135, s[28:31], s39 offen offset:3072 sc1 lds
    s_add_u32 s41, s61, 0x8400
    buffer_load_dwordx4 v[44:47], v135, s[28:31], s41 offen sc1
    s_add_u32 s41, s61, 0x15c00
    buffer_load_dwordx4 v[48:51], v135, s[28:31], s41 offen sc1
    s_add_u32 s41, s61, 0x23400
    buffer_load_dwordx4 v[52:55], v135, s[28:31], s41 offen sc1
    s_add_u32 s41, s61, 0xa000
    buffer_load_dwordx4 v[56:59], v135, s[28:31], s41 offen sc1
    s_add_u32 s41, s61, 0x17800
    buffer_load_dwordx4 v[60:63], v135, s[28:31], s41 offen sc1
    s_add_u32 s41, s61, 0x25000
    buffer_load_dwordx4 v[64:67], v135, s[28:31], s41 offen sc1
    s_add_u32 s41, s61, 0xa400
    buffer_load_dwordx4 v[68:71], v135, s[28:31], s41 offen sc1
    s_add_u32 s41, s61, 0x17c00
    buffer_load_dwordx4 v[72:75], v135, s[28:31], s41 offen sc1
    s_add_u32 s41, s61, 0x25400
    buffer_load_dwordx4 v[76:79], v135, s[28:31], s41 offen sc1
    s_add_u32 s41, s61, 0xc000
    buffer_load_dwordx4 v[80:83], v135, s[28:31], s41 offen sc1
    s_add_u32 s41, s61, 0x19800
    buffer_load_dwordx4 v[84:87], v135, s[28:31], s41 offen sc1
    s_waitcnt vmcnt(0)
    s_branch Lp4e
Lp4b:
    ds_read_b128 v[136:139], v6 offset:0
    ds_read_b128 v[140:143], v6 offset:40960
    ds_read_b128 v[144:147], v6 offset:1024
    ds_read_b128 v[164:167], v6 offset:41984
    ds_read_b128 v[128:131], v6 offset:2048
    ds_read_b128 v[172:175], v6 offset:43008
    s_waitcnt vmcnt(7)
    s_waitcnt lgkmcnt(5)
    v_mfma_f32_32x32x16_bf16 v[96:111], v[136:139], v[16:19], 0
    s_add_u32 s65, s65, 4096
    buffer_load_dwordx4 v[48:51], v135, s[28:31], s65 offen offset:0 sc1
    s_waitcnt lgkmcnt(4)
    v_mfma_f32_32x32x16_bf16 v[112:127], v[140:143], v[16:19], 0
    buffer_load_dwordx4 v[52:55], v135, s[28:31], s65 offen offset:1024 sc1
    ds_read_b128 v[136:139], v6 offset:3072
    ds_read_b128 v[140:143], v6 offset:44032
    s_waitcnt vmcnt(8)
    s_waitcnt lgkmcnt(5)
    v_mfma_f32_32x32x16_bf16 v[96:111], v[144:147], v[20:23], v[96:111]
    buffer_load_dwordx4 v[56:59], v135, s[28:31], s65 offen offset:2048 sc1
    s_waitcnt lgkmcnt(4)
    v_mfma_f32_32x32x16_bf16 v[112:127], v[164:167], v[20:23], v[112:127]
    buffer_load_dwordx4 v[60:63], v135, s[28:31], s65 offen offset:3072 sc1
    ds_read_b128 v[144:147], v6 offset:4096
    ds_read_b128 v[164:167], v6 offset:45056
    s_waitcnt vmcnt(9)
    s_waitcnt lgkmcnt(5)
    v_mfma_f32_32x32x16_bf16 v[96:111], v[128:131], v[24:27], v[96:111]
    s_add_u32 s65, s65, 4096
    buffer_load_dwordx4 v[64:67], v135, s[28:31], s65 offen offset:0 sc1
    s_waitcnt lgkmcnt(4)
    v_mfma_f32_32x32x16_bf16 v[112:127], v[172:175], v[24:27], v[112:127]
    buffer_load_dwordx4 v[68:71], v135, s[28:31], s65 offen offset:1024 sc1
    ds_read_b128 v[128:131], v6 offset:5120
    ds_read_b128 v[172:175], v6 offset:46080
    s_waitcnt vmcnt(10)
    s_waitcnt lgkmcnt(5)
    v_mfma_f32_32x32x16_bf16 v[96:111], v[136:139], v[28:31], v[96:111]
    buffer_load_dwordx4 v[72:75], v135, s[28:31], s65 offen offset:2048 sc1
    s_waitcnt lgkmcnt(4)
    v_mfma_f32_32x32x16_bf16 v[112:127], v[140:143], v[28:31], v[112:127]
    buffer_load_dwordx4 v[76:79], v135, s[28:31], s65 offen offset:3072 sc1
    ds_read_b128 v[136:139], v6 offset:6144
    ds_read_b128 v[140:143], v6 offset:47104
    s_waitcnt vmcnt(11)
    s_waitcnt lgkmcnt(5)
    v_mfma_f32_32x32x16_bf16 v[96:111], v[144:147], v[32:35], v[96:111]
    s_add_u32 s65, s65, 4096
    buffer_load_dwordx4 v[80:83], v135, s[28:31], s65 offen offset:0 sc1
    s_waitcnt lgkmcnt(4)
    v_mfma_f32_32x32x16_bf16 v[112:127], v[164:167], v[32:35], v[112:127]
    buffer_load_dwordx4 v[84:87], v135, s[28:31], s65 offen offset:1024 sc1
    ds_read_b128 v[144:147], v6 offset:7168
    ds_read_b128 v[164:167], v6 offset:48128
    s_waitcnt vmcnt(12)
    s_waitcnt lgkmcnt(5)
    v_mfma_f32_32x32x16_bf16 v[96:111], v[128:131], v[36:39], v[96:111]
    buffer_load_dwordx4 v[88:91], v135, s[28:31], s65 offen offset:2048 sc1
    s_waitcnt lgkmcnt(4)
    v_mfma_f32_32x32x16_bf16 v[112:127], v[172:175], v[36:39], v[112:127]
    buffer_load_dwordx4 v[92:95], v135, s[28:31], s65 offen offset:3072 sc1
    ds_read_b128 v[128:131], v6 offset:8192
    ds_read_b128 v[172:175], v6 offset:49152
    s_waitcnt vmcnt(13)
    s_waitcnt lgkmcnt(5)
    v_mfma_f32_32x32x16_bf16 v[96:111], v[136:139], v[40:43], v[96:111]
    s_waitcnt lgkmcnt(4)
    v_mfma_f32_32x32x16_bf16 v[112:127], v[140:143], v[40:43], v[112:127]
    ds_read_b128 v[136:139], v6 offset:9216
    ds_read_b128 v[140:143], v6 offset:50176
    s_waitcnt vmcnt(12)
    s_waitcnt lgkmcnt(5)
    v_mfma_f32_32x32x16_bf16 v[96:111], v[144:147], v[44:47], v[96:111]
    s_waitcnt lgkmcnt(4)
    v_mfma_f32_32x32x16_bf16 v[112:127], v[164:167], v[44:47], v[112:127]
    ds_read_b128 v[144:147], v6 offset:10240
    ds_read_b128 v[164:167], v6 offset:51200
    s_waitcnt vmcnt(11)
    s_waitcnt lgkmcnt(5)
    v_mfma_f32_32x32x16_bf16 v[96:111], v[128:131], v[48:51], v[96:111]
    s_waitcnt lgkmcnt(4)
    v_mfma_f32_32x32x16_bf16 v[112:127], v[172:175], v[48:51], v[112:127]
    ds_read_b128 v[128:131], v6 offset:11264
    ds_read_b128 v[172:175], v6 offset:52224
    s_waitcnt vmcnt(10)
    s_waitcnt lgkmcnt(5)
    v_mfma_f32_32x32x16_bf16 v[96:111], v[136:139], v[52:55], v[96:111]
    s_waitcnt lgkmcnt(4)
    v_mfma_f32_32x32x16_bf16 v[112:127], v[140:143], v[52:55], v[112:127]
    ds_read_b128 v[136:139], v6 offset:12288
    ds_read_b128 v[140:143], v6 offset:53248
    s_waitcnt vmcnt(9)
    s_waitcnt lgkmcnt(5)
    v_mfma_f32_32x32x16_bf16 v[96:111], v[144:147], v[56:59], v[96:111]
    s_waitcnt lgkmcnt(4)
    v_mfma_f32_32x32x16_bf16 v[112:127], v[164:167], v[56:59], v[112:127]
    ds_read_b128 v[144:147], v6 offset:13312
    ds_read_b128 v[164:167], v6 offset:54272
    s_waitcnt vmcnt(8)
    s_waitcnt lgkmcnt(5)
    v_mfma_f32_32x32x16_bf16 v[96:111], v[128:131], v[60:63], v[96:111]
    s_waitcnt lgkmcnt(4)
    v_mfma_f32_32x32x16_bf16 v[112:127], v[172:175], v[60:63], v[112:127]
    ds_read_b128 v[128:131], v6 offset:14336
    ds_read_b128 v[172:175], v6 offset:55296
    s_waitcnt vmcnt(7)
    s_waitcnt lgkmcnt(5)
    v_mfma_f32_32x32x16_bf16 v[96:111], v[136:139], v[64:67], v[96:111]
    s_waitcnt lgkmcnt(4)
    v_mfma_f32_32x32x16_bf16 v[112:127], v[140:143], v[64:67], v[112:127]
    s_add_u32 s41, s63, 16384
    buffer_load_dwordx4 v[168:171], v135, s[28:31], s41 offen sc1
    ds_read_b128 v[136:139], v6 offset:15360
    ds_read_b128 v[140:143], v6 offset:56320
    s_waitcnt vmcnt(7)
    s_waitcnt lgkmcnt(5)
    v_mfma_f32_32x32x16_bf16 v[96:111], v[144:147], v[68:71], v[96:111]
    s_waitcnt lgkmcnt(4)
    v_mfma_f32_32x32x16_bf16 v[112:127], v[164:167], v[68:71], v[112:127]
    ds_read_b128 v[144:147], v6 offset:16384
    ds_read_b128 v[164:167], v6 offset:57344
    s_waitcnt vmcnt(6)
    s_waitcnt lgkmcnt(5)
    v_mfma_f32_32x32x16_bf16 v[96:111], v[128:131], v[72:75], v[96:111]
    s_waitcnt lgkmcnt(4)
    v_mfma_f32_32x32x16_bf16 v[112:127], v[172:175], v[72:75], v[112:127]
    ds_read_b128 v[128:131], v6 offset:17408
    ds_read_b128 v[172:175], v6 offset:58368
    s_waitcnt vmcnt(5)
    s_waitcnt lgkmcnt(5)
    v_mfma_f32_32x32x16_bf16 v[96:111], v[136:139], v[76:79], v[96:111]
    s_waitcnt lgkmcnt(4)
    v_mfma_f32_32x32x16_bf16 v[112:127], v[140:143], v[76:79], v[112:127]
    ds_read_b128 v[136:139], v6 offset:18432
    ds_read_b128 v[140:143], v6 offset:59392
    s_waitcnt vmcnt(4)
    s_waitcnt lgkmcnt(5)
    v_mfma_f32_32x32x16_bf16 v[96:111], v[144:147], v[80:83], v[96:111]
    s_waitcnt lgkmcnt(4)
    v_mfma_f32_32x32x16_bf16 v[112:127], v[164:167], v[80:83], v[112:127]
    ds_read_b128 v[144:147], v6 offset:19456
    ds_read_b128 v[164:167], v6 offset:60416
    s_waitcnt vmcnt(3)
    s_waitcnt lgkmcnt(5)
    v_mfma_f32_32x32x16_bf16 v[96:111], v[128:131], v[84:87], v[96:111]
    s_waitcnt lgkmcnt(4)
    v_mfma_f32_32x32x16_bf16 v[112:127], v[172:175], v[84:87], v[112:127]
    s_waitcnt vmcnt(2)
    s_waitcnt lgkmcnt(3)
    v_mfma_f32_32x32x16_bf16 v[96:111], v[136:139], v[88:91], v[96:111]
    s_waitcnt lgkmcnt(2)
    v_mfma_f32_32x32x16_bf16 v[112:127], v[140:143], v[88:91], v[112:127]
    s_waitcnt vmcnt(1)
    s_waitcnt lgkmcnt(1)
    v_mfma_f32_32x32x16_bf16 v[96:111], v[144:147], v[92:95], v[96:111]
    s_waitcnt lgkmcnt(0)
    v_mfma_f32_32x32x16_bf16 v[112:127], v[164:167], v[92:95], v[112:127]
    s_lshl_b32 s37, s62, 12
    s_add_u32 s37, s37, 0x80000
    buffer_load_dwordx2 v[148:149], v9, s[28:31], s37 offen offset:0 sc1
    buffer_load_dwordx2 v[150:151], v9, s[28:31], s37 offen offset:256 sc1
    buffer_load_dwordx2 v[152:153], v9, s[28:31], s37 offen offset:512 sc1
    buffer_load_dwordx2 v[154:155], v9, s[28:31], s37 offen offset:768 sc1
    buffer_load_dwordx2 v[156:157], v9, s[28:31], s37 offen offset:1024 sc1
    buffer_load_dwordx2 v[158:159], v9, s[28:31], s37 offen offset:1280 sc1
    buffer_load_dwordx2 v[160:161], v9, s[28:31], s37 offen offset:1536 sc1
    buffer_load_dwordx2 v[162:163], v9, s[28:31], s37 offen offset:1792 sc1
    v_add_u32 v9, 139264, v7
    s_nop 0
    ds_write_b128 v9, v[96:99] offset:0
    ds_write_b128 v9, v[100:103] offset:1024
    ds_write_b128 v9, v[104:107] offset:2048
    ds_write_b128 v9, v[108:111] offset:3072
    v_add_u32 v6, 40960, v6
    s_waitcnt lgkmcnt(0)
    s_barrier
    s_setprio 1
    v_add_u32 v6, 0xa000, v6
    ds_read_b128 v[136:139], v6 offset:0
    ds_read_b128 v[140:143], v6 offset:1024
    ds_read_b128 v[144:147], v6 offset:2048
    s_waitcnt lgkmcnt(2)
    v_mfma_f32_32x32x16_bf16 v[96:111], v[136:139], v[16:19], 0
    s_mul_i32 s37, s34, 40
    s_mul_i32 s38, s32, 5
    s_add_u32 s37, s37, s38
    s_lshl_b32 s37, s37, 10
    s_add_u32 s37, s37, 0x1ce0000
    s_lshl_b32 s38, s38, 10
    s_add_u32 m0, s38, 20480
    s_nop 0
    buffer_load_dwordx4 v135, s[28:31], s37 offen offset:0 sc1 lds
    buffer_load_dwordx4 v135, s[28:31], s37 offen offset:1024 sc1 lds
    buffer_load_dwordx4 v135, s[28:31], s37 offen offset:2048 sc1 lds
    buffer_load_dwordx4 v135, s[28:31], s37 offen offset:3072 sc1 lds
    s_add_u32 s37, s37, 4096
    s_add_u32 m0, m0, 4096
    s_nop 0
    buffer_load_dwordx4 v135, s[28:31], s37 offen sc1 lds
    ds_read_b128 v[136:139], v6 offset:3072
    s_waitcnt lgkmcnt(2)
    v_mfma_f32_32x32x16_bf16 v[96:111], v[140:143], v[20:23], v[96:111]
    ds_read_b128 v[140:143], v6 offset:4096
    s_waitcnt lgkmcnt(2)
    v_mfma_f32_32x32x16_bf16 v[96:111], v[144:147], v[24:27], v[96:111]
    ds_read_b128 v[144:147], v6 offset:5120
    s_waitcnt lgkmcnt(2)
    v_mfma_f32_32x32x16_bf16 v[96:111], v[136:139], v[28:31], v[96:111]
    s_waitcnt vmcnt(5)
    v_add_f32 v148, v148, v156
    v_add_f32 v149, v149, v157
    v_add_f32 v150, v150, v158
    v_add_f32 v151, v151, v159
    v_add_f32 v152, v152, v160
    v_add_f32 v153, v153, v161
    v_add_f32 v154, v154, v162
    v_add_f32 v155, v155, v163
    v_add_f32 v148, v148, v152
    v_add_f32 v149, v149, v153
    v_add_f32 v150, v150, v154
    v_add_f32 v151, v151, v155
    v_add_f32 v148, v148, v150
    v_add_f32 v149, v149, v151
    v_mov_b32 v150, v148
    v_mov_b32 v151, v149
    s_nop 1
    v_permlane32_swap_b32 v148, v150
    v_permlane32_swap_b32 v149, v151
    v_add_f32 v148, v148, v150
    v_add_f32 v149, v149, v151
    v_mul_f32 v148, 0xbacccccd, v148
    v_mul_f32 v149, 0x3acccccd, v149
    v_fma_f32 v149, -v148, v148, v149
    v_max_f32 v149, 0, v149
    v_add_f32 v149, 0x3727c5ac, v149
    v_rsq_f32 v8, v149
    v_mov_b32 v5, v149
    v_mul_f32 v149, v149, v8
    v_mul_f32 v4, v8, v8
    v_mul_f32 v4, v4, v8
    v_mul_f32 v4, 0xbdd2d3e8, v4
    v_mul_f32 v8, 0xc0135761, v8
    v_cvt_pk_bf16_f32 v150, v148, v148
    v_and_b32 v150, 0xffff0000, v150
    v_sub_f32 v152, v148, v150
    v_cvt_pk_bf16_f32 v151, v149, v149
    v_and_b32 v151, 0xffff0000, v151
    v_sub_f32 v153, v149, v151
    v_cvt_pk_bf16_f32 v164, v150, v150
    v_cvt_pk_bf16_f32 v165, v152, v151
    v_cvt_pk_bf16_f32 v166, v151, v153
    v_mov_b32 v167, 0
    ds_read_b128 v[136:139], v6 offset:6144
    s_waitcnt lgkmcnt(2)
    v_mfma_f32_32x32x16_bf16 v[96:111], v[140:143], v[32:35], v[96:111]
    v_mfma_f32_32x32x16_bf16 v[112:127], v[168:171], v[164:167], v[112:127]
    ds_read_b128 v[140:143], v6 offset:7168
    s_waitcnt lgkmcnt(2)
    v_mfma_f32_32x32x16_bf16 v[96:111], v[144:147], v[36:39], v[96:111]
    ds_read_b128 v[148:151], v7 offset:0
    ds_read_b128 v[152:155], v7 offset:1024
    ds_read_b128 v[156:159], v7 offset:2048
    ds_read_b128 v[160:163], v7 offset:3072
    s_nop 2
    ds_read_b128 v[144:147], v6 offset:8192
    s_waitcnt lgkmcnt(6)
    v_mfma_f32_32x32x16_bf16 v[96:111], v[136:139], v[40:43], v[96:111]
    s_waitcnt lgkmcnt(4)
    v_add_f32 v112, v112, v148
    v_add_f32 v113, v113, v149
    v_add_f32 v114, v114, v150
    v_add_f32 v115, v115, v151
    s_waitcnt lgkmcnt(2)
    v_add_f32 v120, v120, v156
    v_add_f32 v121, v121, v157
    v_add_f32 v122, v122, v158
    ds_read_b128 v[136:139], v6 offset:9216
    v_mfma_f32_32x32x16_bf16 v[96:111], v[140:143], v[44:47], v[96:111]
    v_add_f32 v123, v123, v159
    v_add_f32 v116, v116, v152
    v_add_f32 v117, v117, v153
    v_add_f32 v118, v118, v154
    v_add_f32 v119, v119, v155
    s_waitcnt lgkmcnt(2)
    v_add_f32 v124, v124, v160
    v_add_f32 v125, v125, v161
    ds_read_b128 v[140:143], v6 offset:10240
    s_waitcnt lgkmcnt(2)
    v_mfma_f32_32x32x16_bf16 v[96:111], v[144:147], v[48:51], v[96:111]
    v_add_f32 v126, v126, v162
    v_add_f32 v127, v127, v163
    v_mul_f32 v128, v112, v112
    v_mul_f32 v130, v113, v113
    v_fma_f32 v128, v128, v4, v8
    v_fma_f32 v130, v130, v4, v8
    v_mul_f32 v128, v128, v112
    ds_read_b128 v[144:147], v6 offset:11264
    s_waitcnt lgkmcnt(2)
    v_mfma_f32_32x32x16_bf16 v[96:111], v[136:139], v[52:55], v[96:111]
    v_mul_f32 v130, v130, v113
    v_exp_f32 v128, v128
    v_exp_f32 v130, v130
    v_mul_f32 v112, v112, v120
    v_mul_f32 v113, v113, v121
    v_fma_f32 v128, v128, v5, v5
    v_fma_f32 v130, v130, v5, v5
    ds_read_b128 v[136:139], v6 offset:12288
    s_waitcnt lgkmcnt(2)
    v_mfma_f32_32x32x16_bf16 v[96:111], v[140:143], v[56:59], v[96:111]
    v_rcp_f32 v128, v128
    v_rcp_f32 v130, v130
    s_nop 0
    v_mul_f32 v112, v112, v128
    v_mul_f32 v113, v113, v130
    v_cvt_pk_bf16_f32 v172, v112, v113
    v_mul_f32 v128, v114, v114
    ds_read_b128 v[140:143], v6 offset:13312
    s_waitcnt lgkmcnt(2)
    v_mfma_f32_32x32x16_bf16 v[96:111], v[144:147], v[60:63], v[96:111]
    v_mul_f32 v130, v115, v115
    v_fma_f32 v128, v128, v4, v8
    v_fma_f32 v130, v130, v4, v8
    v_mul_f32 v128, v128, v114
    v_mul_f32 v130, v130, v115
    v_exp_f32 v128, v128
    v_exp_f32 v130, v130
    ds_read_b128 v[144:147], v6 offset:14336
    s_waitcnt lgkmcnt(2)
    v_mfma_f32_32x32x16_bf16 v[96:111], v[136:139], v[64:67], v[96:111]
    v_mul_f32 v114, v114, v122
    v_mul_f32 v115, v115, v123
    v_fma_f32 v128, v128, v5, v5
    v_fma_f32 v130, v130, v5, v5
    v_rcp_f32 v128, v128
    v_rcp_f32 v130, v130
    s_nop 0
    ds_read_b128 v[136:139], v6 offset:15360
    s_waitcnt lgkmcnt(2)
    v_mfma_f32_32x32x16_bf16 v[96:111], v[140:143], v[68:71], v[96:111]
    v_mul_f32 v114, v114, v128
    v_mul_f32 v115, v115, v130
    v_cvt_pk_bf16_f32 v173, v114, v115
    v_mul_f32 v128, v116, v116
    v_mul_f32 v130, v117, v117
    v_fma_f32 v128, v128, v4, v8
    v_fma_f32 v130, v130, v4, v8
    ds_read_b128 v[140:143], v6 offset:16384
    s_waitcnt lgkmcnt(2)
    v_mfma_f32_32x32x16_bf16 v[96:111], v[144:147], v[72:75], v[96:111]
    v_mul_f32 v128, v128, v116
    v_mul_f32 v130, v130, v117
    v_exp_f32 v128, v128
    v_exp_f32 v130, v130
    v_mul_f32 v116, v116, v124
    v_mul_f32 v117, v117, v125
    v_fma_f32 v128, v128, v5, v5
    ds_read_b128 v[144:147], v6 offset:17408
    s_waitcnt lgkmcnt(2)
    v_mfma_f32_32x32x16_bf16 v[96:111], v[136:139], v[76:79], v[96:111]
    v_fma_f32 v130, v130, v5, v5
    v_rcp_f32 v128, v128
    v_rcp_f32 v130, v130
    s_nop 0
    v_mul_f32 v116, v116, v128
    v_mul_f32 v117, v117, v130
    v_cvt_pk_bf16_f32 v174, v116, v117
    ds_read_b128 v[136:139], v6 offset:18432
    s_waitcnt lgkmcnt(2)
    v_mfma_f32_32x32x16_bf16 v[96:111], v[140:143], v[80:83], v[96:111]
    v_mul_f32 v128, v118, v118
    v_mul_f32 v130, v119, v119
    v_fma_f32 v128, v128, v4, v8
    v_fma_f32 v130, v130, v4, v8
    v_mul_f32 v128, v128, v118
    v_mul_f32 v130, v130, v119
    v_exp_f32 v128, v128
    ds_read_b128 v[140:143], v6 offset:19456
    s_waitcnt lgkmcnt(2)
    v_mfma_f32_32x32x16_bf16 v[96:111], v[144:147], v[84:87], v[96:111]
    v_exp_f32 v130, v130
    v_mul_f32 v118, v118, v126
    v_mul_f32 v119, v119, v127
    v_fma_f32 v128, v128, v5, v5
    v_fma_f32 v130, v130, v5, v5
    v_rcp_f32 v128, v128
    v_rcp_f32 v130, v130
    s_waitcnt lgkmcnt(1)
    v_mfma_f32_32x32x16_bf16 v[96:111], v[136:139], v[88:91], v[96:111]
    s_nop 0
    v_mul_f32 v118, v118, v128
    v_mul_f32 v119, v119, v130
    v_cvt_pk_bf16_f32 v175, v118, v119
    s_add_u32 s41, s60, 16384
    buffer_store_dwordx4 v[172:175], v135, s[28:31], s41 offen sc1
    s_waitcnt lgkmcnt(0)
    v_mfma_f32_32x32x16_bf16 v[96:111], v[140:143], v[92:95], v[96:111]
    s_nop 11
    ds_write_b128 v7, v[96:99] offset:0
    ds_write_b128 v7, v[100:103] offset:1024
    ds_write_b128 v7, v[104:107] offset:2048
    ds_write_b128 v7, v[108:111] offset:3072
    s_waitcnt vmcnt(1)
    s_waitcnt lgkmcnt(0)
    s_barrier
    s_setprio 0
    v_add_u32 v6, 0xfffec000, v6
    ds_read_b128 v[136:139], v6 offset:0
    ds_read_b128 v[140:143], v6 offset:1024
    ds_read_b128 v[144:147], v6 offset:2048
    s_waitcnt lgkmcnt(2)
    v_mfma_f32_32x32x16_bf16 v[96:111], v[136:139], v[16:19], 0
    s_mul_i32 s39, s34, 40
    s_and_b32 s38, s32, 3
    s_mul_i32 s38, s38, 10
    s_add_u32 s39, s39, s38
    s_lshl_b32 s39, s39, 10
    s_add_u32 s39, s39, 0x1d80000
    s_lshl_b32 s38, s38, 10
    s_add_u32 m0, s38, 102400
    s_nop 0
    buffer_load_dwordx4 v135, s[28:31], s39 offen offset:0 sc1 lds
    buffer_load_dwordx4 v135, s[28:31], s39 offen offset:1024 sc1 lds
    ds_read_b128 v[136:139], v6 offset:3072
    s_waitcnt lgkmcnt(2)
    v_mfma_f32_32x32x16_bf16 v[96:111], v[140:143], v[20:23], v[96:111]
    buffer_load_dwordx4 v135, s[28:31], s39 offen offset:2048 sc1 lds
    buffer_load_dwordx4 v135, s[28:31], s39 offen offset:3072 sc1 lds
    ds_read_b128 v[140:143], v6 offset:4096
    s_waitcnt lgkmcnt(2)
    v_mfma_f32_32x32x16_bf16 v[96:111], v[144:147], v[24:27], v[96:111]
    s_add_u32 s39, s39, 4096
    s_add_u32 m0, m0, 4096
    s_nop 0
    buffer_load_dwordx4 v135, s[28:31], s39 offen offset:0 sc1 lds
    buffer_load_dwordx4 v135, s[28:31], s39 offen offset:1024 sc1 lds
    ds_read_b128 v[144:147], v6 offset:5120
    s_waitcnt lgkmcnt(2)
    v_mfma_f32_32x32x16_bf16 v[96:111], v[136:139], v[28:31], v[96:111]
    buffer_load_dwordx4 v135, s[28:31], s39 offen offset:2048 sc1 lds
    buffer_load_dwordx4 v135, s[28:31], s39 offen offset:3072 sc1 lds
    ds_read_b128 v[136:139], v6 offset:6144
    s_waitcnt lgkmcnt(2)
    v_mfma_f32_32x32x16_bf16 v[96:111], v[140:143], v[32:35], v[96:111]
    s_add_u32 s39, s39, 4096
    s_add_u32 m0, m0, 4096
    s_nop 0
    buffer_load_dwordx4 v135, s[28:31], s39 offen offset:0 sc1 lds
    buffer_load_dwordx4 v135, s[28:31], s39 offen offset:1024 sc1 lds
    s_add_u32 s41, s63, 49152
    buffer_load_dwordx4 v[168:171], v135, s[28:31], s41 offen sc1
    ds_read_b128 v[140:143], v6 offset:7168
    s_waitcnt lgkmcnt(2)
    v_mfma_f32_32x32x16_bf16 v[96:111], v[144:147], v[36:39], v[96:111]
    ds_read_b128 v[144:147], v6 offset:8192
    s_waitcnt lgkmcnt(2)
    v_mfma_f32_32x32x16_bf16 v[96:111], v[136:139], v[40:43], v[96:111]
    s_and_b32 s37, s32, 3
    s_mul_i32 s37, s37, 2048
    s_add_u32 m0, s37, 94208
    s_add_u32 s41, s61, 0x21000
    buffer_load_dwordx4 v135, s[28:31], s41 offen sc1 lds
    ds_read_b128 v[136:139], v6 offset:9216
    s_waitcnt lgkmcnt(2)
    v_mfma_f32_32x32x16_bf16 v[96:111], v[140:143], v[44:47], v[96:111]
    ds_read_b128 v[140:143], v6 offset:10240
    s_waitcnt lgkmcnt(2)
    v_mfma_f32_32x32x16_bf16 v[96:111], v[144:147], v[48:51], v[96:111]
    s_and_b32 s37, s32, 3
    s_mul_i32 s37, s37, 2048
    s_add_u32 m0, s37, 95232
    s_add_u32 s41, s61, 0x6400
    buffer_load_dwordx4 v135, s[28:31], s41 offen sc1 lds
    ds_read_b128 v[144:147], v6 offset:11264
    s_waitcnt lgkmcnt(2)
    v_mfma_f32_32x32x16_bf16 v[96:111], v[136:139], v[52:55], v[96:111]
    ds_read_b128 v[136:139], v6 offset:12288
    s_waitcnt lgkmcnt(2)
    v_mfma_f32_32x32x16_bf16 v[96:111], v[140:143], v[56:59], v[96:111]
    s_and_b32 s37, s32, 3
    s_mul_i32 s37, s37, 5120
    s_add_u32 m0, s37, 143360
    s_add_u32 s41, s61, 0x13c00
    buffer_load_dwordx4 v135, s[28:31], s41 offen sc1 lds
    ds_read_b128 v[140:143], v6 offset:13312
    s_waitcnt lgkmcnt(2)
    v_mfma_f32_32x32x16_bf16 v[96:111], v[144:147], v[60:63], v[96:111]
    ds_read_b128 v[144:147], v6 offset:14336
    s_waitcnt lgkmcnt(2)
    v_mfma_f32_32x32x16_bf16 v[96:111], v[136:139], v[64:67], v[96:111]
    s_and_b32 s37, s32, 3
    s_mul_i32 s37, s37, 5120
    s_add_u32 m0, s37, 144384
    s_add_u32 s41, s61, 0x21400
    buffer_load_dwordx4 v135, s[28:31], s41 offen sc1 lds
    ds_read_b128 v[136:139], v6 offset:15360
    s_waitcnt lgkmcnt(2)
    v_mfma_f32_32x32x16_bf16 v[96:111], v[140:143], v[68:71], v[96:111]
    ds_read_b128 v[140:143], v6 offset:16384
    s_waitcnt lgkmcnt(2)
    v_mfma_f32_32x32x16_bf16 v[96:111], v[144:147], v[72:75], v[96:111]
    s_and_b32 s37, s32, 3
    s_mul_i32 s37, s37, 5120
    s_add_u32 m0, s37, 145408
    s_add_u32 s41, s61, 0x8000
    buffer_load_dwordx4 v135, s[28:31], s41 offen sc1 lds
    ds_read_b128 v[144:147], v6 offset:17408
    s_waitcnt lgkmcnt(2)
    v_mfma_f32_32x32x16_bf16 v[96:111], v[136:139], v[76:79], v[96:111]
    ds_read_b128 v[136:139], v6 offset:18432
    s_waitcnt lgkmcnt(2)
    v_mfma_f32_32x32x16_bf16 v[96:111], v[140:143], v[80:83], v[96:111]
    s_and_b32 s37, s32, 3
    s_mul_i32 s37, s37, 5120
    s_add_u32 m0, s37, 146432
    s_add_u32 s41, s61, 0x15800
    buffer_load_dwordx4 v135, s[28:31], s41 offen sc1 lds
    ds_read_b128 v[140:143], v6 offset:19456
    s_waitcnt lgkmcnt(2)
    v_mfma_f32_32x32x16_bf16 v[96:111], v[144:147], v[84:87], v[96:111]
    s_waitcnt lgkmcnt(1)
    v_mfma_f32_32x32x16_bf16 v[96:111], v[136:139], v[88:91], v[96:111]
    s_and_b32 s37, s32, 3
    s_mul_i32 s37, s37, 5120
    s_add_u32 m0, s37, 147456
    s_add_u32 s41, s61, 0x23000
    buffer_load_dwordx4 v135, s[28:31], s41 offen sc1 lds
    s_waitcnt lgkmcnt(0)
    v_mfma_f32_32x32x16_bf16 v[96:111], v[140:143], v[92:95], v[96:111]
    s_waitcnt vmcnt(8)
    s_waitcnt lgkmcnt(0)
    s_barrier
    s_setprio 1
    s_cmp_lg_u32 s32, 0
    s_cbranch_scc1 Lf4_18
    s_add_u32 s38, s35, 2
    s_lshl_b32 s37, s36, 7
    s_add_u32 s37, s37, 0x30000
    v_mov_b32 v2, s38
    v_mov_b32 v3, 0
    s_mov_b64 exec, 1
    buffer_store_dword v2, v3, s[28:31], s37 offen sc1
    s_mov_b64 exec, -1
Lf4_18:
    v_add_u32 v6, 0x14000, v6
    ds_read_b128 v[136:139], v6 offset:0
    ds_read_b128 v[140:143], v6 offset:1024
    ds_read_b128 v[144:147], v6 offset:2048
    s_waitcnt lgkmcnt(2)
    v_mfma_f32_32x32x16_bf16 v[112:127], v[136:139], v[16:19], 0
    s_waitcnt vmcnt(7)
    v_mfma_f32_32x32x16_bf16 v[96:111], v[168:171], v[164:167], v[96:111]
    ds_read_b128 v[136:139], v6 offset:3072
    s_waitcnt lgkmcnt(2)
    v_mfma_f32_32x32x16_bf16 v[112:127], v[140:143], v[20:23], v[112:127]
    ds_read_b128 v[148:151], v7 offset:0
    ds_read_b128 v[152:155], v7 offset:1024
    ds_read_b128 v[156:159], v7 offset:2048
    ds_read_b128 v[160:163], v7 offset:3072
    s_nop 2
    ds_read_b128 v[140:143], v6 offset:4096
    s_waitcnt lgkmcnt(6)
    v_mfma_f32_32x32x16_bf16 v[112:127], v[144:147], v[24:27], v[112:127]
    s_waitcnt lgkmcnt(4)
    v_add_f32 v96, v96, v148
    v_add_f32 v97, v97, v149
    v_add_f32 v98, v98, v150
    v_add_f32 v99, v99, v151
    s_waitcnt lgkmcnt(2)
    v_add_f32 v104, v104, v156
    v_add_f32 v105, v105, v157
    ds_read_b128 v[144:147], v6 offset:5120
    v_mfma_f32_32x32x16_bf16 v[112:127], v[136:139], v[28:31], v[112:127]
    v_add_f32 v106, v106, v158
    v_add_f32 v107, v107, v159
    v_add_f32 v100, v100, v152
    v_add_f32 v101, v101, v153
    v_add_f32 v102, v102, v154
    v_add_f32 v103, v103, v155
    ds_read_b128 v[136:139], v6 offset:6144
    s_waitcnt lgkmcnt(2)
    v_mfma_f32_32x32x16_bf16 v[112:127], v[140:143], v[32:35], v[112:127]
    v_add_f32 v108, v108, v160
    v_add_f32 v109, v109, v161
    v_add_f32 v110, v110, v162
    v_add_f32 v111, v111, v163
    v_mul_f32 v128, v96, v96
    v_mul_f32 v130, v97, v97
    ds_read_b128 v[140:143], v6 offset:7168
    s_waitcnt lgkmcnt(2)
    v_mfma_f32_32x32x16_bf16 v[112:127], v[144:147], v[36:39], v[112:127]
    v_fma_f32 v128, v128, v4, v8
    v_fma_f32 v130, v130, v4, v8
    v_mul_f32 v128, v128, v96
    v_mul_f32 v130, v130, v97
    v_exp_f32 v128, v128
    v_exp_f32 v130, v130
    ds_read_b128 v[144:147], v6 offset:8192
    s_waitcnt lgkmcnt(2)
    v_mfma_f32_32x32x16_bf16 v[112:127], v[136:139], v[40:43], v[112:127]
    v_mul_f32 v96, v96, v104
    v_mul_f32 v97, v97, v105
    v_fma_f32 v128, v128, v5, v5
    v_fma_f32 v130, v130, v5, v5
    v_rcp_f32 v128, v128
    v_rcp_f32 v130, v130
    ds_read_b128 v[136:139], v6 offset:9216
    s_waitcnt lgkmcnt(2)
    v_mfma_f32_32x32x16_bf16 v[112:127], v[140:143], v[44:47], v[112:127]
    s_nop 0
    v_mul_f32 v96, v96, v128
    v_mul_f32 v97, v97, v130
    v_cvt_pk_bf16_f32 v172, v96, v97
    v_mul_f32 v128, v98, v98
    v_mul_f32 v130, v99, v99
    ds_read_b128 v[140:143], v6 offset:10240
    s_waitcnt lgkmcnt(2)
    v_mfma_f32_32x32x16_bf16 v[112:127], v[144:147], v[48:51], v[112:127]
    v_fma_f32 v128, v128, v4, v8
    v_fma_f32 v130, v130, v4, v8
    v_mul_f32 v128, v128, v98
    v_mul_f32 v130, v130, v99
    v_exp_f32 v128, v128
    v_exp_f32 v130, v130
    ds_read_b128 v[144:147], v6 offset:11264
    s_waitcnt lgkmcnt(2)
    v_mfma_f32_32x32x16_bf16 v[112:127], v[136:139], v[52:55], v[112:127]
    v_mul_f32 v98, v98, v106
    v_mul_f32 v99, v99, v107
    v_fma_f32 v128, v128, v5, v5
    v_fma_f32 v130, v130, v5, v5
    v_rcp_f32 v128, v128
    v_rcp_f32 v130, v130
    ds_read_b128 v[136:139], v6 offset:12288
    s_waitcnt lgkmcnt(2)
    v_mfma_f32_32x32x16_bf16 v[112:127], v[140:143], v[56:59], v[112:127]
    s_nop 0
    v_mul_f32 v98, v98, v128
    v_mul_f32 v99, v99, v130
    v_cvt_pk_bf16_f32 v173, v98, v99
    v_mul_f32 v128, v100, v100
    v_mul_f32 v130, v101, v101
    ds_read_b128 v[140:143], v6 offset:13312
    s_waitcnt lgkmcnt(2)
    v_mfma_f32_32x32x16_bf16 v[112:127], v[144:147], v[60:63], v[112:127]
    v_fma_f32 v128, v128, v4, v8
    v_fma_f32 v130, v130, v4, v8
    v_mul_f32 v128, v128, v100
    v_mul_f32 v130, v130, v101
    v_exp_f32 v128, v128
    v_exp_f32 v130, v130
    ds_read_b128 v[144:147], v6 offset:14336
    s_waitcnt lgkmcnt(2)
    v_mfma_f32_32x32x16_bf16 v[112:127], v[136:139], v[64:67], v[112:127]
    v_mul_f32 v100, v100, v108
    v_mul_f32 v101, v101, v109
    v_fma_f32 v128, v128, v5, v5
    v_fma_f32 v130, v130, v5, v5
    v_rcp_f32 v128, v128
    v_rcp_f32 v130, v130
    ds_read_b128 v[136:139], v6 offset:15360
    s_waitcnt lgkmcnt(2)
    v_mfma_f32_32x32x16_bf16 v[112:127], v[140:143], v[68:71], v[112:127]
    s_nop 0
    v_mul_f32 v100, v100, v128
    v_mul_f32 v101, v101, v130
    v_cvt_pk_bf16_f32 v174, v100, v101
    v_mul_f32 v128, v102, v102
    v_mul_f32 v130, v103, v103
    ds_read_b128 v[140:143], v6 offset:16384
    s_waitcnt lgkmcnt(2)
    v_mfma_f32_32x32x16_bf16 v[112:127], v[144:147], v[72:75], v[112:127]
    v_fma_f32 v128, v128, v4, v8
    v_fma_f32 v130, v130, v4, v8
    v_mul_f32 v128, v128, v102
    v_mul_f32 v130, v130, v103
    v_exp_f32 v128, v128
    v_exp_f32 v130, v130
    ds_read_b128 v[144:147], v6 offset:17408
    s_waitcnt lgkmcnt(2)
    v_mfma_f32_32x32x16_bf16 v[112:127], v[136:139], v[76:79], v[112:127]
    v_mul_f32 v102, v102, v110
    v_mul_f32 v103, v103, v111
    v_fma_f32 v128, v128, v5, v5
    v_fma_f32 v130, v130, v5, v5
    v_rcp_f32 v128, v128
    v_rcp_f32 v130, v130
    ds_read_b128 v[136:139], v6 offset:18432
    s_waitcnt lgkmcnt(2)
    v_mfma_f32_32x32x16_bf16 v[112:127], v[140:143], v[80:83], v[112:127]
    s_nop 0
    v_mul_f32 v102, v102, v128
    v_mul_f32 v103, v103, v130
    v_cvt_pk_bf16_f32 v175, v102, v103
    s_add_u32 s41, s60, 49152
    buffer_store_dwordx4 v[172:175], v135, s[28:31], s41 offen sc1
    ds_read_b128 v[140:143], v6 offset:19456
    s_waitcnt lgkmcnt(2)
    v_mfma_f32_32x32x16_bf16 v[112:127], v[144:147], v[84:87], v[112:127]
    s_waitcnt lgkmcnt(1)
    v_mfma_f32_32x32x16_bf16 v[112:127], v[136:139], v[88:91], v[112:127]
    s_waitcnt lgkmcnt(0)
    v_mfma_f32_32x32x16_bf16 v[112:127], v[140:143], v[92:95], v[112:127]
    s_nop 11
    ds_write_b128 v7, v[112:115] offset:0
    ds_write_b128 v7, v[116:119] offset:1024
    ds_write_b128 v7, v[120:123] offset:2048
    ds_write_b128 v7, v[124:127] offset:3072
    s_waitcnt lgkmcnt(0)
    s_barrier
    s_setprio 0
    s_cmp_lg_u32 s32, 0
    s_cbranch_scc1 Lf4_19
    s_add_u32 s38, s35, 3
    s_lshl_b32 s37, s36, 7
    s_add_u32 s37, s37, 0x30000
    v_mov_b32 v2, s38
    v_mov_b32 v3, 0
    s_mov_b64 exec, 1
    buffer_store_dword v2, v3, s[28:31], s37 offen sc1
    s_mov_b64 exec, -1
Lf4_19:
    v_add_u32 v6, 0xfffec000, v6
    ds_read_b128 v[136:139], v6 offset:0
    ds_read_b128 v[140:143], v6 offset:1024
    ds_read_b128 v[144:147], v6 offset:2048
    s_waitcnt lgkmcnt(2)
    v_mfma_f32_32x32x16_bf16 v[96:111], v[136:139], v[16:19], 0
    s_mul_i32 s39, s34, 40
    s_and_b32 s38, s32, 3
    s_mul_i32 s38, s38, 10
    s_add_u32 s39, s39, s38
    s_lshl_b32 s39, s39, 10
    s_add_u32 s39, s39, 0x1ec0000
    s_lshl_b32 s38, s38, 10
    s_add_u32 m0, s38, 102400
    s_nop 0
    buffer_load_dwordx4 v135, s[28:31], s39 offen offset:0 sc1 lds
    buffer_load_dwordx4 v135, s[28:31], s39 offen offset:1024 sc1 lds
    ds_read_b128 v[136:139], v6 offset:3072
    s_waitcnt lgkmcnt(2)
    v_mfma_f32_32x32x16_bf16 v[96:111], v[140:143], v[20:23], v[96:111]
    buffer_load_dwordx4 v135, s[28:31], s39 offen offset:2048 sc1 lds
    buffer_load_dwordx4 v135, s[28:31], s39 offen offset:3072 sc1 lds
    ds_read_b128 v[140:143], v6 offset:4096
    s_waitcnt lgkmcnt(2)
    v_mfma_f32_32x32x16_bf16 v[96:111], v[144:147], v[24:27], v[96:111]
    s_add_u32 s39, s39, 4096
    s_add_u32 m0, m0, 4096
    s_nop 0
    buffer_load_dwordx4 v135, s[28:31], s39 offen offset:0 sc1 lds
    buffer_load_dwordx4 v135, s[28:31], s39 offen offset:1024 sc1 lds
    ds_read_b128 v[144:147], v6 offset:5120
    s_waitcnt lgkmcnt(2)
    v_mfma_f32_32x32x16_bf16 v[96:111], v[136:139], v[28:31], v[96:111]
    buffer_load_dwordx4 v135, s[28:31], s39 offen offset:2048 sc1 lds
    buffer_load_dwordx4 v135, s[28:31], s39 offen offset:3072 sc1 lds
    ds_read_b128 v[136:139], v6 offset:6144
    s_waitcnt lgkmcnt(2)
    v_mfma_f32_32x32x16_bf16 v[96:111], v[140:143], v[32:35], v[96:111]
    s_add_u32 s39, s39, 4096
    s_add_u32 m0, m0, 4096
    s_nop 0
    buffer_load_dwordx4 v135, s[28:31], s39 offen offset:0 sc1 lds
    buffer_load_dwordx4 v135, s[28:31], s39 offen offset:1024 sc1 lds
    s_add_u32 s41, s63, 81920
    buffer_load_dwordx4 v[168:171], v135, s[28:31], s41 offen sc1
    ds_read_b128 v[140:143], v6 offset:7168
    s_waitcnt lgkmcnt(2)
    v_mfma_f32_32x32x16_bf16 v[96:111], v[144:147], v[36:39], v[96:111]
    ds_read_b128 v[144:147], v6 offset:8192
    s_waitcnt lgkmcnt(2)
    v_mfma_f32_32x32x16_bf16 v[96:111], v[136:139], v[40:43], v[96:111]
    ds_read_b128 v[136:139], v6 offset:9216
    s_waitcnt lgkmcnt(2)
    v_mfma_f32_32x32x16_bf16 v[96:111], v[140:143], v[44:47], v[96:111]
    ds_read_b128 v[140:143], v6 offset:10240
    s_waitcnt lgkmcnt(2)
    v_mfma_f32_32x32x16_bf16 v[96:111], v[144:147], v[48:51], v[96:111]
    ds_read_b128 v[144:147], v6 offset:11264
    s_waitcnt lgkmcnt(2)
    v_mfma_f32_32x32x16_bf16 v[96:111], v[136:139], v[52:55], v[96:111]
    ds_read_b128 v[136:139], v6 offset:12288
    s_waitcnt lgkmcnt(2)
    v_mfma_f32_32x32x16_bf16 v[96:111], v[140:143], v[56:59], v[96:111]
    ds_read_b128 v[140:143], v6 offset:13312
    s_waitcnt lgkmcnt(2)
    v_mfma_f32_32x32x16_bf16 v[96:111], v[144:147], v[60:63], v[96:111]
    ds_read_b128 v[144:147], v6 offset:14336
    s_waitcnt lgkmcnt(2)
    v_mfma_f32_32x32x16_bf16 v[96:111], v[136:139], v[64:67], v[96:111]
    ds_read_b128 v[136:139], v6 offset:15360
    s_waitcnt lgkmcnt(2)
    v_mfma_f32_32x32x16_bf16 v[96:111], v[140:143], v[68:71], v[96:111]
    ds_read_b128 v[140:143], v6 offset:16384
    s_waitcnt lgkmcnt(2)
    v_mfma_f32_32x32x16_bf16 v[96:111], v[144:147], v[72:75], v[96:111]
    ds_read_b128 v[144:147], v6 offset:17408
    s_waitcnt lgkmcnt(2)
    v_mfma_f32_32x32x16_bf16 v[96:111], v[136:139], v[76:79], v[96:111]
    ds_read_b128 v[136:139], v6 offset:18432
    s_waitcnt lgkmcnt(2)
    v_mfma_f32_32x32x16_bf16 v[96:111], v[140:143], v[80:83], v[96:111]
    ds_read_b128 v[140:143], v6 offset:19456
    s_waitcnt lgkmcnt(2)
    v_mfma_f32_32x32x16_bf16 v[96:111], v[144:147], v[84:87], v[96:111]
    s_waitcnt lgkmcnt(1)
    v_mfma_f32_32x32x16_bf16 v[96:111], v[136:139], v[88:91], v[96:111]
    s_waitcnt lgkmcnt(0)
    v_mfma_f32_32x32x16_bf16 v[96:111], v[140:143], v[92:95], v[96:111]
    s_cmp_ge_u32 s34, 12
    s_cbranch_scc1 Lp4x1
    s_waitcnt vmcnt(1)
    s_waitcnt lgkmcnt(0)
    s_barrier
    s_setprio 1
    s_cmp_lg_u32 s32, 0
    s_cbranch_scc1 Lf4_20
    s_add_u32 s38, s35, 4
    s_lshl_b32 s37, s36, 7
    s_add_u32 s37, s37, 0x30000
    v_mov_b32 v2, s38
    v_mov_b32 v3, 0
    s_mov_b64 exec, 1
    buffer_store_dword v2, v3, s[28:31], s37 offen sc1
    s_mov_b64 exec, -1
Lf4_20:
    v_add_u32 v6, 0x14000, v6
    ds_read_b128 v[136:139], v6 offset:0
    ds_read_b128 v[140:143], v6 offset:1024
    ds_read_b128 v[144:147], v6 offset:2048
    s_waitcnt lgkmcnt(2)
    v_mfma_f32_32x32x16_bf16 v[112:127], v[136:139], v[16:19], 0
    s_waitcnt vmcnt(0)
    v_mfma_f32_32x32x16_bf16 v[96:111], v[168:171], v[164:167], v[96:111]
    ds_read_b128 v[136:139], v6 offset:3072
    s_waitcnt lgkmcnt(2)
    v_mfma_f32_32x32x16_bf16 v[112:127], v[140:143], v[20:23], v[112:127]
    ds_read_b128 v[148:151], v7 offset:0
    ds_read_b128 v[152:155], v7 offset:1024
    ds_read_b128 v[156:159], v7 offset:2048
    ds_read_b128 v[160:163], v7 offset:3072
    s_nop 2
    s_add_u32 s39, s64, 0x4000
    s_lshl_b32 s38, s32, 12
    s_add_u32 m0, s38, 61440
    s_nop 0
    buffer_load_dwordx4 v135, s[28:31], s39 offen offset:0 sc1 lds
    ds_read_b128 v[140:143], v6 offset:4096
    s_waitcnt lgkmcnt(6)
    v_mfma_f32_32x32x16_bf16 v[112:127], v[144:147], v[24:27], v[112:127]
    s_waitcnt lgkmcnt(4)
    v_add_f32 v96, v96, v148
    v_add_f32 v97, v97, v149
    v_add_f32 v98, v98, v150
    v_add_f32 v99, v99, v151
    s_waitcnt lgkmcnt(2)
    v_add_f32 v104, v104, v156
    v_add_f32 v105, v105, v157
    s_cmp_lg_u32 s32, 7
    s_cbranch_scc1 Lai_21
    v_and_b32 v132, 15, v1
    s_lshl_b32 s37, s33, 11
    s_add_u32 s37, s37, 0x30000
    v_lshl_add_u32 v132, v132, 7, s37
    buffer_load_dword v133, v132, s[28:31], 0 offen sc1
Lai_21:
    ds_read_b128 v[144:147], v6 offset:5120
    v_mfma_f32_32x32x16_bf16 v[112:127], v[136:139], v[28:31], v[112:127]
    v_add_f32 v106, v106, v158
    v_add_f32 v107, v107, v159
    v_add_f32 v100, v100, v152
    v_add_f32 v101, v101, v153
    v_add_f32 v102, v102, v154
    v_add_f32 v103, v103, v155
    buffer_load_dwordx4 v135, s[28:31], s39 offen offset:1024 sc1 lds
    ds_read_b128 v[136:139], v6 offset:6144
    s_waitcnt lgkmcnt(2)
    v_mfma_f32_32x32x16_bf16 v[112:127], v[140:143], v[32:35], v[112:127]
    v_add_f32 v108, v108, v160
    v_add_f32 v109, v109, v161
    v_add_f32 v110, v110, v162
    v_add_f32 v111, v111, v163
    v_mul_f32 v128, v96, v96
    v_mul_f32 v130, v97, v97
    ds_read_b128 v[140:143], v6 offset:7168
    s_waitcnt lgkmcnt(2)
    v_mfma_f32_32x32x16_bf16 v[112:127], v[144:147], v[36:39], v[112:127]
    v_fma_f32 v128, v128, v4, v8
    v_fma_f32 v130, v130, v4, v8
    v_mul_f32 v128, v128, v96
    v_mul_f32 v130, v130, v97
    v_exp_f32 v128, v128
    v_exp_f32 v130, v130
    buffer_load_dwordx4 v135, s[28:31], s39 offen offset:2048 sc1 lds
    ds_read_b128 v[144:147], v6 offset:8192
    s_waitcnt lgkmcnt(2)
    v_mfma_f32_32x32x16_bf16 v[112:127], v[136:139], v[40:43], v[112:127]
    v_mul_f32 v96, v96, v104
    v_mul_f32 v97, v97, v105
    v_fma_f32 v128, v128, v5, v5
    v_fma_f32 v130, v130, v5, v5
    v_rcp_f32 v128, v128
    v_rcp_f32 v130, v130
    ds_read_b128 v[136:139], v6 offset:9216
    s_waitcnt lgkmcnt(2)
    v_mfma_f32_32x32x16_bf16 v[112:127], v[140:143], v[44:47], v[112:127]
    s_nop 0
    v_mul_f32 v96, v96, v128
    v_mul_f32 v97, v97, v130
    v_cvt_pk_bf16_f32 v172, v96, v97
    v_mul_f32 v128, v98, v98
    v_mul_f32 v130, v99, v99
    buffer_load_dwordx4 v135, s[28:31], s39 offen offset:3072 sc1 lds
    ds_read_b128 v[140:143], v6 offset:10240
    s_waitcnt lgkmcnt(2)
    v_mfma_f32_32x32x16_bf16 v[112:127], v[144:147], v[48:51], v[112:127]
    v_fma_f32 v128, v128, v4, v8
    v_fma_f32 v130, v130, v4, v8
    v_mul_f32 v128, v128, v98
    v_mul_f32 v130, v130, v99
    v_exp_f32 v128, v128
    v_exp_f32 v130, v130
    ds_read_b128 v[144:147], v6 offset:11264
    s_waitcnt lgkmcnt(2)
    v_mfma_f32_32x32x16_bf16 v[112:127], v[136:139], v[52:55], v[112:127]
    v_mul_f32 v98, v98, v106
    v_mul_f32 v99, v99, v107
    v_fma_f32 v128, v128, v5, v5
    v_fma_f32 v130, v130, v5, v5
    v_rcp_f32 v128, v128
    v_rcp_f32 v130, v130
    s_add_u32 s39, s64, 0xfffe9000
    s_lshl_b32 s38, s32, 12
    s_add_u32 m0, s38, 45056
    s_nop 0
    buffer_load_dwordx4 v135, s[28:31], s39 offen offset:0 sc1 lds
    ds_read_b128 v[136:139], v6 offset:12288
    s_waitcnt lgkmcnt(2)
    v_mfma_f32_32x32x16_bf16 v[112:127], v[140:143], v[56:59], v[112:127]
    s_nop 0
    v_mul_f32 v98, v98, v128
    v_mul_f32 v99, v99, v130
    v_cvt_pk_bf16_f32 v173, v98, v99
    v_mul_f32 v128, v100, v100
    v_mul_f32 v130, v101, v101
    ds_read_b128 v[140:143], v6 offset:13312
    s_waitcnt lgkmcnt(2)
    v_mfma_f32_32x32x16_bf16 v[112:127], v[144:147], v[60:63], v[112:127]
    v_fma_f32 v128, v128, v4, v8
    v_fma_f32 v130, v130, v4, v8
    v_mul_f32 v128, v128, v100
    v_mul_f32 v130, v130, v101
    v_exp_f32 v128, v128
    v_exp_f32 v130, v130
    buffer_load_dwordx4 v135, s[28:31], s39 offen offset:1024 sc1 lds
    ds_read_b128 v[144:147], v6 offset:14336
    s_waitcnt lgkmcnt(2)
    v_mfma_f32_32x32x16_bf16 v[112:127], v[136:139], v[64:67], v[112:127]
    v_mul_f32 v100, v100, v108
    v_mul_f32 v101, v101, v109
    v_fma_f32 v128, v128, v5, v5
    v_fma_f32 v130, v130, v5, v5
    v_rcp_f32 v128, v128
    v_rcp_f32 v130, v130
    ds_read_b128 v[136:139], v6 offset:15360
    s_waitcnt lgkmcnt(2)
    v_mfma_f32_32x32x16_bf16 v[112:127], v[140:143], v[68:71], v[112:127]
    s_nop 0
    v_mul_f32 v100, v100, v128
    v_mul_f32 v101, v101, v130
    v_cvt_pk_bf16_f32 v174, v100, v101
    v_mul_f32 v128, v102, v102
    v_mul_f32 v130, v103, v103
    buffer_load_dwordx4 v135, s[28:31], s39 offen offset:2048 sc1 lds
    ds_read_b128 v[140:143], v6 offset:16384
    s_waitcnt lgkmcnt(2)
    v_mfma_f32_32x32x16_bf16 v[112:127], v[144:147], v[72:75], v[112:127]
    v_fma_f32 v128, v128, v4, v8
    v_fma_f32 v130, v130, v4, v8
    v_mul_f32 v128, v128, v102
    v_mul_f32 v130, v130, v103
    v_exp_f32 v128, v128
    v_exp_f32 v130, v130
    ds_read_b128 v[144:147], v6 offset:17408
    s_waitcnt lgkmcnt(2)
    v_mfma_f32_32x32x16_bf16 v[112:127], v[136:139], v[76:79], v[112:127]
    v_mul_f32 v102, v102, v110
    v_mul_f32 v103, v103, v111
    v_fma_f32 v128, v128, v5, v5
    v_fma_f32 v130, v130, v5, v5
    v_rcp_f32 v128, v128
    v_rcp_f32 v130, v130
    buffer_load_dwordx4 v135, s[28:31], s39 offen offset:3072 sc1 lds
    ds_read_b128 v[136:139], v6 offset:18432
    s_waitcnt lgkmcnt(2)
    v_mfma_f32_32x32x16_bf16 v[112:127], v[140:143], v[80:83], v[112:127]
    s_nop 0
    v_mul_f32 v102, v102, v128
    v_mul_f32 v103, v103, v130
    v_cvt_pk_bf16_f32 v175, v102, v103
    s_add_u32 s41, s60, 81920
    buffer_store_dwordx4 v[172:175], v135, s[28:31], s41 offen sc1
    ds_read_b128 v[140:143], v6 offset:19456
    s_waitcnt lgkmcnt(2)
    v_mfma_f32_32x32x16_bf16 v[112:127], v[144:147], v[84:87], v[112:127]
    s_waitcnt lgkmcnt(1)
    v_mfma_f32_32x32x16_bf16 v[112:127], v[136:139], v[88:91], v[112:127]
    s_waitcnt lgkmcnt(0)
    v_mfma_f32_32x32x16_bf16 v[112:127], v[140:143], v[92:95], v[112:127]
    s_nop 11
    ds_write_b128 v7, v[112:115] offset:0
    ds_write_b128 v7, v[116:119] offset:1024
    ds_write_b128 v7, v[120:123] offset:2048
    ds_write_b128 v7, v[124:127] offset:3072
    s_cmp_lg_u32 s32, 7
    s_cbranch_scc1 Lac_22
    s_waitcnt vmcnt(1)
    v_subrev_u32 v133, s35, v133
    v_subrev_u32 v133, 3, v133
    v_cmp_lt_u32 vcc, 4, v133
    s_cbranch_vccz Lac_22
    s_mov_b32 s46, 30000
Lpa_23:
    buffer_load_dword v133, v132, s[28:31], 0 offen sc1
    s_waitcnt vmcnt(0)
    v_subrev_u32 v133, s35, v133
    v_subrev_u32 v133, 3, v133
    v_cmp_lt_u32 vcc, 4, v133
    s_cbranch_vccz Lpea_24
    s_sub_u32 s46, s46, 1
    s_cmp_gt_i32 s46, 0
    s_cbranch_scc1 Lpa_23
Lpea_24:
Lac_22:
    s_waitcnt lgkmcnt(0)
    s_barrier
    s_setprio 0
    s_cmp_lg_u32 s32, 0
    s_cbranch_scc1 Lf4_25
    s_add_u32 s38, s35, 5
    s_lshl_b32 s37, s36, 7
    s_add_u32 s37, s37, 0x30000
    v_mov_b32 v2, s38
    v_mov_b32 v3, 0
    s_mov_b64 exec, 1
    buffer_store_dword v2, v3, s[28:31], s37 offen sc1
    s_mov_b64 exec, -1
Lf4_25:
    s_cmp_lg_u32 s32, 7
    s_cbranch_scc1 Lai_26
    v_and_b32 v132, 15, v1
    s_lshl_b32 s37, s33, 11
    s_add_u32 s37, s37, 0x30000
    v_lshl_add_u32 v132, v132, 7, s37
    buffer_load_dword v133, v132, s[28:31], 0 offen sc1
Lai_26:
    s_add_u32 s41, s61, 0x32800
    buffer_load_dwordx4 v[16:19], v135, s[28:31], s41 offen sc1
    s_add_u32 s41, s61, 0x40000
    buffer_load_dwordx4 v[20:23], v135, s[28:31], s41 offen sc1
    s_add_u32 s41, s61, 0x32c00
    buffer_load_dwordx4 v[24:27], v135, s[28:31], s41 offen sc1
    s_add_u32 s41, s61, 0x40400
    buffer_load_dwordx4 v[28:31], v135, s[28:31], s41 offen sc1
    s_add_u32 s41, s61, 0x34800
    buffer_load_dwordx4 v[32:35], v135, s[28:31], s41 offen sc1
    s_add_u32 s41, s61, 0x42000
    buffer_load_dwordx4 v[36:39], v135, s[28:31], s41 offen sc1
    s_add_u32 s41, s61, 0x34c00
    buffer_load_dwordx4 v[40:43], v135, s[28:31], s41 offen sc1
    s_add_u32 s41, s61, 0x42400
    buffer_load_dwordx4 v[44:47], v135, s[28:31], s41 offen sc1
    s_waitcnt vmcnt(9)
    s_branch Lp4e
Lp4x1:
    s_waitcnt vmcnt(0) lgkmcnt(0)
    s_barrier
    s_setprio 0
    s_cmp_lg_u32 s32, 0
    s_cbranch_scc1 Lf4_27
    s_add_u32 s38, s35, 5
    s_lshl_b32 s37, s36, 7
    s_add_u32 s37, s37, 0x30000
    v_mov_b32 v2, s38
    v_mov_b32 v3, 0
    s_mov_b64 exec, 1
    buffer_store_dword v2, v3, s[28:31], s37 offen sc1
    s_mov_b64 exec, -1
Lf4_27:
    v_mfma_f32_32x32x16_bf16 v[96:111], v[168:171], v[164:167], v[96:111]
    ds_read_b128 v[148:151], v7 offset:0
    ds_read_b128 v[152:155], v7 offset:1024
    ds_read_b128 v[156:159], v7 offset:2048
    ds_read_b128 v[160:163], v7 offset:3072
    s_nop 7
    s_waitcnt lgkmcnt(3)
    v_add_f32 v96, v96, v148
    v_add_f32 v97, v97, v149
    v_add_f32 v98, v98, v150
    v_add_f32 v99, v99, v151
    s_waitcnt lgkmcnt(1)
    v_add_f32 v104, v104, v156
    v_add_f32 v105, v105, v157
    v_add_f32 v106, v106, v158
    v_add_f32 v107, v107, v159
    v_add_f32 v100, v100, v152
    v_add_f32 v101, v101, v153
    v_add_f32 v102, v102, v154
    v_add_f32 v103, v103, v155
    s_waitcnt lgkmcnt(0)
    v_add_f32 v108, v108, v160
    v_add_f32 v109, v109, v161
    v_add_f32 v110, v110, v162
    v_add_f32 v111, v111, v163
    v_mul_f32 v128, v96, v96
    v_mul_f32 v130, v97, v97
    v_fma_f32 v128, v128, v4, v8
    v_fma_f32 v130, v130, v4, v8
    v_mul_f32 v128, v128, v96
    v_mul_f32 v130, v130, v97
    v_exp_f32 v128, v128
    v_exp_f32 v130, v130
    v_mul_f32 v96, v96, v104
    v_mul_f32 v97, v97, v105
    v_fma_f32 v128, v128, v5, v5
    v_fma_f32 v130, v130, v5, v5
    v_rcp_f32 v128, v128
    v_rcp_f32 v130, v130
    s_nop 0
    v_mul_f32 v96, v96, v128
    v_mul_f32 v97, v97, v130
    v_cvt_pk_bf16_f32 v172, v96, v97
    v_mul_f32 v128, v98, v98
    v_mul_f32 v130, v99, v99
    v_fma_f32 v128, v128, v4, v8
    v_fma_f32 v130, v130, v4, v8
    v_mul_f32 v128, v128, v98
    v_mul_f32 v130, v130, v99
    v_exp_f32 v128, v128
    v_exp_f32 v130, v130
    v_mul_f32 v98, v98, v106
    v_mul_f32 v99, v99, v107
    v_fma_f32 v128, v128, v5, v5
    v_fma_f32 v130, v130, v5, v5
    v_rcp_f32 v128, v128
    v_rcp_f32 v130, v130
    s_nop 0
    v_mul_f32 v98, v98, v128
    v_mul_f32 v99, v99, v130
    v_cvt_pk_bf16_f32 v173, v98, v99
    v_mul_f32 v128, v100, v100
    v_mul_f32 v130, v101, v101
    v_fma_f32 v128, v128, v4, v8
    v_fma_f32 v130, v130, v4, v8
    v_mul_f32 v128, v128, v100
    v_mul_f32 v130, v130, v101
    v_exp_f32 v128, v128
    v_exp_f32 v130, v130
    v_mul_f32 v100, v100, v108
    v_mul_f32 v101, v101, v109
    v_fma_f32 v128, v128, v5, v5
    v_fma_f32 v130, v130, v5, v5
    v_rcp_f32 v128, v128
    v_rcp_f32 v130, v130
    s_nop 0
    v_mul_f32 v100, v100, v128
    v_mul_f32 v101, v101, v130
    v_cvt_pk_bf16_f32 v174, v100, v101
    v_mul_f32 v128, v102, v102
    v_mul_f32 v130, v103, v103
    v_fma_f32 v128, v128, v4, v8
    v_fma_f32 v130, v130, v4, v8
    v_mul_f32 v128, v128, v102
    v_mul_f32 v130, v130, v103
    v_exp_f32 v128, v128
    v_exp_f32 v130, v130
    v_mul_f32 v102, v102, v110
    v_mul_f32 v103, v103, v111
    v_fma_f32 v128, v128, v5, v5
    v_fma_f32 v130, v130, v5, v5
    v_rcp_f32 v128, v128
    v_rcp_f32 v130, v130
    s_nop 0
    v_mul_f32 v102, v102, v128
    v_mul_f32 v103, v103, v130
    v_cvt_pk_bf16_f32 v175, v102, v103
    s_add_u32 s41, s60, 81920
    buffer_store_dwordx4 v[172:175], v135, s[28:31], s41 offen sc1
    s_cmp_lg_u32 s32, 7
    s_cbranch_scc1 Lq6q
    v_and_b32 v132, 15, v1
    s_lshl_b32 s37, s33, 11
    v_lshlrev_b32 v132, 7, v132
    s_add_u32 s37, s37, 0x30000
    v_add_u32 v132, s37, v132
    s_mov_b32 s46, 30000
Lp4q_28:
    buffer_load_dword v133, v132, s[28:31], 0 offen sc1
    s_waitcnt vmcnt(0)
    v_subrev_u32 v133, s35, v133
    v_subrev_u32 v133, 4, v133
    v_cmp_lt_u32 vcc, 3, v133
    s_cbranch_vccz Lpe4q_29
    s_sub_u32 s46, s46, 1
    s_cmp_gt_i32 s46, 0
    s_cbranch_scc1 Lp4q_28
Lpe4q_29:
Lq6q:
    s_barrier
    s_add_u32 s39, s64, 0x0
    s_lshl_b32 s38, s32, 12
    s_add_u32 m0, s38, 20480
    s_nop 0
    buffer_load_dwordx4 v135, s[28:31], s39 offen offset:0 sc1 lds
    buffer_load_dwordx4 v135, s[28:31], s39 offen offset:1024 sc1 lds
    buffer_load_dwordx4 v135, s[28:31], s39 offen offset:2048 sc1 lds
    buffer_load_dwordx4 v135, s[28:31], s39 offen offset:3072 sc1 lds
    s_add_u32 s39, s64, 0x4000
    s_lshl_b32 s38, s32, 12
    s_add_u32 m0, s38, 61440
    s_nop 0
    buffer_load_dwordx4 v135, s[28:31], s39 offen offset:0 sc1 lds
    buffer_load_dwordx4 v135, s[28:31], s39 offen offset:1024 sc1 lds
    buffer_load_dwordx4 v135, s[28:31], s39 offen offset:2048 sc1 lds
    buffer_load_dwordx4 v135, s[28:31], s39 offen offset:3072 sc1 lds
    s_add_u32 s41, s61, 0x32800
    buffer_load_dwordx4 v[16:19], v135, s[28:31], s41 offen sc1
    s_add_u32 s41, s61, 0x40000
    buffer_load_dwordx4 v[20:23], v135, s[28:31], s41 offen sc1
    s_add_u32 s41, s61, 0x32c00
    buffer_load_dwordx4 v[24:27], v135, s[28:31], s41 offen sc1
    s_add_u32 s41, s61, 0x40400
    buffer_load_dwordx4 v[28:31], v135, s[28:31], s41 offen sc1
    s_add_u32 s41, s61, 0x34800
    buffer_load_dwordx4 v[32:35], v135, s[28:31], s41 offen sc1
    s_add_u32 s41, s61, 0x42000
    buffer_load_dwordx4 v[36:39], v135, s[28:31], s41 offen sc1
    s_add_u32 s41, s61, 0x34c00
    buffer_load_dwordx4 v[40:43], v135, s[28:31], s41 offen sc1
    s_add_u32 s41, s61, 0x42400
    buffer_load_dwordx4 v[44:47], v135, s[28:31], s41 offen sc1
    s_waitcnt vmcnt(0)
Lp4e:
    s_barrier
    v_lshrrev_b32 v2, 5, v1
    v_lshlrev_b32 v2, 10, v2
    v_bfe_u32 v3, v1, 4, 1
    v_and_b32 v4, 15, v1
    v_lshl_add_u32 v2, v3, 9, v2
    v_lshl_add_u32 v2, v4, 4, v2
    s_and_b32 s37, s32, 3
    s_mul_i32 s38, s37, 4096
    s_add_u32 s38, s38, 20480
    s_add_u32 s39, s37, 0
    s_bfe_u32 s40, s39, 0x10001
    s_mul_i32 s40, s40, 16384
    s_add_u32 s40, s40, s38
    s_and_b32 s39, s39, 1
    s_lshl_b32 s41, s39, 8
    s_add_u32 s41, s41, s40
    v_add_u32 v128, s41, v2
    s_add_u32 s39, s37, 1
    s_bfe_u32 s40, s39, 0x10001
    s_mul_i32 s40, s40, 16384
    s_add_u32 s40, s40, s38
    s_and_b32 s39, s39, 1
    s_lshl_b32 s41, s39, 8
    s_add_u32 s41, s41, s40
    v_add_u32 v129, s41, v2
    s_add_u32 s39, s37, 2
    s_bfe_u32 s40, s39, 0x10001
    s_mul_i32 s40, s40, 16384
    s_add_u32 s40, s40, s38
    s_and_b32 s39, s39, 1
    s_lshl_b32 s41, s39, 8
    s_add_u32 s41, s41, s40
    v_add_u32 v130, s41, v2
    s_add_u32 s39, s37, 3
    s_bfe_u32 s40, s39, 0x10001
    s_mul_i32 s40, s40, 16384
    s_add_u32 s40, s40, s38
    s_and_b32 s39, s39, 1
    s_lshl_b32 s41, s39, 8
    s_add_u32 s41, s41, s40
    v_add_u32 v131, s41, v2
    s_cmp_ge_u32 s32, 4
    s_cbranch_scc1 Lp5b
    ds_read_b128 v[152:155], v128 offset:0
    ds_read_b128 v[156:159], v129 offset:0
    ds_read_b128 v[160:163], v130 offset:0
    ds_read_b128 v[164:167], v131 offset:0
    ds_read_b128 v[168:171], v128 offset:2048
    ds_read_b128 v[172:175], v129 offset:2048
    ds_read_b128 v[120:123], v130 offset:2048
    ds_read_b128 v[124:127], v131 offset:2048
    s_waitcnt lgkmcnt(7)
    v_mfma_f32_16x16x32_bf16 v[88:91], v[176:179], v[152:155], 0
    v_mfma_f32_16x16x32_bf16 v[104:107], v[180:183], v[152:155], 0
    v_mfma_f32_16x16x32_bf16 v[136:139], v[184:187], v[152:155], 0
    s_waitcnt lgkmcnt(6)
    v_mfma_f32_16x16x32_bf16 v[92:95], v[176:179], v[156:159], 0
    v_mfma_f32_16x16x32_bf16 v[108:111], v[180:183], v[156:159], 0
    v_mfma_f32_16x16x32_bf16 v[140:143], v[184:187], v[156:159], 0
    s_waitcnt lgkmcnt(5)
    v_mfma_f32_16x16x32_bf16 v[96:99], v[176:179], v[160:163], 0
    v_mfma_f32_16x16x32_bf16 v[112:115], v[180:183], v[160:163], 0
    v_mfma_f32_16x16x32_bf16 v[144:147], v[184:187], v[160:163], 0
    s_waitcnt lgkmcnt(4)
    v_mfma_f32_16x16x32_bf16 v[100:103], v[176:179], v[164:167], 0
    v_mfma_f32_16x16x32_bf16 v[116:119], v[180:183], v[164:167], 0
    v_mfma_f32_16x16x32_bf16 v[148:151], v[184:187], v[164:167], 0
    s_waitcnt lgkmcnt(3)
    v_mfma_f32_16x16x32_bf16 v[88:91], v[188:191], v[168:171], v[88:91]
    v_mfma_f32_16x16x32_bf16 v[104:107], v[192:195], v[168:171], v[104:107]
    v_mfma_f32_16x16x32_bf16 v[136:139], v[196:199], v[168:171], v[136:139]
    s_add_u32 s39, s64, 0x8000
    s_lshl_b32 s38, s32, 12
    s_add_u32 m0, s38, 94208
    s_nop 0
    buffer_load_dwordx4 v135, s[28:31], s39 offen offset:0 sc1 lds
    s_waitcnt lgkmcnt(2)
    v_mfma_f32_16x16x32_bf16 v[92:95], v[188:191], v[172:175], v[92:95]
    v_mfma_f32_16x16x32_bf16 v[108:111], v[192:195], v[172:175], v[108:111]
    v_mfma_f32_16x16x32_bf16 v[140:143], v[196:199], v[172:175], v[140:143]
    buffer_load_dwordx4 v135, s[28:31], s39 offen offset:1024 sc1 lds
    s_waitcnt lgkmcnt(1)
    v_mfma_f32_16x16x32_bf16 v[96:99], v[188:191], v[120:123], v[96:99]
    v_mfma_f32_16x16x32_bf16 v[112:115], v[192:195], v[120:123], v[112:115]
    v_mfma_f32_16x16x32_bf16 v[144:147], v[196:199], v[120:123], v[144:147]
    buffer_load_dwordx4 v135, s[28:31], s39 offen offset:2048 sc1 lds
    s_waitcnt lgkmcnt(0)
    v_mfma_f32_16x16x32_bf16 v[100:103], v[188:191], v[124:127], v[100:103]
    v_mfma_f32_16x16x32_bf16 v[116:119], v[192:195], v[124:127], v[116:119]
    v_mfma_f32_16x16x32_bf16 v[148:151], v[196:199], v[124:127], v[148:151]
    buffer_load_dwordx4 v135, s[28:31], s39 offen offset:3072 sc1 lds
    s_waitcnt vmcnt(4)
    v_mov_b32 v2, 1
    v_mov_b32 v3, 3604
    s_waitcnt lgkmcnt(0)
    s_mov_b64 exec, 1
    ds_add_rtn_u32 v2, v3, v2
    s_waitcnt lgkmcnt(0)
    s_mov_b64 exec, -1
    v_readfirstlane_b32 s40, v2
    s_cmp_lg_u32 s40, 7
    s_cbranch_scc1 Lp70
    s_add_u32 s41, s35, 7
    s_mul_i32 s37, s36, 128
    s_add_u32 s37, s37, 196608
    v_mov_b32 v2, s41
    v_mov_b32 v3, 0
    s_mov_b64 s[44:45], exec
    s_mov_b64 exec, 1
    buffer_store_dword v2, v3, s[28:31], s37 offen sc1
    s_mov_b64 exec, s[44:45]
Lp70:
    s_waitcnt lgkmcnt(0)
    s_barrier
    ds_read_b128 v[152:155], v128 offset:40960
    ds_read_b128 v[156:159], v129 offset:40960
    ds_read_b128 v[160:163], v130 offset:40960
    ds_read_b128 v[164:167], v131 offset:40960
    ds_read_b128 v[168:171], v128 offset:43008
    ds_read_b128 v[172:175], v129 offset:43008
    ds_read_b128 v[120:123], v130 offset:43008
    ds_read_b128 v[124:127], v131 offset:43008
    v_add_u32 v128, 0x12000, v128
    v_add_u32 v129, 0x12000, v129
    v_add_u32 v130, 0x12000, v130
    v_add_u32 v131, 0x12000, v131
    s_waitcnt lgkmcnt(7)
    v_mfma_f32_16x16x32_bf16 v[88:91], v[200:203], v[152:155], v[88:91]
    v_mfma_f32_16x16x32_bf16 v[104:107], v[204:207], v[152:155], v[104:107]
    v_mfma_f32_16x16x32_bf16 v[136:139], v[208:211], v[152:155], v[136:139]
    s_waitcnt lgkmcnt(6)
    v_mfma_f32_16x16x32_bf16 v[92:95], v[200:203], v[156:159], v[92:95]
    v_mfma_f32_16x16x32_bf16 v[108:111], v[204:207], v[156:159], v[108:111]
    v_mfma_f32_16x16x32_bf16 v[140:143], v[208:211], v[156:159], v[140:143]
    s_waitcnt lgkmcnt(5)
    v_mfma_f32_16x16x32_bf16 v[96:99], v[200:203], v[160:163], v[96:99]
    v_mfma_f32_16x16x32_bf16 v[112:115], v[204:207], v[160:163], v[112:115]
    v_mfma_f32_16x16x32_bf16 v[144:147], v[208:211], v[160:163], v[144:147]
    s_waitcnt lgkmcnt(4)
    v_mfma_f32_16x16x32_bf16 v[100:103], v[200:203], v[164:167], v[100:103]
    v_mfma_f32_16x16x32_bf16 v[116:119], v[204:207], v[164:167], v[116:119]
    v_mfma_f32_16x16x32_bf16 v[148:151], v[208:211], v[164:167], v[148:151]
    s_waitcnt lgkmcnt(3)
    v_mfma_f32_16x16x32_bf16 v[88:91], v[212:215], v[168:171], v[88:91]
    v_mfma_f32_16x16x32_bf16 v[104:107], v[216:219], v[168:171], v[104:107]
    v_mfma_f32_16x16x32_bf16 v[136:139], v[220:223], v[168:171], v[136:139]
    s_add_u32 s39, s64, 0xc000
    s_lshl_b32 s38, s32, 12
    s_add_u32 m0, s38, 126976
    s_nop 0
    buffer_load_dwordx4 v135, s[28:31], s39 offen offset:0 sc1 lds
    s_waitcnt lgkmcnt(2)
    v_mfma_f32_16x16x32_bf16 v[92:95], v[212:215], v[172:175], v[92:95]
    v_mfma_f32_16x16x32_bf16 v[108:111], v[216:219], v[172:175], v[108:111]
    v_mfma_f32_16x16x32_bf16 v[140:143], v[220:223], v[172:175], v[140:143]
    buffer_load_dwordx4 v135, s[28:31], s39 offen offset:1024 sc1 lds
    s_waitcnt lgkmcnt(1)
    v_mfma_f32_16x16x32_bf16 v[96:99], v[212:215], v[120:123], v[96:99]
    v_mfma_f32_16x16x32_bf16 v[112:115], v[216:219], v[120:123], v[112:115]
    v_mfma_f32_16x16x32_bf16 v[144:147], v[220:223], v[120:123], v[144:147]
    buffer_load_dwordx4 v135, s[28:31], s39 offen offset:2048 sc1 lds
    s_waitcnt lgkmcnt(0)
    v_mfma_f32_16x16x32_bf16 v[100:103], v[212:215], v[124:127], v[100:103]
    v_mfma_f32_16x16x32_bf16 v[116:119], v[216:219], v[124:127], v[116:119]
    v_mfma_f32_16x16x32_bf16 v[148:151], v[220:223], v[124:127], v[148:151]
    buffer_load_dwordx4 v135, s[28:31], s39 offen offset:3072 sc1 lds
    s_waitcnt vmcnt(4)
    s_waitcnt lgkmcnt(0)
    s_barrier
    ds_read_b128 v[152:155], v128 offset:0
    ds_read_b128 v[156:159], v129 offset:0
    ds_read_b128 v[160:163], v130 offset:0
    ds_read_b128 v[164:167], v131 offset:0
    ds_read_b128 v[168:171], v128 offset:2048
    ds_read_b128 v[172:175], v129 offset:2048
    ds_read_b128 v[120:123], v130 offset:2048
    ds_read_b128 v[124:127], v131 offset:2048
    s_waitcnt lgkmcnt(7)
    v_mfma_f32_16x16x32_bf16 v[88:91], v[224:227], v[152:155], v[88:91]
    v_mfma_f32_16x16x32_bf16 v[104:107], v[228:231], v[152:155], v[104:107]
    v_mfma_f32_16x16x32_bf16 v[136:139], v[232:235], v[152:155], v[136:139]
    s_waitcnt lgkmcnt(6)
    v_mfma_f32_16x16x32_bf16 v[92:95], v[224:227], v[156:159], v[92:95]
    v_mfma_f32_16x16x32_bf16 v[108:111], v[228:231], v[156:159], v[108:111]
    v_mfma_f32_16x16x32_bf16 v[140:143], v[232:235], v[156:159], v[140:143]
    s_waitcnt lgkmcnt(5)
    v_mfma_f32_16x16x32_bf16 v[96:99], v[224:227], v[160:163], v[96:99]
    v_mfma_f32_16x16x32_bf16 v[112:115], v[228:231], v[160:163], v[112:115]
    v_mfma_f32_16x16x32_bf16 v[144:147], v[232:235], v[160:163], v[144:147]
    s_waitcnt lgkmcnt(4)
    v_mfma_f32_16x16x32_bf16 v[100:103], v[224:227], v[164:167], v[100:103]
    v_mfma_f32_16x16x32_bf16 v[116:119], v[228:231], v[164:167], v[116:119]
    v_mfma_f32_16x16x32_bf16 v[148:151], v[232:235], v[164:167], v[148:151]
    s_waitcnt lgkmcnt(3)
    v_mfma_f32_16x16x32_bf16 v[88:91], v[236:239], v[168:171], v[88:91]
    v_mfma_f32_16x16x32_bf16 v[104:107], v[240:243], v[168:171], v[104:107]
    v_mfma_f32_16x16x32_bf16 v[136:139], v[244:247], v[168:171], v[136:139]
    s_add_u32 s39, s64, 0x10000
    s_lshl_b32 s38, s32, 12
    s_add_u32 m0, s38, 20480
    s_nop 0
    buffer_load_dwordx4 v135, s[28:31], s39 offen offset:0 sc1 lds
    s_waitcnt lgkmcnt(2)
    v_mfma_f32_16x16x32_bf16 v[92:95], v[236:239], v[172:175], v[92:95]
    v_mfma_f32_16x16x32_bf16 v[108:111], v[240:243], v[172:175], v[108:111]
    v_mfma_f32_16x16x32_bf16 v[140:143], v[244:247], v[172:175], v[140:143]
    buffer_load_dwordx4 v135, s[28:31], s39 offen offset:1024 sc1 lds
    s_waitcnt lgkmcnt(1)
    v_mfma_f32_16x16x32_bf16 v[96:99], v[236:239], v[120:123], v[96:99]
    v_mfma_f32_16x16x32_bf16 v[112:115], v[240:243], v[120:123], v[112:115]
    v_mfma_f32_16x16x32_bf16 v[144:147], v[244:247], v[120:123], v[144:147]
    buffer_load_dwordx4 v135, s[28:31], s39 offen offset:2048 sc1 lds
    s_waitcnt lgkmcnt(0)
    v_mfma_f32_16x16x32_bf16 v[100:103], v[236:239], v[124:127], v[100:103]
    v_mfma_f32_16x16x32_bf16 v[116:119], v[240:243], v[124:127], v[116:119]
    v_mfma_f32_16x16x32_bf16 v[148:151], v[244:247], v[124:127], v[148:151]
    buffer_load_dwordx4 v135, s[28:31], s39 offen offset:3072 sc1 lds
    s_waitcnt vmcnt(4)
    s_waitcnt lgkmcnt(0)
    s_barrier
    ds_read_b128 v[152:155], v128 offset:32768
    ds_read_b128 v[156:159], v129 offset:32768
    ds_read_b128 v[160:163], v130 offset:32768
    ds_read_b128 v[164:167], v131 offset:32768
    ds_read_b128 v[168:171], v128 offset:34816
    ds_read_b128 v[172:175], v129 offset:34816
    ds_read_b128 v[120:123], v130 offset:34816
    ds_read_b128 v[124:127], v131 offset:34816
    v_add_u32 v128, 0xfffee000, v128
    v_add_u32 v129, 0xfffee000, v129
    v_add_u32 v130, 0xfffee000, v130
    v_add_u32 v131, 0xfffee000, v131
    s_waitcnt lgkmcnt(7)
    v_mfma_f32_16x16x32_bf16 v[88:91], v[248:251], v[152:155], v[88:91]
    v_mfma_f32_16x16x32_bf16 v[104:107], v[252:255], v[152:155], v[104:107]
    v_mfma_f32_16x16x32_bf16 v[136:139], v[16:19], v[152:155], v[136:139]
    s_add_u32 s41, s61, 0x27000
    buffer_load_dwordx4 v[176:179], v135, s[28:31], s41 offen sc1
    s_waitcnt lgkmcnt(6)
    v_mfma_f32_16x16x32_bf16 v[92:95], v[248:251], v[156:159], v[92:95]
    v_mfma_f32_16x16x32_bf16 v[108:111], v[252:255], v[156:159], v[108:111]
    v_mfma_f32_16x16x32_bf16 v[140:143], v[16:19], v[156:159], v[140:143]
    s_add_u32 s41, s61, 0xc400
    buffer_load_dwordx4 v[180:183], v135, s[28:31], s41 offen sc1
    s_waitcnt lgkmcnt(5)
    v_mfma_f32_16x16x32_bf16 v[96:99], v[248:251], v[160:163], v[96:99]
    v_mfma_f32_16x16x32_bf16 v[112:115], v[252:255], v[160:163], v[112:115]
    v_mfma_f32_16x16x32_bf16 v[144:147], v[16:19], v[160:163], v[144:147]
    s_add_u32 s41, s61, 0x19c00
    buffer_load_dwordx4 v[184:187], v135, s[28:31], s41 offen sc1
    s_waitcnt lgkmcnt(4)
    v_mfma_f32_16x16x32_bf16 v[100:103], v[248:251], v[164:167], v[100:103]
    v_mfma_f32_16x16x32_bf16 v[116:119], v[252:255], v[164:167], v[116:119]
    v_mfma_f32_16x16x32_bf16 v[148:151], v[16:19], v[164:167], v[148:151]
    s_add_u32 s41, s61, 0x27400
    buffer_load_dwordx4 v[188:191], v135, s[28:31], s41 offen sc1
    s_waitcnt lgkmcnt(3)
    v_mfma_f32_16x16x32_bf16 v[88:91], v[20:23], v[168:171], v[88:91]
    v_mfma_f32_16x16x32_bf16 v[104:107], v[24:27], v[168:171], v[104:107]
    v_mfma_f32_16x16x32_bf16 v[136:139], v[28:31], v[168:171], v[136:139]
    s_waitcnt lgkmcnt(2)
    v_mfma_f32_16x16x32_bf16 v[92:95], v[20:23], v[172:175], v[92:95]
    v_mfma_f32_16x16x32_bf16 v[108:111], v[24:27], v[172:175], v[108:111]
    v_mfma_f32_16x16x32_bf16 v[140:143], v[28:31], v[172:175], v[140:143]
    s_waitcnt lgkmcnt(1)
    v_mfma_f32_16x16x32_bf16 v[96:99], v[20:23], v[120:123], v[96:99]
    v_mfma_f32_16x16x32_bf16 v[112:115], v[24:27], v[120:123], v[112:115]
    v_mfma_f32_16x16x32_bf16 v[144:147], v[28:31], v[120:123], v[144:147]
    s_waitcnt lgkmcnt(0)
    v_mfma_f32_16x16x32_bf16 v[100:103], v[20:23], v[124:127], v[100:103]
    v_mfma_f32_16x16x32_bf16 v[116:119], v[24:27], v[124:127], v[116:119]
    v_mfma_f32_16x16x32_bf16 v[148:151], v[28:31], v[124:127], v[148:151]
    s_waitcnt vmcnt(4)
    s_waitcnt lgkmcnt(0)
    s_barrier
    ds_read_b128 v[152:155], v128 offset:0
    ds_read_b128 v[156:159], v129 offset:0
    ds_read_b128 v[160:163], v130 offset:0
    ds_read_b128 v[164:167], v131 offset:0
    ds_read_b128 v[168:171], v128 offset:2048
    ds_read_b128 v[172:175], v129 offset:2048
    ds_read_b128 v[120:123], v130 offset:2048
    ds_read_b128 v[124:127], v131 offset:2048
    s_waitcnt lgkmcnt(7)
    v_mfma_f32_16x16x32_bf16 v[88:91], v[32:35], v[152:155], v[88:91]
    v_mfma_f32_16x16x32_bf16 v[104:107], v[36:39], v[152:155], v[104:107]
    v_mfma_f32_16x16x32_bf16 v[136:139], v[40:43], v[152:155], v[136:139]
    s_add_u32 s39, s64, 0x14000
    s_lshl_b32 s38, s32, 12
    s_add_u32 m0, s38, 61440
    s_nop 0
    buffer_load_dwordx4 v135, s[28:31], s39 offen offset:0 sc1 lds
    s_waitcnt lgkmcnt(6)
    v_mfma_f32_16x16x32_bf16 v[92:95], v[32:35], v[156:159], v[92:95]
    v_mfma_f32_16x16x32_bf16 v[108:111], v[36:39], v[156:159], v[108:111]
    v_mfma_f32_16x16x32_bf16 v[140:143], v[40:43], v[156:159], v[140:143]
    buffer_load_dwordx4 v135, s[28:31], s39 offen offset:1024 sc1 lds
    s_waitcnt lgkmcnt(5)
    v_mfma_f32_16x16x32_bf16 v[96:99], v[32:35], v[160:163], v[96:99]
    v_mfma_f32_16x16x32_bf16 v[112:115], v[36:39], v[160:163], v[112:115]
    v_mfma_f32_16x16x32_bf16 v[144:147], v[40:43], v[160:163], v[144:147]
    buffer_load_dwordx4 v135, s[28:31], s39 offen offset:2048 sc1 lds
    s_waitcnt lgkmcnt(4)
    v_mfma_f32_16x16x32_bf16 v[100:103], v[32:35], v[164:167], v[100:103]
    v_mfma_f32_16x16x32_bf16 v[116:119], v[36:39], v[164:167], v[116:119]
    v_mfma_f32_16x16x32_bf16 v[148:151], v[40:43], v[164:167], v[148:151]
    buffer_load_dwordx4 v135, s[28:31], s39 offen offset:3072 sc1 lds
    s_waitcnt lgkmcnt(3)
    v_mfma_f32_16x16x32_bf16 v[88:91], v[44:47], v[168:171], v[88:91]
    v_mfma_f32_16x16x32_bf16 v[104:107], v[48:51], v[168:171], v[104:107]
    v_mfma_f32_16x16x32_bf16 v[136:139], v[52:55], v[168:171], v[136:139]
    s_add_u32 s39, s64, 0x18000
    s_lshl_b32 s38, s32, 12
    s_add_u32 m0, s38, 94208
    s_nop 0
    buffer_load_dwordx4 v135, s[28:31], s39 offen offset:0 sc1 lds
    s_waitcnt lgkmcnt(2)
    v_mfma_f32_16x16x32_bf16 v[92:95], v[44:47], v[172:175], v[92:95]
    v_mfma_f32_16x16x32_bf16 v[108:111], v[48:51], v[172:175], v[108:111]
    v_mfma_f32_16x16x32_bf16 v[140:143], v[52:55], v[172:175], v[140:143]
    buffer_load_dwordx4 v135, s[28:31], s39 offen offset:1024 sc1 lds
    s_waitcnt lgkmcnt(1)
    v_mfma_f32_16x16x32_bf16 v[96:99], v[44:47], v[120:123], v[96:99]
    v_mfma_f32_16x16x32_bf16 v[112:115], v[48:51], v[120:123], v[112:115]
    v_mfma_f32_16x16x32_bf16 v[144:147], v[52:55], v[120:123], v[144:147]
    buffer_load_dwordx4 v135, s[28:31], s39 offen offset:2048 sc1 lds
    s_waitcnt lgkmcnt(0)
    v_mfma_f32_16x16x32_bf16 v[100:103], v[44:47], v[124:127], v[100:103]
    v_mfma_f32_16x16x32_bf16 v[116:119], v[48:51], v[124:127], v[116:119]
    v_mfma_f32_16x16x32_bf16 v[148:151], v[52:55], v[124:127], v[148:151]
    buffer_load_dwordx4 v135, s[28:31], s39 offen offset:3072 sc1 lds
    s_waitcnt vmcnt(4)
    s_waitcnt lgkmcnt(0)
    s_barrier
    ds_read_b128 v[152:155], v128 offset:40960
    ds_read_b128 v[156:159], v129 offset:40960
    ds_read_b128 v[160:163], v130 offset:40960
    ds_read_b128 v[164:167], v131 offset:40960
    ds_read_b128 v[168:171], v128 offset:43008
    ds_read_b128 v[172:175], v129 offset:43008
    ds_read_b128 v[120:123], v130 offset:43008
    ds_read_b128 v[124:127], v131 offset:43008
    v_add_u32 v128, 0x12000, v128
    v_add_u32 v129, 0x12000, v129
    v_add_u32 v130, 0x12000, v130
    v_add_u32 v131, 0x12000, v131
    s_waitcnt lgkmcnt(7)
    v_mfma_f32_16x16x32_bf16 v[88:91], v[56:59], v[152:155], v[88:91]
    v_mfma_f32_16x16x32_bf16 v[104:107], v[60:63], v[152:155], v[104:107]
    v_mfma_f32_16x16x32_bf16 v[136:139], v[64:67], v[152:155], v[136:139]
    s_and_b32 s37, s32, 3
    s_lshr_b32 s39, s32, 2
    s_mul_i32 s39, s39, 36864
    s_add_u32 s38, s37, 0
    s_and_b32 s38, s38, 3
    s_mul_i32 s38, s38, 3072
    s_add_u32 s38, s38, s39
    s_add_u32 s38, s38, 20480
    v_lshl_add_u32 v6, v1, 4, s38
    s_add_u32 s38, s37, 1
    s_and_b32 s38, s38, 3
    s_mul_i32 s38, s38, 3072
    s_add_u32 s38, s38, s39
    s_add_u32 s38, s38, 22528
    v_lshl_add_u32 v7, v1, 4, s38
    s_add_u32 s38, s37, 2
    s_and_b32 s38, s38, 3
    s_mul_i32 s38, s38, 3072
    s_add_u32 s38, s38, s39
    s_add_u32 s38, s38, 21504
    v_lshl_add_u32 v8, v1, 4, s38
    s_add_u32 s38, s37, 3
    s_and_b32 s38, s38, 3
    s_mul_i32 s38, s38, 3072
    s_add_u32 s38, s38, s39
    s_add_u32 s38, s38, 20480
    v_lshl_add_u32 v9, v1, 4, s38
    s_waitcnt lgkmcnt(6)
    v_mfma_f32_16x16x32_bf16 v[92:95], v[56:59], v[156:159], v[92:95]
    v_mfma_f32_16x16x32_bf16 v[108:111], v[60:63], v[156:159], v[108:111]
    v_mfma_f32_16x16x32_bf16 v[140:143], v[64:67], v[156:159], v[140:143]
    s_waitcnt lgkmcnt(5)
    v_mfma_f32_16x16x32_bf16 v[96:99], v[56:59], v[160:163], v[96:99]
    v_mfma_f32_16x16x32_bf16 v[112:115], v[60:63], v[160:163], v[112:115]
    v_mfma_f32_16x16x32_bf16 v[144:147], v[64:67], v[160:163], v[144:147]
    s_lshl_b32 s37, s33, 7
    s_lshr_b32 s38, s34, 3
    s_lshl_b32 s38, s38, 6
    s_add_u32 s37, s37, s38
    s_and_b32 s38, s32, 3
    s_lshl_b32 s38, s38, 4
    s_add_u32 s37, s37, s38
    s_mul_i32 s37, s37, 1280
    s_and_b32 s38, s34, 7
    s_mul_i32 s38, s38, 160
    s_add_u32 s37, s37, s38
    s_lshr_b32 s38, s32, 2
    s_mul_i32 s38, s38, 96
    s_add_u32 s37, s37, s38
    v_and_b32 v2, 15, v1
    v_mul_u32_u24 v2, 1280, v2
    v_lshrrev_b32 v3, 4, v1
    v_lshl_add_u32 v2, v3, 3, v2
    v_add_u32 v4, s37, v2
    s_waitcnt lgkmcnt(4)
    v_mfma_f32_16x16x32_bf16 v[100:103], v[56:59], v[164:167], v[100:103]
    v_mfma_f32_16x16x32_bf16 v[116:119], v[60:63], v[164:167], v[116:119]
    v_mfma_f32_16x16x32_bf16 v[148:151], v[64:67], v[164:167], v[148:151]
    s_waitcnt lgkmcnt(3)
    v_mfma_f32_16x16x32_bf16 v[88:91], v[68:71], v[168:171], v[88:91]
    v_mfma_f32_16x16x32_bf16 v[104:107], v[72:75], v[168:171], v[104:107]
    v_mfma_f32_16x16x32_bf16 v[136:139], v[76:79], v[168:171], v[136:139]
    s_waitcnt lgkmcnt(2)
    v_mfma_f32_16x16x32_bf16 v[92:95], v[68:71], v[172:175], v[92:95]
    v_mfma_f32_16x16x32_bf16 v[108:111], v[72:75], v[172:175], v[108:111]
    v_mfma_f32_16x16x32_bf16 v[140:143], v[76:79], v[172:175], v[140:143]
    s_waitcnt lgkmcnt(1)
    v_mfma_f32_16x16x32_bf16 v[96:99], v[68:71], v[120:123], v[96:99]
    v_mfma_f32_16x16x32_bf16 v[112:115], v[72:75], v[120:123], v[112:115]
    v_mfma_f32_16x16x32_bf16 v[144:147], v[76:79], v[120:123], v[144:147]
    s_waitcnt lgkmcnt(0)
    v_mfma_f32_16x16x32_bf16 v[100:103], v[68:71], v[124:127], v[100:103]
    v_mfma_f32_16x16x32_bf16 v[116:119], v[72:75], v[124:127], v[116:119]
    v_mfma_f32_16x16x32_bf16 v[148:151], v[76:79], v[124:127], v[148:151]
    s_waitcnt vmcnt(0)
    s_waitcnt lgkmcnt(0)
    s_barrier
    s_and_b32 s37, s32, 3
    s_cmp_eq_u32 s37, 3
    s_cbranch_scc1 Lp5s0
    ds_read_b128 v[156:159], v129 offset:0
    ds_read_b128 v[172:175], v129 offset:2048
    ds_read_b128 v[160:163], v130 offset:0
    ds_read_b128 v[120:123], v130 offset:2048
    ds_read_b128 v[164:167], v131 offset:0
    ds_read_b128 v[124:127], v131 offset:2048
    ds_read_b128 v[152:155], v128 offset:0
    ds_read_b128 v[168:171], v128 offset:2048
    s_waitcnt lgkmcnt(7)
    v_mfma_f32_16x16x32_bf16 v[92:95], v[80:83], v[156:159], v[92:95]
    v_mfma_f32_16x16x32_bf16 v[108:111], v[84:87], v[156:159], v[108:111]
    v_mfma_f32_16x16x32_bf16 v[140:143], v[176:179], v[156:159], v[140:143]
    s_waitcnt lgkmcnt(6)
    v_mfma_f32_16x16x32_bf16 v[92:95], v[180:183], v[172:175], v[92:95]
    v_mfma_f32_16x16x32_bf16 v[108:111], v[184:187], v[172:175], v[108:111]
    v_mfma_f32_16x16x32_bf16 v[140:143], v[188:191], v[172:175], v[140:143]
    s_waitcnt lgkmcnt(5)
    v_mfma_f32_16x16x32_bf16 v[96:99], v[80:83], v[160:163], v[96:99]
    v_mfma_f32_16x16x32_bf16 v[112:115], v[84:87], v[160:163], v[112:115]
    v_mfma_f32_16x16x32_bf16 v[144:147], v[176:179], v[160:163], v[144:147]
    s_waitcnt lgkmcnt(4)
    v_mfma_f32_16x16x32_bf16 v[96:99], v[180:183], v[120:123], v[96:99]
    v_mfma_f32_16x16x32_bf16 v[112:115], v[184:187], v[120:123], v[112:115]
    v_mfma_f32_16x16x32_bf16 v[144:147], v[188:191], v[120:123], v[144:147]
    ds_write_b128 v7, v[92:95] offset:0
    ds_write_b128 v7, v[108:111] offset:12288
    ds_write_b128 v7, v[140:143] offset:24576
    s_waitcnt lgkmcnt(6)
    v_mfma_f32_16x16x32_bf16 v[100:103], v[80:83], v[164:167], v[100:103]
    v_mfma_f32_16x16x32_bf16 v[116:119], v[84:87], v[164:167], v[116:119]
    v_mfma_f32_16x16x32_bf16 v[148:151], v[176:179], v[164:167], v[148:151]
    s_waitcnt lgkmcnt(5)
    v_mfma_f32_16x16x32_bf16 v[100:103], v[180:183], v[124:127], v[100:103]
    v_mfma_f32_16x16x32_bf16 v[116:119], v[184:187], v[124:127], v[116:119]
    v_mfma_f32_16x16x32_bf16 v[148:151], v[188:191], v[124:127], v[148:151]
    ds_write_b128 v8, v[96:99] offset:0
    ds_write_b128 v8, v[112:115] offset:12288
    ds_write_b128 v8, v[144:147] offset:24576
    s_waitcnt lgkmcnt(7)
    v_mfma_f32_16x16x32_bf16 v[88:91], v[80:83], v[152:155], v[88:91]
    v_mfma_f32_16x16x32_bf16 v[104:107], v[84:87], v[152:155], v[104:107]
    v_mfma_f32_16x16x32_bf16 v[136:139], v[176:179], v[152:155], v[136:139]
    s_waitcnt lgkmcnt(6)
    v_mfma_f32_16x16x32_bf16 v[88:91], v[180:183], v[168:171], v[88:91]
    v_mfma_f32_16x16x32_bf16 v[104:107], v[184:187], v[168:171], v[104:107]
    v_mfma_f32_16x16x32_bf16 v[136:139], v[188:191], v[168:171], v[136:139]
    ds_write_b128 v9, v[100:103] offset:0
    ds_write_b128 v9, v[116:119] offset:12288
    ds_write_b128 v9, v[148:151] offset:24576
    s_branch Lp5t0
Lp5s0:
    s_nop 4
    ds_write_b128 v7, v[92:95] offset:0
    ds_write_b128 v7, v[108:111] offset:12288
    ds_write_b128 v7, v[140:143] offset:24576
    ds_write_b128 v8, v[96:99] offset:0
    ds_write_b128 v8, v[112:115] offset:12288
    ds_write_b128 v8, v[144:147] offset:24576
    ds_write_b128 v9, v[100:103] offset:0
    ds_write_b128 v9, v[116:119] offset:12288
    ds_write_b128 v9, v[148:151] offset:24576
Lp5t0:
    v_lshrrev_b32 v2, 4, v1
    v_lshlrev_b32 v3, 4, v2
    s_waitcnt vmcnt(0)
    ds_read_b128 v[176:179], v3 offset:2880
    ds_read_b128 v[180:183], v3 offset:2944
    ds_read_b128 v[184:187], v3 offset:3008
    s_waitcnt lgkmcnt(0)
    s_barrier
    ds_read_b128 v[152:155], v6 offset:0
    ds_read_b128 v[156:159], v6 offset:1024
    ds_read_b128 v[160:163], v6 offset:2048
    ds_read_b128 v[164:167], v6 offset:12288
    ds_read_b128 v[168:171], v6 offset:13312
    ds_read_b128 v[172:175], v6 offset:14336
    ds_read_b128 v[120:123], v6 offset:24576
    ds_read_b128 v[124:127], v6 offset:25600
    ds_read_b128 v[92:95], v6 offset:26624
    s_waitcnt lgkmcnt(6)
    v_add_f32 v152, v152, v156
    v_add_f32 v88, v88, v160
    v_add_f32 v88, v88, v152
    v_add_f32 v153, v153, v157
    v_add_f32 v89, v89, v161
    v_add_f32 v89, v89, v153
    v_add_f32 v154, v154, v158
    v_add_f32 v90, v90, v162
    v_add_f32 v90, v90, v154
    v_add_f32 v155, v155, v159
    v_add_f32 v91, v91, v163
    v_add_f32 v91, v91, v155
    v_lshlrev_b32 v2, 16, v10
    v_and_b32 v3, 0xffff0000, v10
    v_fmac_f32 v2, v176, v88
    v_fmac_f32 v3, v177, v89
    v_cvt_pk_bf16_f32 v10, v2, v3
    v_lshlrev_b32 v2, 16, v11
    v_and_b32 v3, 0xffff0000, v11
    v_fmac_f32 v2, v178, v90
    v_fmac_f32 v3, v179, v91
    v_cvt_pk_bf16_f32 v11, v2, v3
    global_store_dwordx2 v4, v[10:11], s[22:23] offset:0
    s_waitcnt lgkmcnt(3)
    v_add_f32 v164, v164, v168
    v_add_f32 v104, v104, v172
    v_add_f32 v104, v104, v164
    v_add_f32 v165, v165, v169
    v_add_f32 v105, v105, v173
    v_add_f32 v105, v105, v165
    v_add_f32 v166, v166, v170
    v_add_f32 v106, v106, v174
    v_add_f32 v106, v106, v166
    v_add_f32 v167, v167, v171
    v_add_f32 v107, v107, v175
    v_add_f32 v107, v107, v167
    v_lshlrev_b32 v2, 16, v12
    v_and_b32 v3, 0xffff0000, v12
    v_fmac_f32 v2, v180, v104
    v_fmac_f32 v3, v181, v105
    v_cvt_pk_bf16_f32 v12, v2, v3
    v_lshlrev_b32 v2, 16, v13
    v_and_b32 v3, 0xffff0000, v13
    v_fmac_f32 v2, v182, v106
    v_fmac_f32 v3, v183, v107
    v_cvt_pk_bf16_f32 v13, v2, v3
    global_store_dwordx2 v4, v[12:13], s[22:23] offset:32
    s_waitcnt lgkmcnt(0)
    v_add_f32 v120, v120, v124
    v_add_f32 v136, v136, v92
    v_add_f32 v136, v136, v120
    v_add_f32 v121, v121, v125
    v_add_f32 v137, v137, v93
    v_add_f32 v137, v137, v121
    v_add_f32 v122, v122, v126
    v_add_f32 v138, v138, v94
    v_add_f32 v138, v138, v122
    v_add_f32 v123, v123, v127
    v_add_f32 v139, v139, v95
    v_add_f32 v139, v139, v123
    v_lshlrev_b32 v2, 16, v14
    v_and_b32 v3, 0xffff0000, v14
    v_fmac_f32 v2, v184, v136
    v_fmac_f32 v3, v185, v137
    v_cvt_pk_bf16_f32 v14, v2, v3
    v_lshlrev_b32 v2, 16, v15
    v_and_b32 v3, 0xffff0000, v15
    v_fmac_f32 v2, v186, v138
    v_fmac_f32 v3, v187, v139
    v_cvt_pk_bf16_f32 v15, v2, v3
    global_store_dwordx2 v4, v[14:15], s[22:23] offset:64
    s_branch Lp5e
Lp5b:
    ds_read_b128 v[152:155], v128 offset:0
    ds_read_b128 v[156:159], v129 offset:0
    ds_read_b128 v[160:163], v130 offset:0
    ds_read_b128 v[164:167], v131 offset:0
    ds_read_b128 v[168:171], v128 offset:2048
    ds_read_b128 v[172:175], v129 offset:2048
    ds_read_b128 v[120:123], v130 offset:2048
    ds_read_b128 v[124:127], v131 offset:2048
    s_add_u32 s39, s64, 0x8000
    s_lshl_b32 s38, s32, 12
    s_add_u32 m0, s38, 94208
    s_nop 0
    buffer_load_dwordx4 v135, s[28:31], s39 offen offset:0 sc1 lds
    buffer_load_dwordx4 v135, s[28:31], s39 offen offset:1024 sc1 lds
    buffer_load_dwordx4 v135, s[28:31], s39 offen offset:2048 sc1 lds
    buffer_load_dwordx4 v135, s[28:31], s39 offen offset:3072 sc1 lds
    s_waitcnt lgkmcnt(7)
    v_mfma_f32_16x16x32_bf16 v[88:91], v[176:179], v[152:155], 0
    v_mfma_f32_16x16x32_bf16 v[104:107], v[180:183], v[152:155], 0
    s_waitcnt lgkmcnt(6)
    v_mfma_f32_16x16x32_bf16 v[92:95], v[176:179], v[156:159], 0
    v_mfma_f32_16x16x32_bf16 v[108:111], v[180:183], v[156:159], 0
    s_waitcnt lgkmcnt(5)
    v_mfma_f32_16x16x32_bf16 v[96:99], v[176:179], v[160:163], 0
    v_mfma_f32_16x16x32_bf16 v[112:115], v[180:183], v[160:163], 0
    s_waitcnt lgkmcnt(4)
    v_mfma_f32_16x16x32_bf16 v[100:103], v[176:179], v[164:167], 0
    v_mfma_f32_16x16x32_bf16 v[116:119], v[180:183], v[164:167], 0
    s_waitcnt lgkmcnt(3)
    v_mfma_f32_16x16x32_bf16 v[88:91], v[184:187], v[168:171], v[88:91]
    v_mfma_f32_16x16x32_bf16 v[104:107], v[188:191], v[168:171], v[104:107]
    s_waitcnt lgkmcnt(2)
    v_mfma_f32_16x16x32_bf16 v[92:95], v[184:187], v[172:175], v[92:95]
    v_mfma_f32_16x16x32_bf16 v[108:111], v[188:191], v[172:175], v[108:111]
    s_waitcnt lgkmcnt(1)
    v_mfma_f32_16x16x32_bf16 v[96:99], v[184:187], v[120:123], v[96:99]
    v_mfma_f32_16x16x32_bf16 v[112:115], v[188:191], v[120:123], v[112:115]
    s_waitcnt lgkmcnt(0)
    v_mfma_f32_16x16x32_bf16 v[100:103], v[184:187], v[124:127], v[100:103]
    v_mfma_f32_16x16x32_bf16 v[116:119], v[188:191], v[124:127], v[116:119]
    s_waitcnt vmcnt(12)
    v_mov_b32 v2, 1
    v_mov_b32 v3, 3604
    s_waitcnt lgkmcnt(0)
    s_mov_b64 exec, 1
    ds_add_rtn_u32 v2, v3, v2
    s_waitcnt lgkmcnt(0)
    s_mov_b64 exec, -1
    v_readfirstlane_b32 s40, v2
    s_cmp_lg_u32 s40, 7
    s_cbranch_scc1 Lp71
    s_add_u32 s41, s35, 7
    s_mul_i32 s37, s36, 128
    s_add_u32 s37, s37, 196608
    v_mov_b32 v2, s41
    v_mov_b32 v3, 0
    s_mov_b64 s[44:45], exec
    s_mov_b64 exec, 1
    buffer_store_dword v2, v3, s[28:31], s37 offen sc1
    s_mov_b64 exec, s[44:45]
Lp71:
    s_cmp_lg_u32 s32, 7
    s_cbranch_scc1 Lac_30
    s_waitcnt vmcnt(12)
    v_subrev_u32 v133, s35, v133
    v_subrev_u32 v133, 4, v133
    v_cmp_lt_u32 vcc, 3, v133
    s_cbranch_vccz Lac_30
    s_mov_b32 s46, 30000
Lpa_31:
    buffer_load_dword v133, v132, s[28:31], 0 offen sc1
    s_waitcnt vmcnt(0)
    v_subrev_u32 v133, s35, v133
    v_subrev_u32 v133, 4, v133
    v_cmp_lt_u32 vcc, 3, v133
    s_cbranch_vccz Lpea_32
    s_sub_u32 s46, s46, 1
    s_cmp_gt_i32 s46, 0
    s_cbranch_scc1 Lpa_31
Lpea_32:
Lac_30:
    s_waitcnt lgkmcnt(0)
    s_barrier
    ds_read_b128 v[152:155], v128 offset:40960
    ds_read_b128 v[156:159], v129 offset:40960
    ds_read_b128 v[160:163], v130 offset:40960
    ds_read_b128 v[164:167], v131 offset:40960
    ds_read_b128 v[168:171], v128 offset:43008
    ds_read_b128 v[172:175], v129 offset:43008
    ds_read_b128 v[120:123], v130 offset:43008
    ds_read_b128 v[124:127], v131 offset:43008
    v_add_u32 v128, 0x12000, v128
    v_add_u32 v129, 0x12000, v129
    v_add_u32 v130, 0x12000, v130
    v_add_u32 v131, 0x12000, v131
    s_cmp_lg_u32 s32, 7
    s_cbranch_scc1 Lai_33
    v_and_b32 v132, 15, v1
    s_lshl_b32 s37, s33, 11
    s_add_u32 s37, s37, 0x30000
    v_lshl_add_u32 v132, v132, 7, s37
    buffer_load_dword v133, v132, s[28:31], 0 offen sc1
Lai_33:
    s_add_u32 s39, s64, 0xc000
    s_lshl_b32 s38, s32, 12
    s_add_u32 m0, s38, 126976
    s_nop 0
    buffer_load_dwordx4 v135, s[28:31], s39 offen offset:0 sc1 lds
    buffer_load_dwordx4 v135, s[28:31], s39 offen offset:1024 sc1 lds
    buffer_load_dwordx4 v135, s[28:31], s39 offen offset:2048 sc1 lds
    buffer_load_dwordx4 v135, s[28:31], s39 offen offset:3072 sc1 lds
    s_waitcnt lgkmcnt(7)
    v_mfma_f32_16x16x32_bf16 v[88:91], v[192:195], v[152:155], v[88:91]
    v_mfma_f32_16x16x32_bf16 v[104:107], v[196:199], v[152:155], v[104:107]
    s_waitcnt lgkmcnt(6)
    v_mfma_f32_16x16x32_bf16 v[92:95], v[192:195], v[156:159], v[92:95]
    v_mfma_f32_16x16x32_bf16 v[108:111], v[196:199], v[156:159], v[108:111]
    s_waitcnt lgkmcnt(5)
    v_mfma_f32_16x16x32_bf16 v[96:99], v[192:195], v[160:163], v[96:99]
    v_mfma_f32_16x16x32_bf16 v[112:115], v[196:199], v[160:163], v[112:115]
    s_waitcnt lgkmcnt(4)
    v_mfma_f32_16x16x32_bf16 v[100:103], v[192:195], v[164:167], v[100:103]
    v_mfma_f32_16x16x32_bf16 v[116:119], v[196:199], v[164:167], v[116:119]
    s_waitcnt lgkmcnt(3)
    v_mfma_f32_16x16x32_bf16 v[88:91], v[200:203], v[168:171], v[88:91]
    v_mfma_f32_16x16x32_bf16 v[104:107], v[204:207], v[168:171], v[104:107]
    s_waitcnt lgkmcnt(2)
    v_mfma_f32_16x16x32_bf16 v[92:95], v[200:203], v[172:175], v[92:95]
    v_mfma_f32_16x16x32_bf16 v[108:111], v[204:207], v[172:175], v[108:111]
    s_waitcnt lgkmcnt(1)
    v_mfma_f32_16x16x32_bf16 v[96:99], v[200:203], v[120:123], v[96:99]
    v_mfma_f32_16x16x32_bf16 v[112:115], v[204:207], v[120:123], v[112:115]
    s_waitcnt lgkmcnt(0)
    v_mfma_f32_16x16x32_bf16 v[100:103], v[200:203], v[124:127], v[100:103]
    v_mfma_f32_16x16x32_bf16 v[116:119], v[204:207], v[124:127], v[116:119]
    s_cmp_lg_u32 s32, 7
    s_cbranch_scc1 Lac_34
    s_waitcnt vmcnt(4)
    v_subrev_u32 v133, s35, v133
    v_subrev_u32 v133, 5, v133
    v_cmp_lt_u32 vcc, 2, v133
    s_cbranch_vccz Lac_34
    s_mov_b32 s46, 30000
Lpa_35:
    buffer_load_dword v133, v132, s[28:31], 0 offen sc1
    s_waitcnt vmcnt(0)
    v_subrev_u32 v133, s35, v133
    v_subrev_u32 v133, 5, v133
    v_cmp_lt_u32 vcc, 2, v133
    s_cbranch_vccz Lpea_36
    s_sub_u32 s46, s46, 1
    s_cmp_gt_i32 s46, 0
    s_cbranch_scc1 Lpa_35
Lpea_36:
Lac_34:
    s_waitcnt vmcnt(4)
    s_waitcnt lgkmcnt(0)
    s_barrier
    ds_read_b128 v[152:155], v128 offset:0
    ds_read_b128 v[156:159], v129 offset:0
    ds_read_b128 v[160:163], v130 offset:0
    ds_read_b128 v[164:167], v131 offset:0
    ds_read_b128 v[168:171], v128 offset:2048
    ds_read_b128 v[172:175], v129 offset:2048
    ds_read_b128 v[120:123], v130 offset:2048
    ds_read_b128 v[124:127], v131 offset:2048
    s_add_u32 s39, s64, 0x10000
    s_lshl_b32 s38, s32, 12
    s_add_u32 m0, s38, 20480
    s_nop 0
    buffer_load_dwordx4 v135, s[28:31], s39 offen offset:0 sc1 lds
    buffer_load_dwordx4 v135, s[28:31], s39 offen offset:1024 sc1 lds
    buffer_load_dwordx4 v135, s[28:31], s39 offen offset:2048 sc1 lds
    buffer_load_dwordx4 v135, s[28:31], s39 offen offset:3072 sc1 lds
    s_waitcnt lgkmcnt(7)
    v_mfma_f32_16x16x32_bf16 v[88:91], v[208:211], v[152:155], v[88:91]
    v_mfma_f32_16x16x32_bf16 v[104:107], v[212:215], v[152:155], v[104:107]
    s_waitcnt lgkmcnt(6)
    v_mfma_f32_16x16x32_bf16 v[92:95], v[208:211], v[156:159], v[92:95]
    v_mfma_f32_16x16x32_bf16 v[108:111], v[212:215], v[156:159], v[108:111]
    s_waitcnt lgkmcnt(5)
    v_mfma_f32_16x16x32_bf16 v[96:99], v[208:211], v[160:163], v[96:99]
    v_mfma_f32_16x16x32_bf16 v[112:115], v[212:215], v[160:163], v[112:115]
    s_waitcnt lgkmcnt(4)
    v_mfma_f32_16x16x32_bf16 v[100:103], v[208:211], v[164:167], v[100:103]
    v_mfma_f32_16x16x32_bf16 v[116:119], v[212:215], v[164:167], v[116:119]
    s_waitcnt lgkmcnt(3)
    v_mfma_f32_16x16x32_bf16 v[88:91], v[216:219], v[168:171], v[88:91]
    v_mfma_f32_16x16x32_bf16 v[104:107], v[220:223], v[168:171], v[104:107]
    s_waitcnt lgkmcnt(2)
    v_mfma_f32_16x16x32_bf16 v[92:95], v[216:219], v[172:175], v[92:95]
    v_mfma_f32_16x16x32_bf16 v[108:111], v[220:223], v[172:175], v[108:111]
    s_waitcnt lgkmcnt(1)
    v_mfma_f32_16x16x32_bf16 v[96:99], v[216:219], v[120:123], v[96:99]
    v_mfma_f32_16x16x32_bf16 v[112:115], v[220:223], v[120:123], v[112:115]
    s_waitcnt lgkmcnt(0)
    v_mfma_f32_16x16x32_bf16 v[100:103], v[216:219], v[124:127], v[100:103]
    v_mfma_f32_16x16x32_bf16 v[116:119], v[220:223], v[124:127], v[116:119]
    s_waitcnt vmcnt(4)
    s_waitcnt lgkmcnt(0)
    s_barrier
    ds_read_b128 v[152:155], v128 offset:32768
    ds_read_b128 v[156:159], v129 offset:32768
    ds_read_b128 v[160:163], v130 offset:32768
    ds_read_b128 v[164:167], v131 offset:32768
    ds_read_b128 v[168:171], v128 offset:34816
    ds_read_b128 v[172:175], v129 offset:34816
    ds_read_b128 v[120:123], v130 offset:34816
    ds_read_b128 v[124:127], v131 offset:34816
    v_add_u32 v128, 0xfffee000, v128
    v_add_u32 v129, 0xfffee000, v129
    v_add_u32 v130, 0xfffee000, v130
    v_add_u32 v131, 0xfffee000, v131
    s_cmp_lg_u32 s32, 7
    s_cbranch_scc1 Lai_37
    v_and_b32 v132, 15, v1
    s_lshl_b32 s37, s33, 11
    s_add_u32 s37, s37, 0x30000
    v_lshl_add_u32 v132, v132, 7, s37
    buffer_load_dword v133, v132, s[28:31], 0 offen sc1
Lai_37:
    s_waitcnt lgkmcnt(7)
    v_mfma_f32_16x16x32_bf16 v[88:91], v[224:227], v[152:155], v[88:91]
    v_mfma_f32_16x16x32_bf16 v[104:107], v[228:231], v[152:155], v[104:107]
    s_waitcnt lgkmcnt(6)
    v_mfma_f32_16x16x32_bf16 v[92:95], v[224:227], v[156:159], v[92:95]
    v_mfma_f32_16x16x32_bf16 v[108:111], v[228:231], v[156:159], v[108:111]
    s_waitcnt lgkmcnt(5)
    v_mfma_f32_16x16x32_bf16 v[96:99], v[224:227], v[160:163], v[96:99]
    v_mfma_f32_16x16x32_bf16 v[112:115], v[228:231], v[160:163], v[112:115]
    s_waitcnt lgkmcnt(4)
    v_mfma_f32_16x16x32_bf16 v[100:103], v[224:227], v[164:167], v[100:103]
    v_mfma_f32_16x16x32_bf16 v[116:119], v[228:231], v[164:167], v[116:119]
    s_waitcnt lgkmcnt(3)
    v_mfma_f32_16x16x32_bf16 v[88:91], v[232:235], v[168:171], v[88:91]
    v_mfma_f32_16x16x32_bf16 v[104:107], v[236:239], v[168:171], v[104:107]
    s_waitcnt lgkmcnt(2)
    v_mfma_f32_16x16x32_bf16 v[92:95], v[232:235], v[172:175], v[92:95]
    v_mfma_f32_16x16x32_bf16 v[108:111], v[236:239], v[172:175], v[108:111]
    s_waitcnt lgkmcnt(1)
    v_mfma_f32_16x16x32_bf16 v[96:99], v[232:235], v[120:123], v[96:99]
    v_mfma_f32_16x16x32_bf16 v[112:115], v[236:239], v[120:123], v[112:115]
    s_waitcnt lgkmcnt(0)
    v_mfma_f32_16x16x32_bf16 v[100:103], v[232:235], v[124:127], v[100:103]
    v_mfma_f32_16x16x32_bf16 v[116:119], v[236:239], v[124:127], v[116:119]
    s_cmp_lg_u32 s32, 7
    s_cbranch_scc1 Lac_38
    s_waitcnt vmcnt(0)
    v_subrev_u32 v133, s35, v133
    v_subrev_u32 v133, 7, v133
    v_cmp_lt_u32 vcc, 0, v133
    s_cbranch_vccz Lac_38
    s_mov_b32 s46, 30000
Lpa_39:
    buffer_load_dword v133, v132, s[28:31], 0 offen sc1
    s_waitcnt vmcnt(0)
    v_subrev_u32 v133, s35, v133
    v_subrev_u32 v133, 7, v133
    v_cmp_lt_u32 vcc, 0, v133
    s_cbranch_vccz Lpea_40
    s_sub_u32 s46, s46, 1
    s_cmp_gt_i32 s46, 0
    s_cbranch_scc1 Lpa_39
Lpea_40:
Lac_38:
    s_waitcnt vmcnt(0)
    s_waitcnt lgkmcnt(0)
    s_barrier
    ds_read_b128 v[152:155], v128 offset:0
    ds_read_b128 v[156:159], v129 offset:0
    ds_read_b128 v[160:163], v130 offset:0
    ds_read_b128 v[164:167], v131 offset:0
    ds_read_b128 v[168:171], v128 offset:2048
    ds_read_b128 v[172:175], v129 offset:2048
    ds_read_b128 v[120:123], v130 offset:2048
    ds_read_b128 v[124:127], v131 offset:2048
    s_add_u32 s39, s64, 0x14000
    s_lshl_b32 s38, s32, 12
    s_add_u32 m0, s38, 61440
    s_nop 0
    buffer_load_dwordx4 v135, s[28:31], s39 offen offset:0 sc1 lds
    buffer_load_dwordx4 v135, s[28:31], s39 offen offset:1024 sc1 lds
    buffer_load_dwordx4 v135, s[28:31], s39 offen offset:2048 sc1 lds
    buffer_load_dwordx4 v135, s[28:31], s39 offen offset:3072 sc1 lds
    s_add_u32 s39, s64, 0x18000
    s_lshl_b32 s38, s32, 12
    s_add_u32 m0, s38, 94208
    s_nop 0
    buffer_load_dwordx4 v135, s[28:31], s39 offen offset:0 sc1 lds
    buffer_load_dwordx4 v135, s[28:31], s39 offen offset:1024 sc1 lds
    buffer_load_dwordx4 v135, s[28:31], s39 offen offset:2048 sc1 lds
    buffer_load_dwordx4 v135, s[28:31], s39 offen offset:3072 sc1 lds
    s_waitcnt lgkmcnt(7)
    v_mfma_f32_16x16x32_bf16 v[88:91], v[240:243], v[152:155], v[88:91]
    v_mfma_f32_16x16x32_bf16 v[104:107], v[244:247], v[152:155], v[104:107]
    s_waitcnt lgkmcnt(6)
    v_mfma_f32_16x16x32_bf16 v[92:95], v[240:243], v[156:159], v[92:95]
    v_mfma_f32_16x16x32_bf16 v[108:111], v[244:247], v[156:159], v[108:111]
    s_waitcnt lgkmcnt(5)
    v_mfma_f32_16x16x32_bf16 v[96:99], v[240:243], v[160:163], v[96:99]
    v_mfma_f32_16x16x32_bf16 v[112:115], v[244:247], v[160:163], v[112:115]
    s_waitcnt lgkmcnt(4)
    v_mfma_f32_16x16x32_bf16 v[100:103], v[240:243], v[164:167], v[100:103]
    v_mfma_f32_16x16x32_bf16 v[116:119], v[244:247], v[164:167], v[116:119]
    s_waitcnt lgkmcnt(3)
    v_mfma_f32_16x16x32_bf16 v[88:91], v[248:251], v[168:171], v[88:91]
    v_mfma_f32_16x16x32_bf16 v[104:107], v[252:255], v[168:171], v[104:107]
    s_waitcnt lgkmcnt(2)
    v_mfma_f32_16x16x32_bf16 v[92:95], v[248:251], v[172:175], v[92:95]
    v_mfma_f32_16x16x32_bf16 v[108:111], v[252:255], v[172:175], v[108:111]
    s_waitcnt lgkmcnt(1)
    v_mfma_f32_16x16x32_bf16 v[96:99], v[248:251], v[120:123], v[96:99]
    v_mfma_f32_16x16x32_bf16 v[112:115], v[252:255], v[120:123], v[112:115]
    s_waitcnt lgkmcnt(0)
    v_mfma_f32_16x16x32_bf16 v[100:103], v[248:251], v[124:127], v[100:103]
    v_mfma_f32_16x16x32_bf16 v[116:119], v[252:255], v[124:127], v[116:119]
    s_waitcnt vmcnt(4)
    s_waitcnt lgkmcnt(0)
    s_barrier
    ds_read_b128 v[152:155], v128 offset:40960
    ds_read_b128 v[156:159], v129 offset:40960
    ds_read_b128 v[160:163], v130 offset:40960
    ds_read_b128 v[164:167], v131 offset:40960
    ds_read_b128 v[168:171], v128 offset:43008
    ds_read_b128 v[172:175], v129 offset:43008
    ds_read_b128 v[120:123], v130 offset:43008
    ds_read_b128 v[124:127], v131 offset:43008
    v_add_u32 v128, 0x12000, v128
    v_add_u32 v129, 0x12000, v129
    v_add_u32 v130, 0x12000, v130
    v_add_u32 v131, 0x12000, v131
    s_waitcnt lgkmcnt(7)
    v_mfma_f32_16x16x32_bf16 v[88:91], v[16:19], v[152:155], v[88:91]
    v_mfma_f32_16x16x32_bf16 v[104:107], v[20:23], v[152:155], v[104:107]
    s_and_b32 s37, s32, 3
    s_lshr_b32 s39, s32, 2
    s_mul_i32 s39, s39, 36864
    s_add_u32 s38, s37, 0
    s_and_b32 s38, s38, 3
    s_mul_i32 s38, s38, 3072
    s_add_u32 s38, s38, s39
    s_add_u32 s38, s38, 20480
    v_lshl_add_u32 v6, v1, 4, s38
    s_add_u32 s38, s37, 1
    s_and_b32 s38, s38, 3
    s_mul_i32 s38, s38, 3072
    s_add_u32 s38, s38, s39
    s_add_u32 s38, s38, 22528
    v_lshl_add_u32 v7, v1, 4, s38
    s_add_u32 s38, s37, 2
    s_and_b32 s38, s38, 3
    s_mul_i32 s38, s38, 3072
    s_add_u32 s38, s38, s39
    s_add_u32 s38, s38, 21504
    v_lshl_add_u32 v8, v1, 4, s38
    s_add_u32 s38, s37, 3
    s_and_b32 s38, s38, 3
    s_mul_i32 s38, s38, 3072
    s_add_u32 s38, s38, s39
    s_add_u32 s38, s38, 20480
    v_lshl_add_u32 v9, v1, 4, s38
    s_waitcnt lgkmcnt(6)
    v_mfma_f32_16x16x32_bf16 v[92:95], v[16:19], v[156:159], v[92:95]
    v_mfma_f32_16x16x32_bf16 v[108:111], v[20:23], v[156:159], v[108:111]
    s_waitcnt lgkmcnt(5)
    v_mfma_f32_16x16x32_bf16 v[96:99], v[16:19], v[160:163], v[96:99]
    v_mfma_f32_16x16x32_bf16 v[112:115], v[20:23], v[160:163], v[112:115]
    s_lshl_b32 s37, s33, 7
    s_lshr_b32 s38, s34, 3
    s_lshl_b32 s38, s38, 6
    s_add_u32 s37, s37, s38
    s_and_b32 s38, s32, 3
    s_lshl_b32 s38, s38, 4
    s_add_u32 s37, s37, s38
    s_mul_i32 s37, s37, 1280
    s_and_b32 s38, s34, 7
    s_mul_i32 s38, s38, 160
    s_add_u32 s37, s37, s38
    s_lshr_b32 s38, s32, 2
    s_mul_i32 s38, s38, 96
    s_add_u32 s37, s37, s38
    v_and_b32 v2, 15, v1
    v_mul_u32_u24 v2, 1280, v2
    v_lshrrev_b32 v3, 4, v1
    v_lshl_add_u32 v2, v3, 3, v2
    v_add_u32 v4, s37, v2
    s_waitcnt lgkmcnt(4)
    v_mfma_f32_16x16x32_bf16 v[100:103], v[16:19], v[164:167], v[100:103]
    v_mfma_f32_16x16x32_bf16 v[116:119], v[20:23], v[164:167], v[116:119]
    s_waitcnt lgkmcnt(3)
    v_mfma_f32_16x16x32_bf16 v[88:91], v[24:27], v[168:171], v[88:91]
    v_mfma_f32_16x16x32_bf16 v[104:107], v[28:31], v[168:171], v[104:107]
    s_waitcnt lgkmcnt(2)
    v_mfma_f32_16x16x32_bf16 v[92:95], v[24:27], v[172:175], v[92:95]
    v_mfma_f32_16x16x32_bf16 v[108:111], v[28:31], v[172:175], v[108:111]
    s_waitcnt lgkmcnt(1)
    v_mfma_f32_16x16x32_bf16 v[96:99], v[24:27], v[120:123], v[96:99]
    v_mfma_f32_16x16x32_bf16 v[112:115], v[28:31], v[120:123], v[112:115]
    s_waitcnt lgkmcnt(0)
    v_mfma_f32_16x16x32_bf16 v[100:103], v[24:27], v[124:127], v[100:103]
    v_mfma_f32_16x16x32_bf16 v[116:119], v[28:31], v[124:127], v[116:119]
    s_waitcnt vmcnt(0)
    s_waitcnt lgkmcnt(0)
    s_barrier
    s_and_b32 s37, s32, 3
    s_cmp_eq_u32 s37, 3
    s_cbranch_scc1 Lp5s1
    ds_read_b128 v[156:159], v129 offset:0
    ds_read_b128 v[172:175], v129 offset:2048
    ds_read_b128 v[160:163], v130 offset:0
    ds_read_b128 v[120:123], v130 offset:2048
    ds_read_b128 v[164:167], v131 offset:0
    ds_read_b128 v[124:127], v131 offset:2048
    ds_read_b128 v[152:155], v128 offset:0
    ds_read_b128 v[168:171], v128 offset:2048
    s_waitcnt lgkmcnt(7)
    v_mfma_f32_16x16x32_bf16 v[92:95], v[32:35], v[156:159], v[92:95]
    v_mfma_f32_16x16x32_bf16 v[108:111], v[36:39], v[156:159], v[108:111]
    s_waitcnt lgkmcnt(6)
    v_mfma_f32_16x16x32_bf16 v[92:95], v[40:43], v[172:175], v[92:95]
    v_mfma_f32_16x16x32_bf16 v[108:111], v[44:47], v[172:175], v[108:111]
    s_waitcnt lgkmcnt(5)
    v_mfma_f32_16x16x32_bf16 v[96:99], v[32:35], v[160:163], v[96:99]
    v_mfma_f32_16x16x32_bf16 v[112:115], v[36:39], v[160:163], v[112:115]
    s_waitcnt lgkmcnt(4)
    v_mfma_f32_16x16x32_bf16 v[96:99], v[40:43], v[120:123], v[96:99]
    v_mfma_f32_16x16x32_bf16 v[112:115], v[44:47], v[120:123], v[112:115]
    s_nop 1
    ds_write_b128 v7, v[92:95] offset:0
    ds_write_b128 v7, v[108:111] offset:12288
    s_waitcnt lgkmcnt(5)
    v_mfma_f32_16x16x32_bf16 v[100:103], v[32:35], v[164:167], v[100:103]
    v_mfma_f32_16x16x32_bf16 v[116:119], v[36:39], v[164:167], v[116:119]
    s_waitcnt lgkmcnt(4)
    v_mfma_f32_16x16x32_bf16 v[100:103], v[40:43], v[124:127], v[100:103]
    v_mfma_f32_16x16x32_bf16 v[116:119], v[44:47], v[124:127], v[116:119]
    s_nop 1
    ds_write_b128 v8, v[96:99] offset:0
    ds_write_b128 v8, v[112:115] offset:12288
    s_waitcnt lgkmcnt(5)
    v_mfma_f32_16x16x32_bf16 v[88:91], v[32:35], v[152:155], v[88:91]
    v_mfma_f32_16x16x32_bf16 v[104:107], v[36:39], v[152:155], v[104:107]
    s_waitcnt lgkmcnt(4)
    v_mfma_f32_16x16x32_bf16 v[88:91], v[40:43], v[168:171], v[88:91]
    v_mfma_f32_16x16x32_bf16 v[104:107], v[44:47], v[168:171], v[104:107]
    s_nop 1
    ds_write_b128 v9, v[100:103] offset:0
    ds_write_b128 v9, v[116:119] offset:12288
    s_branch Lp5t1
Lp5s1:
    s_nop 4
    ds_write_b128 v7, v[92:95] offset:0
    ds_write_b128 v7, v[108:111] offset:12288
    ds_write_b128 v8, v[96:99] offset:0
    ds_write_b128 v8, v[112:115] offset:12288
    ds_write_b128 v9, v[100:103] offset:0
    ds_write_b128 v9, v[116:119] offset:12288
Lp5t1:
    v_lshrrev_b32 v2, 4, v1
    v_lshlrev_b32 v3, 4, v2
    s_waitcnt vmcnt(0)
    ds_read_b128 v[176:179], v3 offset:3072
    ds_read_b128 v[180:183], v3 offset:3136
    s_waitcnt lgkmcnt(0)
    s_barrier
    ds_read_b128 v[152:155], v6 offset:0
    ds_read_b128 v[156:159], v6 offset:1024
    ds_read_b128 v[160:163], v6 offset:2048
    ds_read_b128 v[164:167], v6 offset:12288
    ds_read_b128 v[168:171], v6 offset:13312
    ds_read_b128 v[172:175], v6 offset:14336
    s_waitcnt lgkmcnt(3)
    v_add_f32 v152, v152, v156
    v_add_f32 v88, v88, v160
    v_add_f32 v88, v88, v152
    v_add_f32 v153, v153, v157
    v_add_f32 v89, v89, v161
    v_add_f32 v89, v89, v153
    v_add_f32 v154, v154, v158
    v_add_f32 v90, v90, v162
    v_add_f32 v90, v90, v154
    v_add_f32 v155, v155, v159
    v_add_f32 v91, v91, v163
    v_add_f32 v91, v91, v155
    v_lshlrev_b32 v2, 16, v10
    v_and_b32 v3, 0xffff0000, v10
    v_fmac_f32 v2, v176, v88
    v_fmac_f32 v3, v177, v89
    v_cvt_pk_bf16_f32 v10, v2, v3
    v_lshlrev_b32 v2, 16, v11
    v_and_b32 v3, 0xffff0000, v11
    v_fmac_f32 v2, v178, v90
    v_fmac_f32 v3, v179, v91
    v_cvt_pk_bf16_f32 v11, v2, v3
    global_store_dwordx2 v4, v[10:11], s[22:23] offset:0
    s_waitcnt lgkmcnt(0)
    v_add_f32 v164, v164, v168
    v_add_f32 v104, v104, v172
    v_add_f32 v104, v104, v164
    v_add_f32 v165, v165, v169
    v_add_f32 v105, v105, v173
    v_add_f32 v105, v105, v165
    v_add_f32 v166, v166, v170
    v_add_f32 v106, v106, v174
    v_add_f32 v106, v106, v166
    v_add_f32 v167, v167, v171
    v_add_f32 v107, v107, v175
    v_add_f32 v107, v107, v167
    v_lshlrev_b32 v2, 16, v12
    v_and_b32 v3, 0xffff0000, v12
    v_fmac_f32 v2, v180, v104
    v_fmac_f32 v3, v181, v105
    v_cvt_pk_bf16_f32 v12, v2, v3
    v_lshlrev_b32 v2, 16, v13
    v_and_b32 v3, 0xffff0000, v13
    v_fmac_f32 v2, v182, v106
    v_fmac_f32 v3, v183, v107
    v_cvt_pk_bf16_f32 v13, v2, v3
    global_store_dwordx2 v4, v[12:13], s[22:23] offset:32
Lp5e:
    s_cmp_lg_u32 s2, 0
    s_cbranch_scc1 Lend
    s_cmp_lg_u32 s32, 0
    s_cbranch_scc1 Lend
    s_mov_b32 s38, 0
    s_mul_i32 s37, s38, 0
    s_add_u32 s37, s37, 0
    v_mov_b32 v2, s35
    v_mov_b32 v3, 0
    s_mov_b64 s[44:45], exec
    s_mov_b64 exec, 1
    buffer_store_dword v2, v3, s[28:31], s37 offen sc1
    s_mov_b64 exec, s[44:45]
Lend:
    s_endpgm
Lslow:
    v_lshlrev_b32 v7, 4, v1
    s_lshl_b32 s55, s58, 11
    s_add_u32 s55, s55, s49
    v_add_u32 v4, s55, v7
    s_mul_i32 s55, s58, 3584
    s_add_u32 s55, s55, s49
    s_add_u32 s55, s55, 4096
    v_and_b32 v133, 31, v1
    v_mul_u32_u24 v5, 56, v133
    v_add_u32 v5, 48, v5
    v_add_u32 v5, s55, v5
    v_lshrrev_b32 v133, 5, v1
    v_lshlrev_b32 v133, 2, v133
    v_bfe_u32 v6, v1, 2, 2
    v_add_u32 v133, v133, v6
    v_mul_u32_u24 v6, 56, v133
    v_add_u32 v6, s55, v6
    v_bfe_u32 v133, v1, 4, 1
    v_lshlrev_b32 v133, 2, v133
    v_and_b32 v116, 3, v1
    v_add_u32 v133, v133, v116
    v_min_u32 v133, 5, v133
    v_lshlrev_b32 v133, 3, v133
    v_add_u32 v6, v6, v133
    s_mul_i32 s56, s32, 3072
    s_add_u32 s59, s48, s56
    s_add_u32 s56, s56, 92160
    s_add_u32 s57, s56, 73728
    s_mov_b32 s53, s56
    s_mov_b32 s54, s33
    v_mov_b32 v84, 0
    v_mov_b32 v85, 0
    v_mov_b32 v86, 0
    v_mov_b32 v87, 0
    v_mov_b32 v88, 0
    v_mov_b32 v89, 0
    v_mov_b32 v90, 0
    v_mov_b32 v91, 0
    v_mov_b32 v92, 0
    v_mov_b32 v93, 0
    v_mov_b32 v94, 0
    v_mov_b32 v95, 0
    v_mov_b32 v96, 0
    v_mov_b32 v97, 0
    v_mov_b32 v98, 0
    v_mov_b32 v99, 0
    v_mov_b32 v100, 0
    v_mov_b32 v101, 0
    v_mov_b32 v102, 0
    v_mov_b32 v103, 0
    v_mov_b32 v104, 0
    v_mov_b32 v105, 0
    v_mov_b32 v106, 0
    v_mov_b32 v107, 0
    v_mov_b32 v108, 0
    v_mov_b32 v109, 0
    v_mov_b32 v110, 0
    v_mov_b32 v111, 0
    v_mov_b32 v112, 0
    v_mov_b32 v113, 0
    v_mov_b32 v114, 0
    v_mov_b32 v115, 0
    v_mov_b32 v76, 0
    v_mov_b32 v124, 0
    v_mov_b32 v77, 0
    v_mov_b32 v125, 0
    v_mov_b32 v78, 0
    v_mov_b32 v126, 0
    v_mov_b32 v79, 0
    v_mov_b32 v127, 0
    s_mov_b32 s50, 0
    s_mov_b32 s52, 0
    s_mul_i32 s55, s54, 24576
    s_add_u32 s55, s55, s59
    s_mov_b32 m0, s53
    s_add_u32 s54, s54, 1
    s_and_b32 s54, s54, 15
    s_add_u32 s53, s53, 24576
    s_cmp_ge_u32 s53, s57
    s_cselect_b32 s53, s56, s53
    buffer_load_dwordx4 v7, s[28:31], s55 offen offset:0 sc1 lds
    buffer_load_dwordx4 v7, s[28:31], s55 offen offset:1024 sc1 lds
    buffer_load_dwordx4 v7, s[28:31], s55 offen offset:2048 sc1 lds
    s_mul_i32 s55, s54, 24576
    s_add_u32 s55, s55, s59
    s_mov_b32 m0, s53
    s_add_u32 s54, s54, 1
    s_and_b32 s54, s54, 15
    s_add_u32 s53, s53, 24576
    s_cmp_ge_u32 s53, s57
    s_cselect_b32 s53, s56, s53
    buffer_load_dwordx4 v7, s[28:31], s55 offen offset:0 sc1 lds
    buffer_load_dwordx4 v7, s[28:31], s55 offen offset:1024 sc1 lds
    buffer_load_dwordx4 v7, s[28:31], s55 offen offset:2048 sc1 lds
    v_mov_b32 v8, 0xff7fffff
    v_mov_b32 v9, 0xff7fffff
    s_waitcnt vmcnt(3)
    s_barrier
    ds_read2_b64 v[128:131], v5 offset0:0 offset1:224
    ds_read_b128 v[116:119], v4
    ds_read_b64_tr_b16 v[120:121], v6
    ds_read_b64_tr_b16 v[122:123], v6 offset:448
    s_waitcnt lgkmcnt(3)
    v_mfma_f32_32x32x4_2b_bf16 v[20:51], v[128:129], v[10:11], 0
    s_nop 15
    s_nop 1
    s_waitcnt lgkmcnt(0)
    v_mfma_f32_32x32x16_bf16 v[20:35], v[116:119], v[12:15], v[20:35]
    v_mfma_f32_32x32x16_bf16 v[36:51], v[116:119], v[16:19], v[36:51]
    ds_read_b128 v[116:119], v4 offset:1024
    s_nop 10
    s_waitcnt lgkmcnt(0)
    .p2align 3
Lat_41:
    s_add_u32 s52, s52, 1
    s_cmp_eq_u32 s52, 3
    s_movk_i32 s51, 24576
    s_cselect_b32 s51, 4294918144, s51
    s_cselect_b32 s52, 0, s52
    v_max3_f32 v8, v20, v21, v8
    v_max3_f32 v8, v22, v23, v8
    v_max3_f32 v8, v24, v25, v8
    v_max3_f32 v8, v26, v27, v8
    s_nop 0
    s_nop 0
    s_nop 0
    s_nop 0
    s_waitcnt lgkmcnt(1)
    v_mfma_f32_32x32x4_2b_bf16 v[52:83], v[130:131], v[10:11], 0
    s_nop 0
    s_nop 0
    s_nop 0
    s_setprio 0
    s_nop 0
    v_max3_f32 v8, v28, v29, v8
    v_max3_f32 v8, v30, v31, v8
    v_max3_f32 v8, v32, v33, v8
    v_max3_f32 v8, v34, v35, v8
    s_nop 0
    s_nop 0
    s_nop 0
    s_nop 0
    s_nop 0
    s_nop 0
    s_nop 0
    s_nop 0
    v_max3_f32 v9, v36, v37, v9
    s_waitcnt lgkmcnt(0)
    v_mfma_f32_32x32x16_bf16 v[52:67], v[116:119], v[12:15], v[52:67]
    v_max3_f32 v9, v38, v39, v9
    v_max3_f32 v9, v40, v41, v9
    v_max3_f32 v9, v42, v43, v9
    s_nop 0
    s_nop 0
    s_nop 0
    s_nop 0
    s_nop 0
    s_nop 0
    v_mfma_f32_32x32x16_bf16 v[68:83], v[116:119], v[16:19], v[68:83]
    s_nop 0
    s_nop 0
    v_max3_f32 v9, v44, v45, v9
    v_max3_f32 v9, v46, v47, v9
    s_waitcnt vmcnt(0)
    s_barrier
    s_setprio 3
    v_add_u32 v4, s51, v4
    v_max3_f32 v9, v48, v49, v9
    ds_read_b128 v[116:119], v4
    v_max3_f32 v9, v50, v51, v9
    s_nop 0
    s_nop 0
    s_nop 0
    s_nop 0
    v_add_u32 v5, s51, v5
    s_nop 0
    ds_read2_b64 v[128:131], v5 offset0:0 offset1:224
    s_nop 0
    s_nop 0
    s_nop 0
    v_max3_f32 v8, v52, v53, v8
    s_setprio 2
    v_max3_f32 v8, v54, v55, v8
    v_max3_f32 v8, v56, v57, v8
    v_max3_f32 v8, v58, v59, v8
    s_nop 0
    s_nop 0
    s_nop 0
    s_nop 0
    s_waitcnt lgkmcnt(0)
    v_mfma_f32_32x32x4_2b_bf16 v[20:51], v[128:129], v[10:11], 0
    s_nop 0
    s_nop 0
    s_nop 0
    s_mul_i32 s55, s54, 24576
    s_add_u32 s55, s55, s59
    s_mov_b32 m0, s53
    s_add_u32 s54, s54, 1
    s_and_b32 s54, s54, 15
    s_add_u32 s53, s53, 24576
    s_cmp_ge_u32 s53, s57
    s_cselect_b32 s53, s56, s53
    buffer_load_dwordx4 v7, s[28:31], s55 offen offset:0 sc1 lds
    s_nop 0
    v_max3_f32 v8, v60, v61, v8
    v_max3_f32 v8, v62, v63, v8
    v_max3_f32 v8, v64, v65, v8
    v_max3_f32 v8, v66, v67, v8
    s_nop 0
    s_nop 0
    s_nop 0
    s_nop 0
    s_nop 0
    buffer_load_dwordx4 v7, s[28:31], s55 offen offset:1024 sc1 lds
    s_nop 0
    s_nop 0
    s_nop 0
    v_max3_f32 v9, v68, v69, v9
    v_mfma_f32_32x32x16_bf16 v[20:35], v[116:119], v[12:15], v[20:35]
    v_max3_f32 v9, v70, v71, v9
    v_max3_f32 v9, v72, v73, v9
    v_max3_f32 v9, v74, v75, v9
    s_nop 0
    s_nop 0
    s_nop 0
    s_setprio 1
    buffer_load_dwordx4 v7, s[28:31], s55 offen offset:2048 sc1 lds
    s_nop 0
    s_nop 0
    s_nop 0
    v_mfma_f32_32x32x16_bf16 v[36:51], v[116:119], v[16:19], v[36:51]
    s_nop 0
    s_nop 0
    ds_read_b128 v[116:119], v4 offset:1024
    v_max3_f32 v9, v76, v77, v9
    v_max3_f32 v9, v78, v79, v9
    v_max3_f32 v9, v80, v81, v9
    v_max3_f32 v9, v82, v83, v9
    s_nop 0
    s_nop 0
    v_add_u32 v6, s51, v6
    s_nop 0
    s_nop 0
    s_nop 0
    s_nop 0
    s_nop 0
    s_nop 0
    s_add_u32 s50, s50, 1
    s_cmp_lt_u32 s50, 16
    s_cbranch_scc1 Lat_41
    s_nop 0
    s_waitcnt lgkmcnt(0)
    s_setprio 0
    s_waitcnt vmcnt(0)
    v_mov_b32 v132, v8
    v_mov_b32 v133, v9
    s_nop 1
    v_permlane32_swap_b32 v132, v8
    v_permlane32_swap_b32 v133, v9
    v_max_f32 v8, v8, v132
    v_max_f32 v9, v9, v133
    s_lshl_b32 s37, s32, 9
    s_add_u32 s37, s37, 53248
    v_lshl_add_u32 v132, v1, 3, s37
    ds_write_b64 v132, v[8:9]
    v_xor_b32 v132, 1024, v132
    s_waitcnt lgkmcnt(0)
    s_barrier
    ds_read_b64 v[132:133], v132
    s_waitcnt lgkmcnt(0)
    v_max_f32 v8, v8, v132
    v_max_f32 v9, v9, v133
    s_barrier
    v_lshlrev_b32 v7, 4, v1
    s_lshl_b32 s55, s58, 11
    s_add_u32 s55, s55, s49
    v_add_u32 v4, s55, v7
    s_mul_i32 s55, s58, 3584
    s_add_u32 s55, s55, s49
    s_add_u32 s55, s55, 4096
    v_and_b32 v133, 31, v1
    v_mul_u32_u24 v5, 56, v133
    v_add_u32 v5, 48, v5
    v_add_u32 v5, s55, v5
    v_lshrrev_b32 v133, 5, v1
    v_lshlrev_b32 v133, 2, v133
    v_bfe_u32 v6, v1, 2, 2
    v_add_u32 v133, v133, v6
    v_mul_u32_u24 v6, 56, v133
    v_add_u32 v6, s55, v6
    v_bfe_u32 v133, v1, 4, 1
    v_lshlrev_b32 v133, 2, v133
    v_and_b32 v116, 3, v1
    v_add_u32 v133, v133, v116
    v_min_u32 v133, 5, v133
    v_lshlrev_b32 v133, 3, v133
    v_add_u32 v6, v6, v133
    s_mul_i32 s56, s32, 3072
    s_add_u32 s59, s48, s56
    s_add_u32 s56, s56, 92160
    s_add_u32 s57, s56, 73728
    s_mov_b32 s53, s56
    s_mov_b32 s54, s33
    v_mov_b32 v84, 0
    v_mov_b32 v85, 0
    v_mov_b32 v86, 0
    v_mov_b32 v87, 0
    v_mov_b32 v88, 0
    v_mov_b32 v89, 0
    v_mov_b32 v90, 0
    v_mov_b32 v91, 0
    v_mov_b32 v92, 0
    v_mov_b32 v93, 0
    v_mov_b32 v94, 0
    v_mov_b32 v95, 0
    v_mov_b32 v96, 0
    v_mov_b32 v97, 0
    v_mov_b32 v98, 0
    v_mov_b32 v99, 0
    v_mov_b32 v100, 0
    v_mov_b32 v101, 0
    v_mov_b32 v102, 0
    v_mov_b32 v103, 0
    v_mov_b32 v104, 0
    v_mov_b32 v105, 0
    v_mov_b32 v106, 0
    v_mov_b32 v107, 0
    v_mov_b32 v108, 0
    v_mov_b32 v109, 0
    v_mov_b32 v110, 0
    v_mov_b32 v111, 0
    v_mov_b32 v112, 0
    v_mov_b32 v113, 0
    v_mov_b32 v114, 0
    v_mov_b32 v115, 0
    v_mov_b32 v76, 0
    v_mov_b32 v124, 0
    v_mov_b32 v77, 0
    v_mov_b32 v125, 0
    v_mov_b32 v78, 0
    v_mov_b32 v126, 0
    v_mov_b32 v79, 0
    v_mov_b32 v127, 0
    s_mov_b32 s50, 0
    s_mov_b32 s52, 0
    s_mul_i32 s55, s54, 24576
    s_add_u32 s55, s55, s59
    s_mov_b32 m0, s53
    s_add_u32 s54, s54, 1
    s_and_b32 s54, s54, 15
    s_add_u32 s53, s53, 24576
    s_cmp_ge_u32 s53, s57
    s_cselect_b32 s53, s56, s53
    buffer_load_dwordx4 v7, s[28:31], s55 offen offset:0 sc1 lds
    buffer_load_dwordx4 v7, s[28:31], s55 offen offset:1024 sc1 lds
    buffer_load_dwordx4 v7, s[28:31], s55 offen offset:2048 sc1 lds
    s_mul_i32 s55, s54, 24576
    s_add_u32 s55, s55, s59
    s_mov_b32 m0, s53
    s_add_u32 s54, s54, 1
    s_and_b32 s54, s54, 15
    s_add_u32 s53, s53, 24576
    s_cmp_ge_u32 s53, s57
    s_cselect_b32 s53, s56, s53
    buffer_load_dwordx4 v7, s[28:31], s55 offen offset:0 sc1 lds
    buffer_load_dwordx4 v7, s[28:31], s55 offen offset:1024 sc1 lds
    buffer_load_dwordx4 v7, s[28:31], s55 offen offset:2048 sc1 lds
    s_waitcnt vmcnt(3)
    s_barrier
    ds_read2_b64 v[128:131], v5 offset0:0 offset1:224
    ds_read_b128 v[116:119], v4
    ds_read_b64_tr_b16 v[120:121], v6
    ds_read_b64_tr_b16 v[122:123], v6 offset:448
    s_waitcnt lgkmcnt(3)
    v_mfma_f32_32x32x4_2b_bf16 v[20:51], v[128:129], v[10:11], 0
    s_nop 15
    s_nop 1
    s_waitcnt lgkmcnt(0)
    v_mfma_f32_32x32x16_bf16 v[20:35], v[116:119], v[12:15], v[20:35]
    v_mfma_f32_32x32x16_bf16 v[36:51], v[116:119], v[16:19], v[36:51]
    ds_read_b128 v[116:119], v4 offset:1024
    s_nop 10
    s_waitcnt lgkmcnt(0)
    .p2align 3
Lat_42:
    s_add_u32 s52, s52, 1
    s_cmp_eq_u32 s52, 3
    s_movk_i32 s51, 24576
    s_cselect_b32 s51, 4294918144, s51
    s_cselect_b32 s52, 0, s52
    v_sub_f32 v20, v20, v8
    v_exp_f32 v20, v20
    v_sub_f32 v21, v21, v8
    v_exp_f32 v21, v21
    v_sub_f32 v22, v22, v8
    v_exp_f32 v22, v22
    s_waitcnt lgkmcnt(3)
    v_mfma_f32_32x32x16_bf16 v[100:115], v[124:127], v[76:79], v[100:115]
    v_sub_f32 v23, v23, v8
    v_exp_f32 v23, v23
    v_sub_f32 v24, v24, v8
    v_exp_f32 v24, v24
    ds_read_b64_tr_b16 v[124:125], v6 offset:896
    ds_read_b64_tr_b16 v[126:127], v6 offset:1344
    v_sub_f32 v25, v25, v8
    v_exp_f32 v25, v25
    v_sub_f32 v26, v26, v8
    v_exp_f32 v26, v26
    v_sub_f32 v27, v27, v8
    v_exp_f32 v27, v27
    v_mfma_f32_32x32x4_2b_bf16 v[52:83], v[130:131], v[10:11], 0
    v_cvt_pk_bf16_f32 v20, v20, v21
    v_cvt_pk_bf16_f32 v21, v22, v23
    v_cvt_pk_bf16_f32 v22, v24, v25
    s_setprio 0
    v_cvt_pk_bf16_f32 v23, v26, v27
    v_sub_f32 v28, v28, v8
    v_exp_f32 v28, v28
    v_sub_f32 v29, v29, v8
    v_exp_f32 v29, v29
    v_sub_f32 v30, v30, v8
    v_exp_f32 v30, v30
    v_sub_f32 v31, v31, v8
    v_exp_f32 v31, v31
    v_sub_f32 v32, v32, v8
    v_exp_f32 v32, v32
    s_waitcnt lgkmcnt(2)
    v_mfma_f32_32x32x16_bf16 v[84:99], v[120:123], v[20:23], v[84:99]
    v_sub_f32 v33, v33, v8
    v_exp_f32 v33, v33
    v_sub_f32 v34, v34, v8
    v_exp_f32 v34, v34
    v_sub_f32 v35, v35, v8
    v_exp_f32 v35, v35
    v_cvt_pk_bf16_f32 v28, v28, v29
    v_cvt_pk_bf16_f32 v29, v30, v31
    v_cvt_pk_bf16_f32 v30, v32, v33
    v_cvt_pk_bf16_f32 v31, v34, v35
    v_sub_f32 v36, v36, v9
    v_exp_f32 v36, v36
    v_mfma_f32_32x32x16_bf16 v[52:67], v[116:119], v[12:15], v[52:67]
    v_sub_f32 v37, v37, v9
    v_exp_f32 v37, v37
    v_sub_f32 v38, v38, v9
    v_exp_f32 v38, v38
    v_sub_f32 v39, v39, v9
    v_exp_f32 v39, v39
    v_sub_f32 v40, v40, v9
    v_exp_f32 v40, v40
    s_waitcnt lgkmcnt(0)
    v_mfma_f32_32x32x16_bf16 v[84:99], v[124:127], v[28:31], v[84:99]
    v_sub_f32 v41, v41, v9
    v_exp_f32 v41, v41
    v_sub_f32 v42, v42, v9
    v_exp_f32 v42, v42
    v_sub_f32 v43, v43, v9
    v_exp_f32 v43, v43
    v_cvt_pk_bf16_f32 v36, v36, v37
    v_cvt_pk_bf16_f32 v37, v38, v39
    v_mfma_f32_32x32x16_bf16 v[68:83], v[116:119], v[16:19], v[68:83]
    v_cvt_pk_bf16_f32 v38, v40, v41
    v_cvt_pk_bf16_f32 v39, v42, v43
    v_sub_f32 v44, v44, v9
    v_exp_f32 v44, v44
    v_sub_f32 v45, v45, v9
    v_exp_f32 v45, v45
    s_waitcnt vmcnt(0)
    s_barrier
    s_setprio 3
    v_add_u32 v4, s51, v4
    v_sub_f32 v46, v46, v9
    v_exp_f32 v46, v46
    ds_read_b128 v[116:119], v4
    v_sub_f32 v47, v47, v9
    v_exp_f32 v47, v47
    v_sub_f32 v48, v48, v9
    v_exp_f32 v48, v48
    v_mfma_f32_32x32x16_bf16 v[100:115], v[120:123], v[36:39], v[100:115]
    v_sub_f32 v49, v49, v9
    v_exp_f32 v49, v49
    v_sub_f32 v50, v50, v9
    v_exp_f32 v50, v50
    ds_read_b64_tr_b16 v[120:121], v6 offset:1792
    ds_read_b64_tr_b16 v[122:123], v6 offset:2240
    v_sub_f32 v51, v51, v9
    v_exp_f32 v51, v51
    v_add_u32 v5, s51, v5
    v_cvt_pk_bf16_f32 v44, v44, v45
    ds_read2_b64 v[128:131], v5 offset0:0 offset1:224
    v_cvt_pk_bf16_f32 v45, v46, v47
    v_cvt_pk_bf16_f32 v46, v48, v49
    v_cvt_pk_bf16_f32 v47, v50, v51
    v_sub_f32 v52, v52, v8
    v_exp_f32 v52, v52
    s_setprio 2
    v_sub_f32 v53, v53, v8
    v_exp_f32 v53, v53
    v_sub_f32 v54, v54, v8
    v_exp_f32 v54, v54
    v_mfma_f32_32x32x16_bf16 v[100:115], v[124:127], v[44:47], v[100:115]
    v_sub_f32 v55, v55, v8
    v_exp_f32 v55, v55
    v_sub_f32 v56, v56, v8
    v_exp_f32 v56, v56
    ds_read_b64_tr_b16 v[124:125], v6 offset:2688
    ds_read_b64_tr_b16 v[126:127], v6 offset:3136
    v_sub_f32 v57, v57, v8
    v_exp_f32 v57, v57
    v_sub_f32 v58, v58, v8
    v_exp_f32 v58, v58
    v_sub_f32 v59, v59, v8
    v_exp_f32 v59, v59
    s_waitcnt lgkmcnt(2)
    v_mfma_f32_32x32x4_2b_bf16 v[20:51], v[128:129], v[10:11], 0
    v_cvt_pk_bf16_f32 v52, v52, v53
    v_cvt_pk_bf16_f32 v53, v54, v55
    v_cvt_pk_bf16_f32 v54, v56, v57
    s_mul_i32 s55, s54, 24576
    s_add_u32 s55, s55, s59
    s_mov_b32 m0, s53
    s_add_u32 s54, s54, 1
    s_and_b32 s54, s54, 15
    s_add_u32 s53, s53, 24576
    s_cmp_ge_u32 s53, s57
    s_cselect_b32 s53, s56, s53
    buffer_load_dwordx4 v7, s[28:31], s55 offen offset:0 sc1 lds
    v_cvt_pk_bf16_f32 v55, v58, v59
    v_sub_f32 v60, v60, v8
    v_exp_f32 v60, v60
    v_sub_f32 v61, v61, v8
    v_exp_f32 v61, v61
    v_sub_f32 v62, v62, v8
    v_exp_f32 v62, v62
    v_sub_f32 v63, v63, v8
    v_exp_f32 v63, v63
    v_sub_f32 v64, v64, v8
    v_exp_f32 v64, v64
    v_mfma_f32_32x32x16_bf16 v[84:99], v[120:123], v[52:55], v[84:99]
    v_sub_f32 v65, v65, v8
    v_exp_f32 v65, v65
    v_sub_f32 v66, v66, v8
    v_exp_f32 v66, v66
    v_sub_f32 v67, v67, v8
    v_exp_f32 v67, v67
    v_cvt_pk_bf16_f32 v60, v60, v61
    buffer_load_dwordx4 v7, s[28:31], s55 offen offset:1024 sc1 lds
    v_cvt_pk_bf16_f32 v61, v62, v63
    v_cvt_pk_bf16_f32 v62, v64, v65
    v_cvt_pk_bf16_f32 v63, v66, v67
    v_sub_f32 v68, v68, v9
    v_exp_f32 v68, v68
    v_mfma_f32_32x32x16_bf16 v[20:35], v[116:119], v[12:15], v[20:35]
    v_sub_f32 v69, v69, v9
    v_exp_f32 v69, v69
    v_sub_f32 v70, v70, v9
    v_exp_f32 v70, v70
    v_sub_f32 v71, v71, v9
    v_exp_f32 v71, v71
    v_sub_f32 v72, v72, v9
    v_exp_f32 v72, v72
    s_waitcnt lgkmcnt(0)
    v_mfma_f32_32x32x16_bf16 v[84:99], v[124:127], v[60:63], v[84:99]
    v_sub_f32 v73, v73, v9
    v_exp_f32 v73, v73
    v_sub_f32 v74, v74, v9
    v_exp_f32 v74, v74
    s_setprio 1
    buffer_load_dwordx4 v7, s[28:31], s55 offen offset:2048 sc1 lds
    v_sub_f32 v75, v75, v9
    v_exp_f32 v75, v75
    v_cvt_pk_bf16_f32 v68, v68, v69
    v_cvt_pk_bf16_f32 v69, v70, v71
    v_mfma_f32_32x32x16_bf16 v[36:51], v[116:119], v[16:19], v[36:51]
    v_cvt_pk_bf16_f32 v70, v72, v73
    v_cvt_pk_bf16_f32 v71, v74, v75
    ds_read_b128 v[116:119], v4 offset:1024
    v_sub_f32 v76, v76, v9
    v_exp_f32 v76, v76
    v_sub_f32 v77, v77, v9
    v_exp_f32 v77, v77
    v_sub_f32 v78, v78, v9
    v_exp_f32 v78, v78
    v_sub_f32 v79, v79, v9
    v_exp_f32 v79, v79
    v_sub_f32 v80, v80, v9
    v_exp_f32 v80, v80
    v_mfma_f32_32x32x16_bf16 v[100:115], v[120:123], v[68:71], v[100:115]
    v_sub_f32 v81, v81, v9
    v_exp_f32 v81, v81
    v_add_u32 v6, s51, v6
    v_sub_f32 v82, v82, v9
    v_exp_f32 v82, v82
    ds_read_b64_tr_b16 v[120:121], v6 offset:0
    ds_read_b64_tr_b16 v[122:123], v6 offset:448
    v_sub_f32 v83, v83, v9
    v_exp_f32 v83, v83
    v_cvt_pk_bf16_f32 v76, v76, v77
    v_cvt_pk_bf16_f32 v77, v78, v79
    v_cvt_pk_bf16_f32 v78, v80, v81
    v_cvt_pk_bf16_f32 v79, v82, v83
    s_add_u32 s50, s50, 1
    s_cmp_lt_u32 s50, 16
    s_cbranch_scc1 Lat_42
    s_nop 0
    s_waitcnt lgkmcnt(0)
    v_mfma_f32_32x32x16_bf16 v[100:115], v[124:127], v[76:79], v[100:115]
    s_setprio 0
    s_waitcnt vmcnt(0)
    s_mul_i32 s37, s32, 3072
    s_add_u32 s37, s37, 53248
    v_lshl_add_u32 v132, v1, 4, s37
    s_xor_b32 s38, s32, 2
    s_mul_i32 s38, s38, 3072
    s_add_u32 s38, s38, 53248
    v_lshl_add_u32 v133, v1, 4, s38
    s_nop 6
    s_cmp_lg_u32 s58, 0
    s_cbranch_scc1 Lox1b
    ds_write_b128 v132, v[100:103] offset:0
    ds_write_b128 v132, v[104:107] offset:1024
    ds_write_b128 v132, v[108:111] offset:2048
    s_branch Lox2b
Lox1b:
    ds_write_b128 v132, v[84:87] offset:0
    ds_write_b128 v132, v[88:91] offset:1024
    ds_write_b128 v132, v[92:95] offset:2048
    v_mov_b32 v84, v100
    v_mov_b32 v85, v101
    v_mov_b32 v86, v102
    v_mov_b32 v87, v103
    v_mov_b32 v88, v104
    v_mov_b32 v89, v105
    v_mov_b32 v90, v106
    v_mov_b32 v91, v107
    v_mov_b32 v92, v108
    v_mov_b32 v93, v109
    v_mov_b32 v94, v110
    v_mov_b32 v95, v111
Lox2b:
    s_waitcnt lgkmcnt(0)
    s_barrier
    ds_read_b128 v[20:23], v133 offset:0
    ds_read_b128 v[24:27], v133 offset:1024
    ds_read_b128 v[28:31], v133 offset:2048
    s_and_b32 s37, s32, 1
    s_lshl_b32 s37, s37, 1
    s_add_u32 s37, s37, s58
    s_lshl_b32 s38, s33, 2
    s_add_u32 s37, s37, s38
    s_mul_i32 s37, s37, 40960
    s_add_u32 s37, s37, 0xa00000
    s_lshr_b32 s38, s32, 2
    s_lshl_b32 s39, s34, 1
    s_add_u32 s38, s38, s39
    s_lshl_b32 s39, s38, 10
    s_add_u32 s39, s39, s37
    s_lshl_b32 s38, s38, 8
    s_add_u32 s38, s38, s37
    s_add_u32 s38, s38, 32768
    s_mov_b32 s64, s39
    s_mov_b32 s65, s38
    s_waitcnt lgkmcnt(0)
    v_add_f32 v84, v84, v20
    v_add_f32 v85, v85, v21
    v_add_f32 v86, v86, v22
    v_add_f32 v87, v87, v23
    v_add_f32 v88, v88, v24
    v_add_f32 v89, v89, v25
    v_add_f32 v90, v90, v26
    v_add_f32 v91, v91, v27
    v_add_f32 v92, v92, v28
    v_add_f32 v93, v93, v29
    v_add_f32 v94, v94, v30
    v_add_f32 v95, v95, v31
    v_mov_b32 v32, v92
    v_mov_b32 v33, v92
    s_nop 1
    v_permlane32_swap_b32 v32, v33
    v_rcp_f32 v32, v33
    s_nop 0
    v_mul_f32 v84, v84, v32
    v_mul_f32 v85, v85, v32
    v_mul_f32 v86, v86, v32
    v_mul_f32 v87, v87, v32
    v_mul_f32 v88, v88, v32
    v_mul_f32 v89, v89, v32
    v_mul_f32 v90, v90, v32
    v_mul_f32 v91, v91, v32
    v_mul_f32 v92, v92, v32
    v_mul_f32 v93, v93, v32
    v_mul_f32 v94, v94, v32
    v_mul_f32 v95, v95, v32
    v_cvt_pk_bf16_f32 v20, v84, v85
    v_cvt_pk_bf16_f32 v21, v86, v87
    v_cvt_pk_bf16_f32 v22, v88, v89
    v_cvt_pk_bf16_f32 v23, v90, v91
    v_cvt_pk_bf16_f32 v24, v92, v93
    v_cvt_pk_bf16_f32 v25, v94, v95
    v_lshlrev_b32 v132, 4, v1
    v_lshlrev_b32 v133, 3, v1
    buffer_store_dwordx4 v[20:23], v132, s[28:31], s39 offen sc1
    s_mov_b32 exec_hi, 0
    buffer_store_dwordx2 v[24:25], v133, s[28:31], s38 offen sc1
    s_mov_b32 exec_hi, -1
    s_waitcnt vmcnt(0)
    s_barrier
    s_branch Lo_done
Lcode_end:

    s_endpgm
.section .rodata,"a"
.p2align 6
.amdhsa_kernel adaLN_cond__mha_block__geglu_ffn__prompt_kernel
  .amdhsa_next_free_vgpr 256
  .amdhsa_next_free_sgpr 102
  .amdhsa_accum_offset 256
  .amdhsa_group_segment_fixed_size 0
  .amdhsa_kernarg_size 96
  .amdhsa_user_sgpr_count 2
  .amdhsa_user_sgpr_kernarg_segment_ptr 1
  .amdhsa_system_sgpr_workgroup_id_x 1
.end_amdhsa_kernel
```
